```python
import torch

def _softmax(x, axis=-1):
    return torch.softmax(x, dim=axis)
def _gelu(x):
    return torch.nn.functional.gelu(x, approximate="tanh")
def _silu(x):
    return torch.nn.functional.silu(x)
def _sigmoid(x):
    return torch.sigmoid(x)
def _layernorm(x, axis=-1, eps=1e-5):
    m = x.mean(dim=axis, keepdim=True)
    v = x.var(dim=axis, keepdim=True, unbiased=False)
    return (x - m) / torch.sqrt(v + eps)
def _scatter_add(tgt, idx, src, axis=0):
    return tgt.clone().index_add_(axis, idx, src)
def _segment_sum(src, seg, n):
    out = torch.zeros((n,) + src.shape[1:], dtype=src.dtype)
    return out.index_add_(0, seg, src)
def _pad(x, pw):
    flat = tuple(v for pair in reversed(pw) for v in pair)
    return torch.nn.functional.pad(x, flat)

kernel_name = 'parallel_sum__mha_block__mixer_token_mlp__prompt'

def setup_inputs():

    _w = (lambda a: (lambda t: t.to(torch.bfloat16) if t.is_floating_point() else t)(torch.as_tensor(a)))
    def _A_setup():
        B, S, D, H = 1, 2048, 640, 32
        return {
            "x": _w((lambda *s: torch.randn(*s, dtype=torch.bfloat16) * 0.05)(B, S, D)),
            "wqkv": _w((lambda *s: torch.randn(*s, dtype=torch.bfloat16) * 0.05)(D, 3 * D)),
            "wo": _w((lambda *s: torch.randn(*s, dtype=torch.bfloat16) * 0.05)(D, D)),
        }
    _A_in = _A_setup()

    def _B_setup():
        B, S, D, F = 1, 2048, 640, 1536
        return {
            "x": _w((lambda *s: torch.randn(*s, dtype=torch.bfloat16) * 0.05)(B, S, D)),
            "w1": _w((lambda *s: torch.randn(*s, dtype=torch.bfloat16) * 1.6)(S, F) * (S ** -0.5)),
            "b1": _w((lambda *s: torch.randn(*s, dtype=torch.bfloat16) * 12.8)(F) * 0.02),
            "w2": _w((lambda *s: torch.randn(*s, dtype=torch.bfloat16) * 0.8)(F, S) * (F ** -0.5)),
            "b2": _w((lambda *s: torch.randn(*s, dtype=torch.bfloat16) * 12.8)(S) * 0.02),
        }
    _B_in = _B_setup()

    return {
        "A_x": _A_in["x"],
        "A_wqkv": _A_in["wqkv"],
        "A_wo": _A_in["wo"],
        "B_x": _B_in["x"],
        "B_w1": _B_in["w1"],
        "B_b1": _B_in["b1"],
        "B_w2": _B_in["w2"],
        "B_b2": _B_in["b2"],
    }

def reference(A_x, A_wqkv, A_wo, B_x, B_w1, B_b1, B_w2, B_b2):
    def _A_ref(x, wqkv, wo):
        B, S, D = x.shape
        H = 32
        Dh = D // H
        qkv = (lambda x, *d: x.permute(*d))((x @ wqkv).reshape(B, S, 3, H, Dh), 2, 0, 3, 1, 4)
        q, k, v = qkv[0], qkv[1], qkv[2]
        scores = torch.einsum("bhqd,bhkd->bhqk", q, k) * (Dh ** -0.5)
        p = _softmax(scores, axis=-1)
        o = torch.einsum("bhqk,bhkd->bhqd", p, v)
        return (lambda x, *d: x.permute(*d))(o, 0, 2, 1, 3).reshape(B, S, D) @ wo

    def _B_ref(x, w1, b1, w2, b2):
        B, S, D = x.shape
        h = _layernorm(x, axis=-1)
        u = torch.einsum("bsd,sf->bdf", h, w1) + b1
        u = _gelu(u)
        y = torch.einsum("bdf,fs->bds", u, w2) + b2
        return (lambda x, *d: x.permute(*d))(y, 0, 2, 1)

    x = A_x
    xn = _layernorm(x, axis=-1)
    return x + _A_ref(xn, A_wqkv, A_wo) + _B_ref(xn, B_w1, B_b1, B_w2, B_b2)
```

```asm
; @launch grid=(256,1,1) block=(512,1,1) lds=159936
.amdgcn_target "amdgcn-amd-amdhsa--gfx950"
.text
.globl parallel_sum__mha_block__mixer_token_mlp__prompt_kernel
.p2align 8
.type parallel_sum__mha_block__mixer_token_mlp__prompt_kernel,@function
parallel_sum__mha_block__mixer_token_mlp__prompt_kernel:
    s_cmp_ge_u32 s2, 256
    s_cbranch_scc1 parallel_sum__mha_block__mixer_token_mlp__prompt_kernel_end
    s_load_dwordx4 s[4:7], s[0:1], 0
    s_load_dwordx4 s[40:43], s[0:1], 72
    s_load_dwordx8 s[72:79], s[0:1], 32
    s_load_dwordx2 s[8:9], s[0:1], 16
    s_load_dwordx2 s[50:51], s[0:1], 64
    v_lshrrev_b32 v2, 6, v0
    v_and_b32 v1, 63, v0
    v_readfirstlane_b32 s37, v2
    s_and_b32 s28, s2, 7
    s_lshr_b32 s29, s2, 3
    s_and_b32 s3, s37, 3
    s_and_b32 s30, s28, 3
    s_lshl_b32 s30, s30, 2
    s_and_b32 s31, s29, 3
    s_add_u32 s10, s30, s31
    s_lshr_b32 s28, s28, 2
    s_lshl_b32 s28, s28, 3
    s_lshr_b32 s29, s29, 2
    s_add_u32 s11, s28, s29
    s_lshl_b32 s26, s3, 14
    s_add_u32 s26, s26, 65536
    v_and_b32 v184, 31, v1
    v_lshrrev_b32 v185, 5, v1
    s_cmp_lt_u32 s37, 4
    s_cbranch_scc1 parallel_sum__mha_block__mixer_token_mlp__prompt_kernel_C
    s_mul_i32 s28, s11, 240
    s_lshl_b32 s29, s11, 8
    s_add_u32 s29, s29, -256
    s_cmp_lt_u32 s11, 11
    s_cselect_b32 s32, s28, s29
    s_lshl_b32 s28, s10, 7
    s_lshl_b32 s30, s3, 5
    s_add_u32 s28, s28, s30
    s_mul_i32 s24, s28, 1280
    s_lshl_b32 s38, s28, 4
    s_add_u32 s38, s38, 19136512
    s_mul_i32 s25, s3, 61440
    s_add_u32 s25, s25, s32
    s_lshl_b32 s27, s3, 12
    v_lshrrev_b32 v180, 3, v1
    v_lshrrev_b32 v181, 4, v1
    v_and_b32 v182, 7, v1
    v_mul_u32_u24 v180, 1280, v180
    v_xor_b32 v183, v182, v181
    v_lshl_add_u32 v2, v183, 4, v180
    v_xor_b32 v183, v182, v181
    v_xor_b32 v183, 4, v183
    v_lshl_add_u32 v3, v183, 4, v180
    v_add_u32 v3, 10240, v3
    v_xor_b32 v183, v182, v181
    v_lshl_add_u32 v4, v183, 4, v180
    v_add_u32 v4, 20480, v4
    v_xor_b32 v183, v182, v181
    v_xor_b32 v183, 4, v183
    v_lshl_add_u32 v5, v183, 4, v180
    v_add_u32 v5, 30720, v5
    v_and_b32 v182, 15, v1
    v_lshlrev_b32 v183, 2, v181
    v_xor_b32 v182, v182, v183
    v_mul_u32_u24 v180, 3840, v181
    v_lshl_add_u32 v6, v182, 4, v180
    v_add_u32 v7, 15360, v6
    v_xor_b32 v8, 32, v6
    v_add_u32 v8, 30720, v8
    v_xor_b32 v9, 32, v6
    v_add_u32 v9, 46080, v9
    s_cmp_eq_u32 s11, 10
    s_cselect_b32 s28, 10, 15
    s_cmp_gt_u32 s11, 10
    s_cselect_b32 s28, 16, s28
    v_xor_b32 v183, 2, v182
    v_cmp_le_u32 vcc, s28, v182
    v_cmp_le_u32 s[60:61], s28, v183
    v_mov_b32 v183, 0x40000000
    v_cndmask_b32 v6, v6, v183, vcc
    v_cndmask_b32 v7, v7, v183, vcc
    v_cndmask_b32 v8, v8, v183, s[60:61]
    v_cndmask_b32 v9, v9, v183, s[60:61]
    s_waitcnt lgkmcnt(0)
    s_mov_b32 s12, s4
    s_and_b32 s13, s5, 0xffff
    s_mov_b32 s14, 2621440
    s_mov_b32 s15, 0x20000
    s_mov_b32 s16, s6
    s_and_b32 s17, s7, 0xffff
    s_mov_b32 s18, 2457600
    s_mov_b32 s19, 0x20000
    s_mov_b32 s44, s40
    s_and_b32 s45, s41, 0xffff
    s_mov_b32 s46, 256
    s_mov_b32 s47, 0x20000
    v_mov_b32 v207, 0
    s_or_b32 s28, s2, s3
    s_cbranch_scc1 parallel_sum__mha_block__mixer_token_mlp__prompt_kernel_NN
    s_memrealtime s[100:101]
    s_waitcnt lgkmcnt(0)
    s_or_b32 s100, s100, 1
    v_mov_b32 v208, s100
    v_mov_b32 v209, s101
    s_mov_b64 exec, 1
    buffer_store_dwordx2 v[208:209], v207, s[44:47], 0 offen sc1
    s_mov_b64 exec, -1
parallel_sum__mha_block__mixer_token_mlp__prompt_kernel_NN:
    s_add_u32 m0, s27, 0
    s_nop 0
    buffer_load_dwordx4 v6, s[16:19], s25 offen lds
    s_add_u32 m0, s26, 0
    s_nop 0
    buffer_load_dwordx4 v2, s[12:15], s24 offen lds
    s_add_u32 m0, s27, 1024
    s_nop 0
    buffer_load_dwordx4 v7, s[16:19], s25 offen lds
    s_add_u32 m0, s26, 1024
    s_nop 0
    buffer_load_dwordx4 v3, s[12:15], s24 offen lds
    s_add_u32 m0, s27, 2048
    s_nop 0
    buffer_load_dwordx4 v8, s[16:19], s25 offen lds
    s_add_u32 m0, s26, 2048
    s_nop 0
    buffer_load_dwordx4 v4, s[12:15], s24 offen lds
    s_add_u32 m0, s27, 3072
    s_nop 0
    buffer_load_dwordx4 v9, s[16:19], s25 offen lds
    s_add_u32 m0, s26, 3072
    s_nop 0
    buffer_load_dwordx4 v5, s[12:15], s24 offen lds
    s_add_u32 s24, s24, 128
    s_add_u32 s25, s25, 245760
    s_add_u32 m0, s27, 16384
    s_nop 0
    buffer_load_dwordx4 v6, s[16:19], s25 offen lds
    s_add_u32 m0, s26, 4096
    s_nop 0
    buffer_load_dwordx4 v2, s[12:15], s24 offen lds
    s_add_u32 m0, s27, 17408
    s_nop 0
    buffer_load_dwordx4 v7, s[16:19], s25 offen lds
    s_add_u32 m0, s26, 5120
    s_nop 0
    buffer_load_dwordx4 v3, s[12:15], s24 offen lds
    s_add_u32 m0, s27, 18432
    s_nop 0
    buffer_load_dwordx4 v8, s[16:19], s25 offen lds
    s_add_u32 m0, s26, 6144
    s_nop 0
    buffer_load_dwordx4 v4, s[12:15], s24 offen lds
    s_add_u32 m0, s27, 19456
    s_nop 0
    buffer_load_dwordx4 v9, s[16:19], s25 offen lds
    s_add_u32 m0, s26, 7168
    s_nop 0
    buffer_load_dwordx4 v5, s[12:15], s24 offen lds
    s_add_u32 s24, s24, 128
    s_add_u32 s25, s25, 245760
    s_lshl_b32 s58, s2, 1
    s_lshr_b32 s59, s3, 1
    s_add_u32 s58, s58, s59
    s_mul_i32 s59, s58, 3840
    s_add_u32 s59, s59, 491520
    s_mul_i32 s58, s58, 5120
    s_add_u32 s58, s58, 256
    v_lshlrev_b32 v168, 7, v1
    v_lshrrev_b32 v169, 3, v1
    v_mul_u32_u24 v169, 256, v169
    v_add_u32 v169, v169, v168
    s_bitcmp1_b32 s3, 0
    s_cbranch_scc1 parallel_sum__mha_block__mixer_token_mlp__prompt_kernel_tgW
    s_mov_b32 exec_hi, 0
    buffer_load_dword v170, v169, s[12:15], s58 offen
    s_branch parallel_sum__mha_block__mixer_token_mlp__prompt_kernel_tgE
parallel_sum__mha_block__mixer_token_mlp__prompt_kernel_tgW:
    s_mov_b64 exec, 0x3fffffff
    buffer_load_dword v170, v168, s[16:19], s59 offen
parallel_sum__mha_block__mixer_token_mlp__prompt_kernel_tgE:
    s_mov_b64 exec, -1
    s_getpc_b64 s[60:61]
parallel_sum__mha_block__mixer_token_mlp__prompt_kernel_pc:
    s_lshr_b32 s62, s2, 3
    s_lshl_b32 s62, s62, 2
    s_add_u32 s62, s62, s3
    s_mul_i32 s62, s62, 384
    v_lshl_add_u32 v176, v1, 7, s62
    v_min_u32 v176, parallel_sum__mha_block__mixer_token_mlp__prompt_kernel_last-parallel_sum__mha_block__mixer_token_mlp__prompt_kernel_pc, v176
    s_mov_b64 exec, 7
    global_load_dword v177, v176, s[60:61]
    s_mov_b64 exec, -1
    s_mov_b32 s20, s42
    s_and_b32 s21, s43, 0xffff
    s_mov_b32 s22, 33554432
    s_mov_b32 s23, 0x20000
    v_mov_b32 v206, 0
    v_mov_b32 v205, 159744
    ds_write_b64 v205, v[206:207] offset:0
    ds_write_b64 v205, v[206:207] offset:8
    ds_write_b64 v205, v[206:207] offset:16
    ds_write_b64 v205, v[206:207] offset:24
    ds_write_b64 v205, v[206:207] offset:40
    ds_write_b64 v205, v[206:207] offset:48
    ds_write_b64 v205, v[206:207] offset:56
    ds_write_b64 v205, v[206:207] offset:64
    ds_write_b64 v205, v[206:207] offset:72
    v_bfe_u32 v180, v1, 2, 2
    v_mul_u32_u24 v180, 1280, v180
    v_lshrrev_b32 v181, 4, v1
    v_lshl_add_u32 v180, v181, 5, v180
    v_and_b32 v181, 3, v1
    v_lshl_add_u32 v180, v181, 3, v180
    s_lshl_b32 s28, s3, 7
    s_add_u32 s28, s28, 132672
    v_add_u32 v180, s28, v180
    s_cmp_lt_u32 s3, 2
    s_cselect_b32 s31, 8, 4
    s_lshl_b32 s28, s31, 7
    v_add_u32 v181, s28, v180
    v_lshrrev_b32 v182, 4, v1
    v_lshlrev_b32 v182, 16, v182
    v_and_b32 v183, 15, v1
    v_lshl_add_u32 v182, v183, 4, v182
    v_lshlrev_b32 v183, 3, v1
    s_lshl_b32 s33, s10, 4
    s_add_u32 s33, s33, s11
    s_lshl_b32 s34, s33, 8
    s_lshl_b32 s29, s3, 18
    s_add_u32 s34, s34, s29
    s_add_u32 s34, s34, 9437184
    s_add_u32 s39, s34, 1048576
    s_lshl_b32 s48, s31, 18
    s_add_u32 s48, s48, s34
    s_waitcnt vmcnt(10)
    s_barrier
    ds_read_b64_tr_b16 v[190:191], v180
    ds_read_b64_tr_b16 v[192:193], v180 offset:5120
    ds_read_b64_tr_b16 v[194:195], v180 offset:512
    ds_read_b64_tr_b16 v[196:197], v180 offset:5632
    ds_read_b64_tr_b16 v[198:199], v181
    ds_read_b64_tr_b16 v[200:201], v181 offset:5120
    v_add_u32 v204, 132608, v183
    ds_read_b64 v[202:203], v204
    s_add_u32 m0, s27, 32768
    s_nop 0
    buffer_load_dwordx4 v6, s[16:19], s25 offen lds
    s_add_u32 m0, s26, 8192
    s_nop 0
    buffer_load_dwordx4 v2, s[12:15], s24 offen lds
    s_add_u32 m0, s27, 33792
    s_nop 0
    buffer_load_dwordx4 v7, s[16:19], s25 offen lds
    s_add_u32 m0, s26, 9216
    s_nop 0
    buffer_load_dwordx4 v3, s[12:15], s24 offen lds
    s_add_u32 m0, s27, 34816
    s_nop 0
    buffer_load_dwordx4 v8, s[16:19], s25 offen lds
    s_add_u32 m0, s26, 10240
    s_nop 0
    buffer_load_dwordx4 v4, s[12:15], s24 offen lds
    s_add_u32 m0, s27, 35840
    s_nop 0
    buffer_load_dwordx4 v9, s[16:19], s25 offen lds
    s_add_u32 m0, s26, 11264
    s_nop 0
    buffer_load_dwordx4 v5, s[12:15], s24 offen lds
    s_add_u32 s24, s24, 128
    s_add_u32 s25, s25, 245760
    s_lshl_b32 s30, s33, 7
    s_add_u32 s30, s30, 19136512
    s_cmp_eq_u32 s3, 0
    s_cselect_b32 s30, s30, 33554432
    s_waitcnt vmcnt(10)
    s_waitcnt lgkmcnt(0)
    s_barrier
    s_mov_b64 exec, 0xff
    buffer_store_dwordx2 v[202:203], v183, s[20:23], s30 offen sc1
    s_mov_b64 exec, -1
    buffer_store_dwordx4 v[190:193], v182, s[20:23], s34 offen sc1
    buffer_store_dwordx4 v[194:197], v182, s[20:23], s39 offen sc1
    buffer_store_dwordx4 v[198:201], v182, s[20:23], s48 offen sc1
    buffer_load_dwordx2 v[208:209], v207, s[44:47], 0 offen sc1
    s_add_u32 m0, s27, 49152
    s_nop 0
    buffer_load_dwordx4 v6, s[16:19], s25 offen lds
    s_add_u32 m0, s26, 12288
    s_nop 0
    buffer_load_dwordx4 v2, s[12:15], s24 offen lds
    s_add_u32 m0, s27, 50176
    s_nop 0
    buffer_load_dwordx4 v7, s[16:19], s25 offen lds
    s_add_u32 m0, s26, 13312
    s_nop 0
    buffer_load_dwordx4 v3, s[12:15], s24 offen lds
    s_add_u32 m0, s27, 51200
    s_nop 0
    buffer_load_dwordx4 v8, s[16:19], s25 offen lds
    s_add_u32 m0, s26, 14336
    s_nop 0
    buffer_load_dwordx4 v4, s[12:15], s24 offen lds
    s_add_u32 m0, s27, 52224
    s_nop 0
    buffer_load_dwordx4 v9, s[16:19], s25 offen lds
    s_add_u32 m0, s26, 15360
    s_nop 0
    buffer_load_dwordx4 v5, s[12:15], s24 offen lds
    s_add_u32 s24, s24, 128
    s_add_u32 s25, s25, 245760
    s_waitcnt vmcnt(13)
    s_barrier
    s_add_u32 m0, s27, 0
    s_nop 0
    buffer_load_dwordx4 v6, s[16:19], s25 offen lds
    s_add_u32 m0, s26, 0
    s_nop 0
    buffer_load_dwordx4 v2, s[12:15], s24 offen lds
    s_add_u32 m0, s27, 1024
    s_nop 0
    buffer_load_dwordx4 v7, s[16:19], s25 offen lds
    s_add_u32 m0, s26, 1024
    s_nop 0
    buffer_load_dwordx4 v3, s[12:15], s24 offen lds
    s_add_u32 m0, s27, 2048
    s_nop 0
    buffer_load_dwordx4 v8, s[16:19], s25 offen lds
    s_add_u32 m0, s26, 2048
    s_nop 0
    buffer_load_dwordx4 v4, s[12:15], s24 offen lds
    s_add_u32 m0, s27, 3072
    s_nop 0
    buffer_load_dwordx4 v9, s[16:19], s25 offen lds
    s_add_u32 m0, s26, 3072
    s_nop 0
    buffer_load_dwordx4 v5, s[12:15], s24 offen lds
    s_add_u32 s24, s24, 128
    s_add_u32 s25, s25, 245760
    s_waitcnt vmcnt(8)
    s_mov_b32 s36, 0x40000
parallel_sum__mha_block__mixer_token_mlp__prompt_kernel_NL:
    v_readfirstlane_b32 s100, v208
    v_readfirstlane_b32 s101, v209
    s_sub_u32 s36, s36, 1
    s_cbranch_scc1 parallel_sum__mha_block__mixer_token_mlp__prompt_kernel_NX
    s_cmp_lg_u32 s100, 0
    s_cbranch_scc1 parallel_sum__mha_block__mixer_token_mlp__prompt_kernel_NX
    buffer_load_dwordx2 v[208:209], v207, s[44:47], 0 offen sc1
    s_waitcnt vmcnt(0)
    s_branch parallel_sum__mha_block__mixer_token_mlp__prompt_kernel_NL
parallel_sum__mha_block__mixer_token_mlp__prompt_kernel_NX:
    ds_write_b64 v205, v[208:209] offset:32
    s_barrier
    s_lshl_b32 s28, s33, 7
    s_add_u32 s28, s28, 18874368
    s_cmp_eq_u32 s3, 0
    s_cselect_b32 s30, s28, 33554432
    s_mov_b64 exec, 1
    buffer_store_dwordx2 v[208:209], v207, s[20:23], s30 offen sc1
    s_mov_b64 exec, -1
    s_add_u32 m0, s27, 16384
    s_nop 0
    buffer_load_dwordx4 v6, s[16:19], s25 offen lds
    s_add_u32 m0, s26, 4096
    s_nop 0
    buffer_load_dwordx4 v2, s[12:15], s24 offen lds
    s_add_u32 m0, s27, 17408
    s_nop 0
    buffer_load_dwordx4 v7, s[16:19], s25 offen lds
    s_add_u32 m0, s26, 5120
    s_nop 0
    buffer_load_dwordx4 v3, s[12:15], s24 offen lds
    s_add_u32 m0, s27, 18432
    s_nop 0
    buffer_load_dwordx4 v8, s[16:19], s25 offen lds
    s_add_u32 m0, s26, 6144
    s_nop 0
    buffer_load_dwordx4 v4, s[12:15], s24 offen lds
    s_add_u32 m0, s27, 19456
    s_nop 0
    buffer_load_dwordx4 v9, s[16:19], s25 offen lds
    s_add_u32 m0, s26, 7168
    s_nop 0
    buffer_load_dwordx4 v5, s[12:15], s24 offen lds
    s_add_u32 s24, s24, 128
    s_add_u32 s25, s25, 245760
    s_waitcnt vmcnt(9)
    s_barrier
    s_add_u32 m0, s27, 32768
    s_nop 0
    buffer_load_dwordx4 v6, s[16:19], s25 offen lds
    s_add_u32 m0, s26, 8192
    s_nop 0
    buffer_load_dwordx4 v2, s[12:15], s24 offen lds
    s_add_u32 m0, s27, 33792
    s_nop 0
    buffer_load_dwordx4 v7, s[16:19], s25 offen lds
    s_add_u32 m0, s26, 9216
    s_nop 0
    buffer_load_dwordx4 v3, s[12:15], s24 offen lds
    s_add_u32 m0, s27, 34816
    s_nop 0
    buffer_load_dwordx4 v8, s[16:19], s25 offen lds
    s_add_u32 m0, s26, 10240
    s_nop 0
    buffer_load_dwordx4 v4, s[12:15], s24 offen lds
    s_add_u32 m0, s27, 35840
    s_nop 0
    buffer_load_dwordx4 v9, s[16:19], s25 offen lds
    s_add_u32 m0, s26, 11264
    s_nop 0
    buffer_load_dwordx4 v5, s[12:15], s24 offen lds
    s_add_u32 s24, s24, 128
    s_add_u32 s25, s25, 245760
    s_waitcnt vmcnt(8)
    s_barrier
    s_add_u32 m0, s27, 49152
    s_nop 0
    buffer_load_dwordx4 v6, s[16:19], s25 offen lds
    s_add_u32 m0, s26, 12288
    s_nop 0
    buffer_load_dwordx4 v2, s[12:15], s24 offen lds
    s_add_u32 m0, s27, 50176
    s_nop 0
    buffer_load_dwordx4 v7, s[16:19], s25 offen lds
    s_add_u32 m0, s26, 13312
    s_nop 0
    buffer_load_dwordx4 v3, s[12:15], s24 offen lds
    s_add_u32 m0, s27, 51200
    s_nop 0
    buffer_load_dwordx4 v8, s[16:19], s25 offen lds
    s_add_u32 m0, s26, 14336
    s_nop 0
    buffer_load_dwordx4 v4, s[12:15], s24 offen lds
    s_add_u32 m0, s27, 52224
    s_nop 0
    buffer_load_dwordx4 v9, s[16:19], s25 offen lds
    s_add_u32 m0, s26, 15360
    s_nop 0
    buffer_load_dwordx4 v5, s[12:15], s24 offen lds
    s_add_u32 s24, s24, 128
    s_add_u32 s25, s25, 245760
    v_lshlrev_b32 v194, 7, v1
    v_and_b32 v195, 1920, v194
    v_and_b32 v194, 384, v194
    s_lshl_b32 s34, s10, 11
    s_add_u32 s34, s34, 18874368
    s_lshl_b32 s39, s3, 9
    s_add_u32 s39, s39, 18907136
    v_lshrrev_b32 v183, 3, v184
    v_lshlrev_b32 v183, 7, v183
    v_and_b32 v180, 7, v184
    v_lshl_add_u32 v183, v180, 3, v183
    s_mov_b64 exec, 0xffff
    buffer_load_dwordx2 v[210:211], v195, s[20:23], s34 offen sc1
    s_mov_b64 exec, -1
    s_waitcnt vmcnt(9)
    s_barrier
    s_add_u32 m0, s27, 0
    s_nop 0
    buffer_load_dwordx4 v6, s[16:19], s25 offen lds
    s_add_u32 m0, s26, 0
    s_nop 0
    buffer_load_dwordx4 v2, s[12:15], s24 offen lds
    s_add_u32 m0, s27, 1024
    s_nop 0
    buffer_load_dwordx4 v7, s[16:19], s25 offen lds
    s_add_u32 m0, s26, 1024
    s_nop 0
    buffer_load_dwordx4 v3, s[12:15], s24 offen lds
    s_add_u32 m0, s27, 2048
    s_nop 0
    buffer_load_dwordx4 v8, s[16:19], s25 offen lds
    s_add_u32 m0, s26, 2048
    s_nop 0
    buffer_load_dwordx4 v4, s[12:15], s24 offen lds
    s_add_u32 m0, s27, 3072
    s_nop 0
    buffer_load_dwordx4 v9, s[16:19], s25 offen lds
    s_add_u32 m0, s26, 3072
    s_nop 0
    buffer_load_dwordx4 v5, s[12:15], s24 offen lds
    s_add_u32 s24, s24, 128
    s_add_u32 s25, s25, 245760
    s_waitcnt vmcnt(9)
    s_waitcnt vmcnt(8)
    s_mov_b32 s36, 0x40000
    s_mov_b32 exec_lo, 65535
    s_mov_b32 exec_hi, 0
    s_branch parallel_sum__mha_block__mixer_token_mlp__prompt_kernel_PSC
parallel_sum__mha_block__mixer_token_mlp__prompt_kernel_PSL:
    buffer_load_dwordx2 v[210:211], v195, s[20:23], s34 offen sc1
    s_waitcnt vmcnt(0)
parallel_sum__mha_block__mixer_token_mlp__prompt_kernel_PSC:
    v_cmp_ne_u64 vcc, s[100:101], v[210:211]
    s_sub_u32 s36, s36, 1
    s_cbranch_scc1 parallel_sum__mha_block__mixer_token_mlp__prompt_kernel_PSX
    s_nop 2
    s_cbranch_vccz parallel_sum__mha_block__mixer_token_mlp__prompt_kernel_PSX
    s_sleep 2
    s_branch parallel_sum__mha_block__mixer_token_mlp__prompt_kernel_PSL
parallel_sum__mha_block__mixer_token_mlp__prompt_kernel_PSX:
    s_mov_b64 exec, -1
    buffer_load_dwordx2 v[198:199], v183, s[20:23], s38 offen sc1
    s_lshl_b32 s28, s10, 7
    s_add_u32 s28, s28, 18907136
    s_or_b32 s29, s11, s3
    s_cselect_b32 s28, 33554432, s28
    s_mov_b64 exec, 1
    buffer_store_dwordx2 v[208:209], v207, s[20:23], s28 offen sc1
    s_mov_b64 exec, -1
    s_barrier
    s_add_u32 m0, s27, 16384
    s_nop 0
    buffer_load_dwordx4 v6, s[16:19], s25 offen lds
    s_add_u32 m0, s26, 4096
    s_nop 0
    buffer_load_dwordx4 v2, s[12:15], s24 offen lds
    s_add_u32 m0, s27, 17408
    s_nop 0
    buffer_load_dwordx4 v7, s[16:19], s25 offen lds
    s_add_u32 m0, s26, 5120
    s_nop 0
    buffer_load_dwordx4 v3, s[12:15], s24 offen lds
    s_add_u32 m0, s27, 18432
    s_nop 0
    buffer_load_dwordx4 v8, s[16:19], s25 offen lds
    s_add_u32 m0, s26, 6144
    s_nop 0
    buffer_load_dwordx4 v4, s[12:15], s24 offen lds
    s_add_u32 m0, s27, 19456
    s_nop 0
    buffer_load_dwordx4 v9, s[16:19], s25 offen lds
    s_add_u32 m0, s26, 7168
    s_nop 0
    buffer_load_dwordx4 v5, s[12:15], s24 offen lds
    s_add_u32 s24, s24, 128
    s_add_u32 s25, s25, 245760
    s_mov_b64 exec, 0xf
    buffer_load_dwordx2 v[212:213], v194, s[20:23], s39 offen sc1
    s_mov_b64 exec, -1
    s_mov_b32 s52, s72
    s_and_b32 s53, s73, 0xffff
    s_mov_b32 s54, 6291456
    s_mov_b32 s55, 0x20000
    s_lshr_b32 s60, s2, 3
    s_bfe_u32 s63, s2, 0x20001
    s_lshl_b32 s61, s3, 6
    s_add_u32 s60, s60, s61
    s_mul_i32 s60, s60, 24576
    s_mul_i32 s63, s63, 768
    s_add_u32 s60, s60, s63
    s_add_u32 s61, s60, 786432
    v_lshrrev_b32 v172, 3, v1
    v_and_b32 v173, 7, v1
    v_mul_u32_u24 v172, 3072, v172
    v_lshl_add_u32 v172, v173, 7, v172
    s_mov_b32 exec_lo, 0x3f3f3f3f
    s_mov_b32 exec_hi, 1061109567
    buffer_load_dword v244, v172, s[52:55], s60 offen
    s_mov_b64 exec, -1
    s_waitcnt vmcnt(12)
    s_barrier
    s_waitcnt vmcnt(2)
    s_barrier
    s_lshl_b32 s28, s3, 8
    s_add_u32 s28, s28, 131584
    v_lshl_add_u32 v180, v184, 2, s28
    ds_write2_b32 v180, v198, v199 offset0:0 offset1:32
    s_mov_b32 s49, s39
    s_waitcnt lgkmcnt(0)
    s_barrier
    s_branch parallel_sum__mha_block__mixer_token_mlp__prompt_kernel_G
parallel_sum__mha_block__mixer_token_mlp__prompt_kernel_C:
    v_and_b32 v212, 31, v1
    v_lshrrev_b32 v213, 5, v1
    v_mul_u32_u24 v208, 1280, v213
    v_lshl_add_u32 v214, v212, 3, v208
    s_lshl_b32 s28, s10, 7
    s_lshl_b32 s29, s11, 3
    s_add_u32 s29, s29, s28
    s_lshl_b32 s30, s3, 1
    s_add_u32 s29, s29, s30
    s_mul_i32 s29, s29, 1280
    s_waitcnt lgkmcnt(0)
    s_mov_b32 s12, s4
    s_and_b32 s13, s5, 0xffff
    s_mov_b32 s14, 2621440
    s_mov_b32 s15, 0x20000
    buffer_load_dwordx2 v[48:49], v214, s[12:15], s29 offen offset:0
    buffer_load_dwordx2 v[50:51], v214, s[12:15], s29 offen offset:256
    buffer_load_dwordx2 v[52:53], v214, s[12:15], s29 offen offset:512
    buffer_load_dwordx2 v[54:55], v214, s[12:15], s29 offen offset:768
    buffer_load_dwordx2 v[56:57], v214, s[12:15], s29 offen offset:1024
    s_mov_b32 s20, s42
    s_and_b32 s21, s43, 0xffff
    s_mov_b32 s22, 33554432
    s_mov_b32 s23, 0x20000
    s_cmp_ge_u32 s11, 11
    s_cselect_b64 vcc, -1, 0
    v_and_b32 v14, 3, v1
    v_bfrev_b32 v15, v14
    v_lshrrev_b32 v15, 30, v15
    v_cndmask_b32 v15, v15, v14, vcc
    v_bfe_u32 v16, v1, 2, 2
    v_bfrev_b32 v17, v16
    v_lshrrev_b32 v17, 30, v17
    v_mov_b32 v17, v16
    v_lshl_add_u32 v17, v17, 2, v14
    v_lshrrev_b32 v18, 4, v1
    v_lshrrev_b32 v208, 1, v17
    v_xor_b32 v208, v208, v18
    v_lshlrev_b32 v209, 7, v17
    v_add_u32 v209, s26, v209
    v_lshl_add_u32 v2, v208, 4, v209
    v_xor_b32 v3, 64, v2
    v_lshl_add_u32 v209, v18, 3, v16
    v_lshlrev_b32 v209, 8, v209
    v_and_b32 v210, 1, v18
    v_lshl_add_u32 v210, v16, 1, v210
    v_lshl_add_u32 v211, v15, 3, v209
    v_xor_b32 v4, 0, v210
    v_lshl_add_u32 v4, v4, 5, v211
    v_xor_b32 v5, 1, v210
    v_lshl_add_u32 v5, v5, 5, v211
    v_xor_b32 v6, 2, v210
    v_lshl_add_u32 v6, v6, 5, v211
    v_xor_b32 v7, 3, v210
    v_lshl_add_u32 v7, v7, 5, v211
    v_xor_b32 v8, 4, v210
    v_lshl_add_u32 v8, v8, 5, v211
    v_xor_b32 v9, 5, v210
    v_lshl_add_u32 v9, v9, 5, v211
    v_xor_b32 v10, 6, v210
    v_lshl_add_u32 v10, v10, 5, v211
    v_xor_b32 v11, 7, v210
    v_lshl_add_u32 v11, v11, 5, v211
    v_lshl_add_u32 v211, v14, 3, v209
    s_lshl_b32 s28, s3, 1
    v_xor_b32 v210, s28, v210
    v_lshl_add_u32 v12, v210, 5, v211
    v_xor_b32 v13, 32, v12
    v_and_b32 v208, 15, v1
    v_cmp_eq_u32 vcc, 0, v208
    v_mov_b32 v210, 0x3f803f80
    v_mov_b32 v24, 0
    v_mov_b32 v25, 0
    v_mov_b32 v26, 0
    v_mov_b32 v27, 0
    v_cndmask_b32 v20, 0, v210, vcc
    v_mov_b32 v21, v20
    v_mov_b32 v22, v20
    v_mov_b32 v23, v20
    v_mov_b32 v32, 0
    v_mov_b32 v33, 0
    v_mov_b32 v34, 0
    v_mov_b32 v35, 0
    v_mfma_f32_32x32x16_bf16 v[144:159], v[24:27], v[24:27], 0
    v_mfma_f32_32x32x16_bf16 v[160:175], v[24:27], v[24:27], 0
    v_mfma_f32_32x32x16_bf16 v[176:191], v[24:27], v[24:27], 0
    v_mfma_f32_32x32x16_bf16 v[192:207], v[24:27], v[24:27], 0
    s_mul_i32 s28, s3, 2560
    s_add_u32 s28, s28, 132672
    v_add_u32 v208, s28, v214
    s_lshl_b32 s28, s3, 4
    s_add_u32 s28, s28, 132608
    v_lshl_add_u32 v209, v213, 3, s28
    s_mov_b32 s31, 0x3000
    s_waitcnt vmcnt(0)
    v_lshlrev_b32 v60, 16, v48
    v_and_b32 v61, 0xffff0000, v48
    v_lshlrev_b32 v62, 16, v49
    v_and_b32 v63, 0xffff0000, v49
    v_lshlrev_b32 v64, 16, v50
    v_and_b32 v65, 0xffff0000, v50
    v_lshlrev_b32 v66, 16, v51
    v_and_b32 v67, 0xffff0000, v51
    v_lshlrev_b32 v68, 16, v52
    v_and_b32 v69, 0xffff0000, v52
    v_lshlrev_b32 v70, 16, v53
    v_and_b32 v71, 0xffff0000, v53
    v_lshlrev_b32 v72, 16, v54
    v_and_b32 v73, 0xffff0000, v54
    v_lshlrev_b32 v74, 16, v55
    v_and_b32 v75, 0xffff0000, v55
    v_lshlrev_b32 v76, 16, v56
    v_and_b32 v77, 0xffff0000, v56
    v_lshlrev_b32 v78, 16, v57
    v_and_b32 v79, 0xffff0000, v57
    v_pk_add_f32 v[80:81], v[60:61], v[62:63]
    v_pk_add_f32 v[82:83], v[64:65], v[66:67]
    v_pk_add_f32 v[80:81], v[80:81], v[68:69]
    v_pk_add_f32 v[82:83], v[82:83], v[70:71]
    v_pk_add_f32 v[80:81], v[80:81], v[72:73]
    v_pk_add_f32 v[82:83], v[82:83], v[74:75]
    v_pk_add_f32 v[80:81], v[80:81], v[76:77]
    v_pk_add_f32 v[82:83], v[82:83], v[78:79]
    v_pk_add_f32 v[80:81], v[80:81], v[82:83]
    v_add_f32 v80, v80, v81
    s_nop 1
    v_add_f32_dpp v80, v80, v80 row_ror:8 row_mask:0xf bank_mask:0xf
    s_nop 1
    v_add_f32_dpp v80, v80, v80 row_ror:4 row_mask:0xf bank_mask:0xf
    s_nop 1
    v_add_f32_dpp v80, v80, v80 row_ror:2 row_mask:0xf bank_mask:0xf
    s_nop 1
    v_add_f32_dpp v80, v80, v80 row_ror:1 row_mask:0xf bank_mask:0xf
    v_mov_b32 v82, v80
    s_nop 1
    v_permlane16_swap_b32 v80, v82
    v_add_f32 v80, v80, v82
    v_mul_f32 v80, 0x3acccccd, v80
    v_mov_b32 v81, v80
    v_pk_add_f32 v[60:61], v[60:61], v[80:81] neg_lo:[0,1] neg_hi:[0,1]
    v_pk_add_f32 v[62:63], v[62:63], v[80:81] neg_lo:[0,1] neg_hi:[0,1]
    v_pk_add_f32 v[64:65], v[64:65], v[80:81] neg_lo:[0,1] neg_hi:[0,1]
    v_pk_add_f32 v[66:67], v[66:67], v[80:81] neg_lo:[0,1] neg_hi:[0,1]
    v_pk_add_f32 v[68:69], v[68:69], v[80:81] neg_lo:[0,1] neg_hi:[0,1]
    v_pk_add_f32 v[70:71], v[70:71], v[80:81] neg_lo:[0,1] neg_hi:[0,1]
    v_pk_add_f32 v[72:73], v[72:73], v[80:81] neg_lo:[0,1] neg_hi:[0,1]
    v_pk_add_f32 v[74:75], v[74:75], v[80:81] neg_lo:[0,1] neg_hi:[0,1]
    v_pk_add_f32 v[76:77], v[76:77], v[80:81] neg_lo:[0,1] neg_hi:[0,1]
    v_pk_add_f32 v[78:79], v[78:79], v[80:81] neg_lo:[0,1] neg_hi:[0,1]
    v_pk_mul_f32 v[82:83], v[60:61], v[60:61]
    v_pk_mul_f32 v[84:85], v[62:63], v[62:63]
    v_pk_fma_f32 v[82:83], v[64:65], v[64:65], v[82:83]
    v_pk_fma_f32 v[84:85], v[66:67], v[66:67], v[84:85]
    v_pk_fma_f32 v[82:83], v[68:69], v[68:69], v[82:83]
    v_pk_fma_f32 v[84:85], v[70:71], v[70:71], v[84:85]
    v_pk_fma_f32 v[82:83], v[72:73], v[72:73], v[82:83]
    v_pk_fma_f32 v[84:85], v[74:75], v[74:75], v[84:85]
    v_pk_fma_f32 v[82:83], v[76:77], v[76:77], v[82:83]
    v_pk_fma_f32 v[84:85], v[78:79], v[78:79], v[84:85]
    v_pk_add_f32 v[82:83], v[82:83], v[84:85]
    v_add_f32 v82, v82, v83
    s_nop 1
    v_add_f32_dpp v82, v82, v82 row_ror:8 row_mask:0xf bank_mask:0xf
    s_nop 1
    v_add_f32_dpp v82, v82, v82 row_ror:4 row_mask:0xf bank_mask:0xf
    s_nop 1
    v_add_f32_dpp v82, v82, v82 row_ror:2 row_mask:0xf bank_mask:0xf
    s_nop 1
    v_add_f32_dpp v82, v82, v82 row_ror:1 row_mask:0xf bank_mask:0xf
    v_mov_b32 v84, v82
    s_nop 1
    v_permlane16_swap_b32 v82, v84
    v_add_f32 v82, v82, v84
    v_mul_f32 v88, 0x3acccccd, v82
    v_cvt_pk_bf16_f32 v87, v80, v88
    v_lshlrev_b32 v86, 16, v87
    v_and_b32 v87, 0xffff0000, v87
    v_add_f32 v87, 0x3727c5ac, v87
    v_cvt_pk_bf16_f32 v87, v87, v87
    v_and_b32 v87, 0xffff0000, v87
    v_sqrt_f32 v87, v87
    v_sub_f32 v89, v80, v86
    v_cvt_pk_bf16_f32 v87, v87, v87
    v_and_b32 v87, 0xffff0000, v87
    v_rcp_f32 v87, v87
    s_nop 0
    v_mul_f32 v89, v89, v87
    v_mul_f32 v88, v88, v87
    v_mul_f32 v88, v88, v87
    v_cvt_pk_bf16_f32 v82, v89, v88
    v_lshlrev_b32 v80, 16, v82
    v_and_b32 v82, 0xffff0000, v82
    v_add_f32 v82, 0x3727c5ac, v82
    v_cvt_pk_bf16_f32 v82, v82, v82
    v_and_b32 v82, 0xffff0000, v82
    v_sqrt_f32 v82, v82
    v_sub_f32 v89, v89, v80
    v_cvt_pk_bf16_f32 v82, v82, v82
    v_and_b32 v82, 0xffff0000, v82
    v_rcp_f32 v82, v82
    ds_write_b64 v209, v[86:87]
    v_mul_f32 v80, v89, v82
    v_mul_f32 v82, v82, v87
    v_mov_b32 v81, v80
    v_mov_b32 v83, v82
    v_pk_fma_f32 v[60:61], v[60:61], v[82:83], v[80:81]
    v_pk_fma_f32 v[62:63], v[62:63], v[82:83], v[80:81]
    v_pk_fma_f32 v[64:65], v[64:65], v[82:83], v[80:81]
    v_pk_fma_f32 v[66:67], v[66:67], v[82:83], v[80:81]
    v_pk_fma_f32 v[68:69], v[68:69], v[82:83], v[80:81]
    v_pk_fma_f32 v[70:71], v[70:71], v[82:83], v[80:81]
    v_pk_fma_f32 v[72:73], v[72:73], v[82:83], v[80:81]
    v_pk_fma_f32 v[74:75], v[74:75], v[82:83], v[80:81]
    v_pk_fma_f32 v[76:77], v[76:77], v[82:83], v[80:81]
    v_pk_fma_f32 v[78:79], v[78:79], v[82:83], v[80:81]
    v_cvt_pk_bf16_f32 v48, v60, v61
    v_cvt_pk_bf16_f32 v49, v62, v63
    v_cvt_pk_bf16_f32 v50, v64, v65
    v_cvt_pk_bf16_f32 v51, v66, v67
    v_cvt_pk_bf16_f32 v52, v68, v69
    v_cvt_pk_bf16_f32 v53, v70, v71
    v_cvt_pk_bf16_f32 v54, v72, v73
    v_cvt_pk_bf16_f32 v55, v74, v75
    v_cvt_pk_bf16_f32 v56, v76, v77
    v_cvt_pk_bf16_f32 v57, v78, v79
    ds_write_b64 v208, v[48:49] offset:0
    ds_write_b64 v208, v[50:51] offset:256
    ds_write_b64 v208, v[52:53] offset:512
    ds_write_b64 v208, v[54:55] offset:768
    ds_write_b64 v208, v[56:57] offset:1024
    s_waitcnt lgkmcnt(0)
    s_cmp_ge_u32 s11, 11
    s_cbranch_scc1 parallel_sum__mha_block__mixer_token_mlp__prompt_kernel_V
    s_barrier
    ds_read_b128 v[48:51], v2 offset:0
    ds_read_b128 v[52:55], v2 offset:2048
    ds_read_b64_tr_b16 v[56:57], v4 offset:0
    ds_read_b64_tr_b16 v[58:59], v4 offset:1024
    ds_read_b64_tr_b16 v[60:61], v5 offset:0
    ds_read_b64_tr_b16 v[62:63], v5 offset:1024
    ds_read_b64_tr_b16 v[64:65], v6 offset:0
    ds_read_b64_tr_b16 v[66:67], v6 offset:1024
    ds_read_b64_tr_b16 v[68:69], v7 offset:0
    ds_read_b64_tr_b16 v[70:71], v7 offset:1024
    ds_read_b64_tr_b16 v[72:73], v8 offset:0
    ds_read_b64_tr_b16 v[74:75], v8 offset:1024
    ds_read_b64_tr_b16 v[76:77], v9 offset:0
    ds_read_b64_tr_b16 v[78:79], v9 offset:1024
    ds_read_b64_tr_b16 v[80:81], v10 offset:0
    ds_read_b64_tr_b16 v[82:83], v10 offset:1024
    ds_read_b64_tr_b16 v[84:85], v11 offset:0
    ds_read_b64_tr_b16 v[86:87], v11 offset:1024
    ds_read_b64_tr_b16 v[88:89], v12 offset:0
    ds_read_b64_tr_b16 v[90:91], v12 offset:1024
    ds_read_b64_tr_b16 v[92:93], v13 offset:0
    ds_read_b64_tr_b16 v[94:95], v13 offset:1024
    s_mov_b32 s36, 9
.p2align 3
parallel_sum__mha_block__mixer_token_mlp__prompt_kernel_LQ:
    s_waitcnt lgkmcnt(0)
    v_mfma_f32_16x16x32_bf16 v[144:147], v[56:59], v[48:51], v[144:147]
    ds_read_b128 v[96:99], v3 offset:0
    ds_read_b128 v[100:103], v3 offset:2048
    v_mfma_f32_16x16x32_bf16 v[148:151], v[56:59], v[52:55], v[148:151]
    ds_read_b64_tr_b16 v[104:105], v4 offset:8192
    ds_read_b64_tr_b16 v[106:107], v4 offset:9216
    v_mfma_f32_16x16x32_bf16 v[152:155], v[60:63], v[48:51], v[152:155]
    ds_read_b64_tr_b16 v[108:109], v5 offset:8192
    ds_read_b64_tr_b16 v[110:111], v5 offset:9216
    v_mfma_f32_16x16x32_bf16 v[156:159], v[60:63], v[52:55], v[156:159]
    ds_read_b64_tr_b16 v[112:113], v6 offset:8192
    ds_read_b64_tr_b16 v[114:115], v6 offset:9216
    v_mfma_f32_16x16x32_bf16 v[160:163], v[64:67], v[48:51], v[160:163]
    ds_read_b64_tr_b16 v[116:117], v7 offset:8192
    ds_read_b64_tr_b16 v[118:119], v7 offset:9216
    v_mfma_f32_16x16x32_bf16 v[164:167], v[64:67], v[52:55], v[164:167]
    ds_read_b64_tr_b16 v[120:121], v8 offset:8192
    ds_read_b64_tr_b16 v[122:123], v8 offset:9216
    v_mfma_f32_16x16x32_bf16 v[168:171], v[68:71], v[48:51], v[168:171]
    ds_read_b64_tr_b16 v[124:125], v9 offset:8192
    ds_read_b64_tr_b16 v[126:127], v9 offset:9216
    v_mfma_f32_16x16x32_bf16 v[172:175], v[68:71], v[52:55], v[172:175]
    ds_read_b64_tr_b16 v[128:129], v10 offset:8192
    ds_read_b64_tr_b16 v[130:131], v10 offset:9216
    v_mfma_f32_16x16x32_bf16 v[176:179], v[72:75], v[48:51], v[176:179]
    ds_read_b64_tr_b16 v[132:133], v11 offset:8192
    ds_read_b64_tr_b16 v[134:135], v11 offset:9216
    v_mfma_f32_16x16x32_bf16 v[180:183], v[72:75], v[52:55], v[180:183]
    ds_read_b64_tr_b16 v[136:137], v12 offset:8192
    ds_read_b64_tr_b16 v[138:139], v12 offset:9216
    v_mfma_f32_16x16x32_bf16 v[184:187], v[76:79], v[48:51], v[184:187]
    ds_read_b64_tr_b16 v[140:141], v13 offset:8192
    ds_read_b64_tr_b16 v[142:143], v13 offset:9216
    v_mfma_f32_16x16x32_bf16 v[188:191], v[76:79], v[52:55], v[188:191]
    v_add_u32 v208, 0x1000, v2
    v_bfi_b32 v2, s31, v208, v2
    v_mfma_f32_16x16x32_bf16 v[192:195], v[80:83], v[48:51], v[192:195]
    v_add_u32 v208, 0x1000, v3
    v_bfi_b32 v3, s31, v208, v3
    v_mfma_f32_16x16x32_bf16 v[196:199], v[80:83], v[52:55], v[196:199]
    v_add_u16 v4, 0x4000, v4
    v_add_u16 v5, 0x4000, v5
    v_mfma_f32_16x16x32_bf16 v[200:203], v[84:87], v[48:51], v[200:203]
    v_add_u16 v6, 0x4000, v6
    v_add_u16 v7, 0x4000, v7
    v_mfma_f32_16x16x32_bf16 v[204:207], v[84:87], v[52:55], v[204:207]
    v_add_u16 v8, 0x4000, v8
    v_add_u16 v9, 0x4000, v9
    v_mfma_f32_16x16x32_bf16 v[24:27], v[20:23], v[88:91], v[24:27]
    v_add_u16 v10, 0x4000, v10
    v_add_u16 v11, 0x4000, v11
    v_mfma_f32_16x16x32_bf16 v[32:35], v[20:23], v[92:95], v[32:35]
    v_add_u16 v12, 0x4000, v12
    v_add_u16 v13, 0x4000, v13
    s_waitcnt lgkmcnt(0)
    v_mfma_f32_16x16x32_bf16 v[144:147], v[104:107], v[96:99], v[144:147]
    v_mfma_f32_16x16x32_bf16 v[148:151], v[104:107], v[100:103], v[148:151]
    s_cmp_eq_u32 s36, 0
    s_cbranch_scc1 parallel_sum__mha_block__mixer_token_mlp__prompt_kernel_LQ_x
    s_barrier
    s_sub_u32 s36, s36, 1
    v_mfma_f32_16x16x32_bf16 v[152:155], v[108:111], v[96:99], v[152:155]
    ds_read_b128 v[48:51], v2 offset:0
    ds_read_b128 v[52:55], v2 offset:2048
    v_mfma_f32_16x16x32_bf16 v[156:159], v[108:111], v[100:103], v[156:159]
    ds_read_b64_tr_b16 v[56:57], v4 offset:0
    ds_read_b64_tr_b16 v[58:59], v4 offset:1024
    v_mfma_f32_16x16x32_bf16 v[160:163], v[112:115], v[96:99], v[160:163]
    ds_read_b64_tr_b16 v[60:61], v5 offset:0
    ds_read_b64_tr_b16 v[62:63], v5 offset:1024
    v_mfma_f32_16x16x32_bf16 v[164:167], v[112:115], v[100:103], v[164:167]
    ds_read_b64_tr_b16 v[64:65], v6 offset:0
    ds_read_b64_tr_b16 v[66:67], v6 offset:1024
    v_mfma_f32_16x16x32_bf16 v[168:171], v[116:119], v[96:99], v[168:171]
    ds_read_b64_tr_b16 v[68:69], v7 offset:0
    ds_read_b64_tr_b16 v[70:71], v7 offset:1024
    v_mfma_f32_16x16x32_bf16 v[172:175], v[116:119], v[100:103], v[172:175]
    ds_read_b64_tr_b16 v[72:73], v8 offset:0
    ds_read_b64_tr_b16 v[74:75], v8 offset:1024
    v_mfma_f32_16x16x32_bf16 v[176:179], v[120:123], v[96:99], v[176:179]
    ds_read_b64_tr_b16 v[76:77], v9 offset:0
    ds_read_b64_tr_b16 v[78:79], v9 offset:1024
    v_mfma_f32_16x16x32_bf16 v[180:183], v[120:123], v[100:103], v[180:183]
    ds_read_b64_tr_b16 v[80:81], v10 offset:0
    ds_read_b64_tr_b16 v[82:83], v10 offset:1024
    v_mfma_f32_16x16x32_bf16 v[184:187], v[124:127], v[96:99], v[184:187]
    ds_read_b64_tr_b16 v[84:85], v11 offset:0
    ds_read_b64_tr_b16 v[86:87], v11 offset:1024
    v_mfma_f32_16x16x32_bf16 v[188:191], v[124:127], v[100:103], v[188:191]
    ds_read_b64_tr_b16 v[88:89], v12 offset:0
    ds_read_b64_tr_b16 v[90:91], v12 offset:1024
    v_mfma_f32_16x16x32_bf16 v[192:195], v[128:131], v[96:99], v[192:195]
    ds_read_b64_tr_b16 v[92:93], v13 offset:0
    ds_read_b64_tr_b16 v[94:95], v13 offset:1024
    v_mfma_f32_16x16x32_bf16 v[196:199], v[128:131], v[100:103], v[196:199]
    v_mfma_f32_16x16x32_bf16 v[200:203], v[132:135], v[96:99], v[200:203]
    v_mfma_f32_16x16x32_bf16 v[204:207], v[132:135], v[100:103], v[204:207]
    v_mfma_f32_16x16x32_bf16 v[24:27], v[20:23], v[136:139], v[24:27]
    v_mfma_f32_16x16x32_bf16 v[32:35], v[20:23], v[140:143], v[32:35]
    s_branch parallel_sum__mha_block__mixer_token_mlp__prompt_kernel_LQ
parallel_sum__mha_block__mixer_token_mlp__prompt_kernel_LQ_x:
    v_mfma_f32_16x16x32_bf16 v[152:155], v[108:111], v[96:99], v[152:155]
    v_mfma_f32_16x16x32_bf16 v[156:159], v[108:111], v[100:103], v[156:159]
    v_mfma_f32_16x16x32_bf16 v[160:163], v[112:115], v[96:99], v[160:163]
    v_mfma_f32_16x16x32_bf16 v[164:167], v[112:115], v[100:103], v[164:167]
    v_mfma_f32_16x16x32_bf16 v[168:171], v[116:119], v[96:99], v[168:171]
    v_mfma_f32_16x16x32_bf16 v[172:175], v[116:119], v[100:103], v[172:175]
    v_mfma_f32_16x16x32_bf16 v[176:179], v[120:123], v[96:99], v[176:179]
    v_mfma_f32_16x16x32_bf16 v[180:183], v[120:123], v[100:103], v[180:183]
    v_mfma_f32_16x16x32_bf16 v[184:187], v[124:127], v[96:99], v[184:187]
    v_mfma_f32_16x16x32_bf16 v[188:191], v[124:127], v[100:103], v[188:191]
    v_mfma_f32_16x16x32_bf16 v[192:195], v[128:131], v[96:99], v[192:195]
    v_mfma_f32_16x16x32_bf16 v[196:199], v[128:131], v[100:103], v[196:199]
    v_mfma_f32_16x16x32_bf16 v[200:203], v[132:135], v[96:99], v[200:203]
    v_mfma_f32_16x16x32_bf16 v[204:207], v[132:135], v[100:103], v[204:207]
    v_mfma_f32_16x16x32_bf16 v[24:27], v[20:23], v[136:139], v[24:27]
    v_mfma_f32_16x16x32_bf16 v[32:35], v[20:23], v[140:143], v[32:35]
    s_lshl_b32 s28, s3, 7
    s_add_u32 s28, s28, 131072
    v_lshl_add_u32 v208, v1, 2, s28
    v_lshlrev_b32 v108, 4, v1
    v_lshlrev_b32 v209, 3, v212
    v_lshl_add_u32 v109, v213, 15, v209
    v_mul_u32_u24 v210, 163840, v213
    v_lshrrev_b32 v118, 1, v212
    v_xor_b32 v118, v118, v212
    v_and_b32 v118, 8, v118
    v_mul_u32_u24 v118, 3, v118
    v_xor_b32 v118, v118, v212
    v_lshlrev_b32 v209, 3, v118
    v_lshlrev_b32 v112, 4, v118
    v_lshl_add_u32 v112, v213, 9, v112
    v_add_u32 v110, v210, v209
    v_lshlrev_b32 v111, 2, v213
    v_add_u32 v111, 159744, v111
    s_lshl_b32 s28, s3, 8
    s_add_u32 s28, s28, 131584
    v_lshl_add_u32 v209, v212, 2, s28
    v_lshlrev_b32 v210, 4, v213
    v_add_u32 v210, 131072, v210
    s_mov_b64 exec, 0xffff
    ds_write2_b32 v208, v24, v32 offset0:0 offset1:16
    s_mov_b64 exec, -1
    v_permlane16_swap_b32 v144, v148
    v_permlane16_swap_b32 v145, v149
    v_permlane16_swap_b32 v146, v150
    v_permlane16_swap_b32 v147, v151
    v_permlane16_swap_b32 v152, v156
    v_permlane16_swap_b32 v153, v157
    v_permlane16_swap_b32 v154, v158
    v_permlane16_swap_b32 v155, v159
    v_permlane16_swap_b32 v160, v164
    v_permlane16_swap_b32 v161, v165
    v_permlane16_swap_b32 v162, v166
    v_permlane16_swap_b32 v163, v167
    v_permlane16_swap_b32 v168, v172
    v_permlane16_swap_b32 v169, v173
    v_permlane16_swap_b32 v170, v174
    v_permlane16_swap_b32 v171, v175
    v_permlane16_swap_b32 v176, v180
    v_permlane16_swap_b32 v177, v181
    v_permlane16_swap_b32 v178, v182
    v_permlane16_swap_b32 v179, v183
    v_permlane16_swap_b32 v184, v188
    v_permlane16_swap_b32 v185, v189
    v_permlane16_swap_b32 v186, v190
    v_permlane16_swap_b32 v187, v191
    v_permlane16_swap_b32 v192, v196
    v_permlane16_swap_b32 v193, v197
    v_permlane16_swap_b32 v194, v198
    v_permlane16_swap_b32 v195, v199
    v_permlane16_swap_b32 v200, v204
    v_permlane16_swap_b32 v201, v205
    v_permlane16_swap_b32 v202, v206
    v_permlane16_swap_b32 v203, v207
    s_waitcnt lgkmcnt(0)
    s_setprio 3
    s_barrier
    v_mov_b32 v138, 159744
    ds_read_b64 v[140:141], v138 offset:32
    ds_read2_b32 v[136:137], v209 offset0:0 offset1:32
    ds_read_b128 v[48:51], v210 offset:0
    ds_read_b128 v[52:55], v210 offset:32
    ds_read_b128 v[56:59], v210 offset:64
    ds_read_b128 v[60:63], v210 offset:96
    ds_read_b128 v[64:67], v210 offset:128
    ds_read_b128 v[68:71], v210 offset:160
    ds_read_b128 v[72:75], v210 offset:192
    ds_read_b128 v[76:79], v210 offset:224
    ds_read_b128 v[80:83], v210 offset:256
    ds_read_b128 v[84:87], v210 offset:288
    ds_read_b128 v[88:91], v210 offset:320
    ds_read_b128 v[92:95], v210 offset:352
    ds_read_b128 v[96:99], v210 offset:384
    ds_read_b128 v[100:103], v210 offset:416
    ds_read_b128 v[104:107], v210 offset:448
    s_mul_i32 s33, s11, 6
    s_lshl_b32 s34, s10, 2
    s_add_u32 s34, s34, s3
    s_waitcnt lgkmcnt(15)
    v_mul_f32 v113, 0x3ea52b5c, v137
    v_mov_b32 v114, v136
    v_mov_b32 v115, v136
    s_add_u32 s28, s33, 0
    s_waitcnt lgkmcnt(10)
    v_pk_fma_f32 v[144:145], v[114:115], v[48:49], v[144:145] neg_lo:[1,0,0] neg_hi:[1,0,0]
    v_pk_fma_f32 v[146:147], v[114:115], v[50:51], v[146:147] neg_lo:[1,0,0] neg_hi:[1,0,0]
    v_pk_fma_f32 v[148:149], v[114:115], v[52:53], v[148:149] neg_lo:[1,0,0] neg_hi:[1,0,0]
    v_pk_fma_f32 v[150:151], v[114:115], v[54:55], v[150:151] neg_lo:[1,0,0] neg_hi:[1,0,0]
    v_pk_fma_f32 v[152:153], v[114:115], v[56:57], v[152:153] neg_lo:[1,0,0] neg_hi:[1,0,0]
    v_pk_fma_f32 v[154:155], v[114:115], v[58:59], v[154:155] neg_lo:[1,0,0] neg_hi:[1,0,0]
    v_pk_fma_f32 v[156:157], v[114:115], v[60:61], v[156:157] neg_lo:[1,0,0] neg_hi:[1,0,0]
    v_pk_fma_f32 v[158:159], v[114:115], v[62:63], v[158:159] neg_lo:[1,0,0] neg_hi:[1,0,0]
    v_pk_fma_f32 v[160:161], v[114:115], v[64:65], v[160:161] neg_lo:[1,0,0] neg_hi:[1,0,0]
    v_pk_fma_f32 v[162:163], v[114:115], v[66:67], v[162:163] neg_lo:[1,0,0] neg_hi:[1,0,0]
    v_pk_mul_f32 v[130:131], v[144:145], v[144:145]
    v_pk_fma_f32 v[130:131], v[146:147], v[146:147], v[130:131]
    v_pk_fma_f32 v[130:131], v[148:149], v[148:149], v[130:131]
    v_pk_fma_f32 v[130:131], v[150:151], v[150:151], v[130:131]
    v_pk_mul_f32 v[132:133], v[156:157], v[156:157]
    v_pk_fma_f32 v[132:133], v[158:159], v[158:159], v[132:133]
    v_pk_fma_f32 v[132:133], v[160:161], v[160:161], v[132:133]
    v_pk_fma_f32 v[132:133], v[162:163], v[162:163], v[132:133]
    v_pk_mul_f32 v[134:135], v[152:153], v[152:153]
    v_pk_fma_f32 v[134:135], v[154:155], v[154:155], v[134:135]
    v_add_f32 v130, v130, v131
    v_add_f32 v132, v132, v133
    v_add_f32 v134, v134, v135
    s_cmp_lt_u32 s28, 32
    s_cselect_b64 vcc, -1, 0
    v_permlane32_swap_b32 v130, v132
    v_cndmask_b32 v116, v137, v113, vcc
    v_cndmask_b32 v117, v137, v113, vcc
    v_add_f32 v130, v130, v132
    v_add_f32 v130, v130, v134
    v_sqrt_f32 v130, v130
    v_pk_mul_f32 v[144:145], v[144:145], v[116:117]
    v_pk_mul_f32 v[146:147], v[146:147], v[116:117]
    v_pk_mul_f32 v[148:149], v[148:149], v[116:117]
    v_pk_mul_f32 v[150:151], v[150:151], v[116:117]
    v_pk_mul_f32 v[152:153], v[152:153], v[116:117]
    v_pk_mul_f32 v[154:155], v[154:155], v[116:117]
    v_pk_mul_f32 v[156:157], v[156:157], v[116:117]
    v_pk_mul_f32 v[158:159], v[158:159], v[116:117]
    v_pk_mul_f32 v[160:161], v[160:161], v[116:117]
    v_pk_mul_f32 v[162:163], v[162:163], v[116:117]
    v_mul_f32 v130, v130, v116
    v_cvt_pk_bf16_f32 v120, v144, v145
    v_cvt_pk_bf16_f32 v121, v146, v147
    v_cvt_pk_bf16_f32 v122, v148, v149
    v_cvt_pk_bf16_f32 v123, v150, v151
    v_cvt_pk_bf16_f32 v124, v156, v157
    v_cvt_pk_bf16_f32 v125, v158, v159
    v_cvt_pk_bf16_f32 v126, v160, v161
    v_cvt_pk_bf16_f32 v127, v162, v163
    v_cvt_pk_bf16_f32 v128, v152, v153
    v_cvt_pk_bf16_f32 v129, v154, v155
    s_cbranch_scc0 parallel_sum__mha_block__mixer_token_mlp__prompt_kernel_p0k
    s_lshl_b32 s29, s28, 6
    s_add_u32 s29, s29, s34
    s_lshl_b32 s30, s29, 10
    s_add_u32 s30, s30, 1048576
    s_add_u32 s31, s30, 65536
    v_mul_f32 v132, 0xbf810000, v130
    v_mov_b32 v133, 0
    buffer_store_dwordx4 v[120:123], v108, s[20:23], s30 offen sc1
    buffer_store_dwordx4 v[124:127], v108, s[20:23], s31 offen sc1
    v_cvt_pk_bf16_f32 v132, v132, v133
    s_lshl_b32 s30, s29, 9
    s_add_u32 s30, s30, 3145728
    buffer_store_dwordx2 v[128:129], v109, s[20:23], s30 offen sc1
    buffer_store_dwordx2 v[132:133], v109, s[20:23], s30 offen offset:256 sc1
    s_branch parallel_sum__mha_block__mixer_token_mlp__prompt_kernel_p0m
parallel_sum__mha_block__mixer_token_mlp__prompt_kernel_p0k:
    s_lshl_b32 s29, s28, 6
    s_add_u32 s29, s29, s34
    s_mul_i32 s30, s29, 2560
    s_add_u32 s30, s30, 4293918720
    s_add_u32 s31, s30, 163840
    buffer_store_dwordx4 v[120:123], v112, s[20:23], s30 offen sc1
    buffer_store_dwordx4 v[124:127], v112, s[20:23], s31 offen sc1
    buffer_store_dwordx2 v[128:129], v110, s[20:23], s30 offen offset:1024 sc1
parallel_sum__mha_block__mixer_token_mlp__prompt_kernel_p0m:
    s_nop 1
    v_max_u32_dpp v130, v130, v130 row_ror:8 row_mask:0xf bank_mask:0xf
    s_nop 1
    v_max_u32_dpp v130, v130, v130 row_ror:4 row_mask:0xf bank_mask:0xf
    s_nop 1
    v_max_u32_dpp v130, v130, v130 row_ror:2 row_mask:0xf bank_mask:0xf
    s_nop 1
    v_max_u32_dpp v130, v130, v130 row_ror:1 row_mask:0xf bank_mask:0xf
    s_mov_b32 exec_lo, 0x10001
    s_mov_b32 exec_hi, 0x10001
    ds_max_u32 v111, v130 offset:56
    s_mov_b64 exec, -1
parallel_sum__mha_block__mixer_token_mlp__prompt_kernel_p0e:
    s_add_u32 s28, s33, 2
    s_waitcnt lgkmcnt(5)
    v_pk_fma_f32 v[164:165], v[114:115], v[68:69], v[164:165] neg_lo:[1,0,0] neg_hi:[1,0,0]
    v_pk_fma_f32 v[166:167], v[114:115], v[70:71], v[166:167] neg_lo:[1,0,0] neg_hi:[1,0,0]
    v_pk_fma_f32 v[168:169], v[114:115], v[72:73], v[168:169] neg_lo:[1,0,0] neg_hi:[1,0,0]
    v_pk_fma_f32 v[170:171], v[114:115], v[74:75], v[170:171] neg_lo:[1,0,0] neg_hi:[1,0,0]
    v_pk_fma_f32 v[172:173], v[114:115], v[76:77], v[172:173] neg_lo:[1,0,0] neg_hi:[1,0,0]
    v_pk_fma_f32 v[174:175], v[114:115], v[78:79], v[174:175] neg_lo:[1,0,0] neg_hi:[1,0,0]
    v_pk_fma_f32 v[176:177], v[114:115], v[80:81], v[176:177] neg_lo:[1,0,0] neg_hi:[1,0,0]
    v_pk_fma_f32 v[178:179], v[114:115], v[82:83], v[178:179] neg_lo:[1,0,0] neg_hi:[1,0,0]
    v_pk_fma_f32 v[180:181], v[114:115], v[84:85], v[180:181] neg_lo:[1,0,0] neg_hi:[1,0,0]
    v_pk_fma_f32 v[182:183], v[114:115], v[86:87], v[182:183] neg_lo:[1,0,0] neg_hi:[1,0,0]
    v_pk_mul_f32 v[130:131], v[164:165], v[164:165]
    v_pk_fma_f32 v[130:131], v[166:167], v[166:167], v[130:131]
    v_pk_fma_f32 v[130:131], v[168:169], v[168:169], v[130:131]
    v_pk_fma_f32 v[130:131], v[170:171], v[170:171], v[130:131]
    v_pk_mul_f32 v[132:133], v[176:177], v[176:177]
    v_pk_fma_f32 v[132:133], v[178:179], v[178:179], v[132:133]
    v_pk_fma_f32 v[132:133], v[180:181], v[180:181], v[132:133]
    v_pk_fma_f32 v[132:133], v[182:183], v[182:183], v[132:133]
    v_pk_mul_f32 v[134:135], v[172:173], v[172:173]
    v_pk_fma_f32 v[134:135], v[174:175], v[174:175], v[134:135]
    v_add_f32 v130, v130, v131
    v_add_f32 v132, v132, v133
    v_add_f32 v134, v134, v135
    s_cmp_lt_u32 s28, 32
    s_cselect_b64 vcc, -1, 0
    v_permlane32_swap_b32 v130, v132
    v_cndmask_b32 v116, v137, v113, vcc
    v_cndmask_b32 v117, v137, v113, vcc
    v_add_f32 v130, v130, v132
    v_add_f32 v130, v130, v134
    v_sqrt_f32 v130, v130
    v_pk_mul_f32 v[164:165], v[164:165], v[116:117]
    v_pk_mul_f32 v[166:167], v[166:167], v[116:117]
    v_pk_mul_f32 v[168:169], v[168:169], v[116:117]
    v_pk_mul_f32 v[170:171], v[170:171], v[116:117]
    v_pk_mul_f32 v[172:173], v[172:173], v[116:117]
    v_pk_mul_f32 v[174:175], v[174:175], v[116:117]
    v_pk_mul_f32 v[176:177], v[176:177], v[116:117]
    v_pk_mul_f32 v[178:179], v[178:179], v[116:117]
    v_pk_mul_f32 v[180:181], v[180:181], v[116:117]
    v_pk_mul_f32 v[182:183], v[182:183], v[116:117]
    v_mul_f32 v130, v130, v116
    v_cvt_pk_bf16_f32 v120, v164, v165
    v_cvt_pk_bf16_f32 v121, v166, v167
    v_cvt_pk_bf16_f32 v122, v168, v169
    v_cvt_pk_bf16_f32 v123, v170, v171
    v_cvt_pk_bf16_f32 v124, v176, v177
    v_cvt_pk_bf16_f32 v125, v178, v179
    v_cvt_pk_bf16_f32 v126, v180, v181
    v_cvt_pk_bf16_f32 v127, v182, v183
    v_cvt_pk_bf16_f32 v128, v172, v173
    v_cvt_pk_bf16_f32 v129, v174, v175
    s_cbranch_scc0 parallel_sum__mha_block__mixer_token_mlp__prompt_kernel_p1k
    s_lshl_b32 s29, s28, 6
    s_add_u32 s29, s29, s34
    s_lshl_b32 s30, s29, 10
    s_add_u32 s30, s30, 1048576
    s_add_u32 s31, s30, 65536
    v_mul_f32 v132, 0xbf810000, v130
    v_mov_b32 v133, 0
    buffer_store_dwordx4 v[120:123], v108, s[20:23], s30 offen sc1
    buffer_store_dwordx4 v[124:127], v108, s[20:23], s31 offen sc1
    v_cvt_pk_bf16_f32 v132, v132, v133
    s_lshl_b32 s30, s29, 9
    s_add_u32 s30, s30, 3145728
    buffer_store_dwordx2 v[128:129], v109, s[20:23], s30 offen sc1
    buffer_store_dwordx2 v[132:133], v109, s[20:23], s30 offen offset:256 sc1
    s_branch parallel_sum__mha_block__mixer_token_mlp__prompt_kernel_p1m
parallel_sum__mha_block__mixer_token_mlp__prompt_kernel_p1k:
    s_lshl_b32 s29, s28, 6
    s_add_u32 s29, s29, s34
    s_mul_i32 s30, s29, 2560
    s_add_u32 s30, s30, 4293918720
    s_add_u32 s31, s30, 163840
    buffer_store_dwordx4 v[120:123], v112, s[20:23], s30 offen sc1
    buffer_store_dwordx4 v[124:127], v112, s[20:23], s31 offen sc1
    buffer_store_dwordx2 v[128:129], v110, s[20:23], s30 offen offset:1024 sc1
parallel_sum__mha_block__mixer_token_mlp__prompt_kernel_p1m:
    s_nop 1
    v_max_u32_dpp v130, v130, v130 row_ror:8 row_mask:0xf bank_mask:0xf
    s_nop 1
    v_max_u32_dpp v130, v130, v130 row_ror:4 row_mask:0xf bank_mask:0xf
    s_nop 1
    v_max_u32_dpp v130, v130, v130 row_ror:2 row_mask:0xf bank_mask:0xf
    s_nop 1
    v_max_u32_dpp v130, v130, v130 row_ror:1 row_mask:0xf bank_mask:0xf
    s_mov_b32 exec_lo, 0x10001
    s_mov_b32 exec_hi, 0x10001
    ds_max_u32 v111, v130 offset:64
    s_mov_b64 exec, -1
parallel_sum__mha_block__mixer_token_mlp__prompt_kernel_p1e:
    s_add_u32 s28, s33, 4
    s_cmp_ge_u32 s28, 64
    s_cbranch_scc1 parallel_sum__mha_block__mixer_token_mlp__prompt_kernel_p2e
    s_waitcnt lgkmcnt(0)
    v_pk_fma_f32 v[184:185], v[114:115], v[88:89], v[184:185] neg_lo:[1,0,0] neg_hi:[1,0,0]
    v_pk_fma_f32 v[186:187], v[114:115], v[90:91], v[186:187] neg_lo:[1,0,0] neg_hi:[1,0,0]
    v_pk_fma_f32 v[188:189], v[114:115], v[92:93], v[188:189] neg_lo:[1,0,0] neg_hi:[1,0,0]
    v_pk_fma_f32 v[190:191], v[114:115], v[94:95], v[190:191] neg_lo:[1,0,0] neg_hi:[1,0,0]
    v_pk_fma_f32 v[192:193], v[114:115], v[96:97], v[192:193] neg_lo:[1,0,0] neg_hi:[1,0,0]
    v_pk_fma_f32 v[194:195], v[114:115], v[98:99], v[194:195] neg_lo:[1,0,0] neg_hi:[1,0,0]
    v_pk_fma_f32 v[196:197], v[114:115], v[100:101], v[196:197] neg_lo:[1,0,0] neg_hi:[1,0,0]
    v_pk_fma_f32 v[198:199], v[114:115], v[102:103], v[198:199] neg_lo:[1,0,0] neg_hi:[1,0,0]
    v_pk_fma_f32 v[200:201], v[114:115], v[104:105], v[200:201] neg_lo:[1,0,0] neg_hi:[1,0,0]
    v_pk_fma_f32 v[202:203], v[114:115], v[106:107], v[202:203] neg_lo:[1,0,0] neg_hi:[1,0,0]
    v_pk_mul_f32 v[130:131], v[184:185], v[184:185]
    v_pk_fma_f32 v[130:131], v[186:187], v[186:187], v[130:131]
    v_pk_fma_f32 v[130:131], v[188:189], v[188:189], v[130:131]
    v_pk_fma_f32 v[130:131], v[190:191], v[190:191], v[130:131]
    v_pk_mul_f32 v[132:133], v[196:197], v[196:197]
    v_pk_fma_f32 v[132:133], v[198:199], v[198:199], v[132:133]
    v_pk_fma_f32 v[132:133], v[200:201], v[200:201], v[132:133]
    v_pk_fma_f32 v[132:133], v[202:203], v[202:203], v[132:133]
    v_pk_mul_f32 v[134:135], v[192:193], v[192:193]
    v_pk_fma_f32 v[134:135], v[194:195], v[194:195], v[134:135]
    v_add_f32 v130, v130, v131
    v_add_f32 v132, v132, v133
    v_add_f32 v134, v134, v135
    s_cmp_lt_u32 s28, 32
    s_cselect_b64 vcc, -1, 0
    v_permlane32_swap_b32 v130, v132
    v_cndmask_b32 v116, v137, v113, vcc
    v_cndmask_b32 v117, v137, v113, vcc
    v_add_f32 v130, v130, v132
    v_add_f32 v130, v130, v134
    v_sqrt_f32 v130, v130
    v_pk_mul_f32 v[184:185], v[184:185], v[116:117]
    v_pk_mul_f32 v[186:187], v[186:187], v[116:117]
    v_pk_mul_f32 v[188:189], v[188:189], v[116:117]
    v_pk_mul_f32 v[190:191], v[190:191], v[116:117]
    v_pk_mul_f32 v[192:193], v[192:193], v[116:117]
    v_pk_mul_f32 v[194:195], v[194:195], v[116:117]
    v_pk_mul_f32 v[196:197], v[196:197], v[116:117]
    v_pk_mul_f32 v[198:199], v[198:199], v[116:117]
    v_pk_mul_f32 v[200:201], v[200:201], v[116:117]
    v_pk_mul_f32 v[202:203], v[202:203], v[116:117]
    v_mul_f32 v130, v130, v116
    v_cvt_pk_bf16_f32 v120, v184, v185
    v_cvt_pk_bf16_f32 v121, v186, v187
    v_cvt_pk_bf16_f32 v122, v188, v189
    v_cvt_pk_bf16_f32 v123, v190, v191
    v_cvt_pk_bf16_f32 v124, v196, v197
    v_cvt_pk_bf16_f32 v125, v198, v199
    v_cvt_pk_bf16_f32 v126, v200, v201
    v_cvt_pk_bf16_f32 v127, v202, v203
    v_cvt_pk_bf16_f32 v128, v192, v193
    v_cvt_pk_bf16_f32 v129, v194, v195
    s_cbranch_scc0 parallel_sum__mha_block__mixer_token_mlp__prompt_kernel_p2k
    s_lshl_b32 s29, s28, 6
    s_add_u32 s29, s29, s34
    s_lshl_b32 s30, s29, 10
    s_add_u32 s30, s30, 1048576
    s_add_u32 s31, s30, 65536
    v_mul_f32 v132, 0xbf810000, v130
    v_mov_b32 v133, 0
    buffer_store_dwordx4 v[120:123], v108, s[20:23], s30 offen sc1
    buffer_store_dwordx4 v[124:127], v108, s[20:23], s31 offen sc1
    v_cvt_pk_bf16_f32 v132, v132, v133
    s_lshl_b32 s30, s29, 9
    s_add_u32 s30, s30, 3145728
    buffer_store_dwordx2 v[128:129], v109, s[20:23], s30 offen sc1
    buffer_store_dwordx2 v[132:133], v109, s[20:23], s30 offen offset:256 sc1
    s_branch parallel_sum__mha_block__mixer_token_mlp__prompt_kernel_p2m
parallel_sum__mha_block__mixer_token_mlp__prompt_kernel_p2k:
    s_lshl_b32 s29, s28, 6
    s_add_u32 s29, s29, s34
    s_mul_i32 s30, s29, 2560
    s_add_u32 s30, s30, 4293918720
    s_add_u32 s31, s30, 163840
    buffer_store_dwordx4 v[120:123], v112, s[20:23], s30 offen sc1
    buffer_store_dwordx4 v[124:127], v112, s[20:23], s31 offen sc1
    buffer_store_dwordx2 v[128:129], v110, s[20:23], s30 offen offset:1024 sc1
parallel_sum__mha_block__mixer_token_mlp__prompt_kernel_p2m:
    s_nop 1
    v_max_u32_dpp v130, v130, v130 row_ror:8 row_mask:0xf bank_mask:0xf
    s_nop 1
    v_max_u32_dpp v130, v130, v130 row_ror:4 row_mask:0xf bank_mask:0xf
    s_nop 1
    v_max_u32_dpp v130, v130, v130 row_ror:2 row_mask:0xf bank_mask:0xf
    s_nop 1
    v_max_u32_dpp v130, v130, v130 row_ror:1 row_mask:0xf bank_mask:0xf
    s_mov_b32 exec_lo, 0x10001
    s_mov_b32 exec_hi, 0x10001
    ds_max_u32 v111, v130 offset:72
    s_mov_b64 exec, -1
parallel_sum__mha_block__mixer_token_mlp__prompt_kernel_p2e:
    s_branch parallel_sum__mha_block__mixer_token_mlp__prompt_kernel_A
parallel_sum__mha_block__mixer_token_mlp__prompt_kernel_V:
    s_barrier
    ds_read_b128 v[48:51], v2 offset:0
    ds_read_b128 v[52:55], v2 offset:2048
    ds_read_b64_tr_b16 v[56:57], v4 offset:0
    ds_read_b64_tr_b16 v[58:59], v4 offset:1024
    ds_read_b64_tr_b16 v[60:61], v5 offset:0
    ds_read_b64_tr_b16 v[62:63], v5 offset:1024
    ds_read_b64_tr_b16 v[64:65], v6 offset:0
    ds_read_b64_tr_b16 v[66:67], v6 offset:1024
    ds_read_b64_tr_b16 v[68:69], v7 offset:0
    ds_read_b64_tr_b16 v[70:71], v7 offset:1024
    ds_read_b64_tr_b16 v[72:73], v8 offset:0
    ds_read_b64_tr_b16 v[74:75], v8 offset:1024
    ds_read_b64_tr_b16 v[76:77], v9 offset:0
    ds_read_b64_tr_b16 v[78:79], v9 offset:1024
    ds_read_b64_tr_b16 v[80:81], v10 offset:0
    ds_read_b64_tr_b16 v[82:83], v10 offset:1024
    ds_read_b64_tr_b16 v[84:85], v11 offset:0
    ds_read_b64_tr_b16 v[86:87], v11 offset:1024
    ds_read_b64_tr_b16 v[88:89], v12 offset:0
    ds_read_b64_tr_b16 v[90:91], v12 offset:1024
    ds_read_b64_tr_b16 v[92:93], v13 offset:0
    ds_read_b64_tr_b16 v[94:95], v13 offset:1024
    s_mov_b32 s36, 9
.p2align 3
parallel_sum__mha_block__mixer_token_mlp__prompt_kernel_LV:
    s_waitcnt lgkmcnt(0)
    v_mfma_f32_16x16x32_bf16 v[144:147], v[48:51], v[56:59], v[144:147]
    ds_read_b128 v[96:99], v3 offset:0
    ds_read_b128 v[100:103], v3 offset:2048
    v_mfma_f32_16x16x32_bf16 v[148:151], v[52:55], v[56:59], v[148:151]
    ds_read_b64_tr_b16 v[104:105], v4 offset:8192
    ds_read_b64_tr_b16 v[106:107], v4 offset:9216
    v_mfma_f32_16x16x32_bf16 v[152:155], v[48:51], v[60:63], v[152:155]
    ds_read_b64_tr_b16 v[108:109], v5 offset:8192
    ds_read_b64_tr_b16 v[110:111], v5 offset:9216
    v_mfma_f32_16x16x32_bf16 v[156:159], v[52:55], v[60:63], v[156:159]
    ds_read_b64_tr_b16 v[112:113], v6 offset:8192
    ds_read_b64_tr_b16 v[114:115], v6 offset:9216
    v_mfma_f32_16x16x32_bf16 v[160:163], v[48:51], v[64:67], v[160:163]
    ds_read_b64_tr_b16 v[116:117], v7 offset:8192
    ds_read_b64_tr_b16 v[118:119], v7 offset:9216
    v_mfma_f32_16x16x32_bf16 v[164:167], v[52:55], v[64:67], v[164:167]
    ds_read_b64_tr_b16 v[120:121], v8 offset:8192
    ds_read_b64_tr_b16 v[122:123], v8 offset:9216
    v_mfma_f32_16x16x32_bf16 v[168:171], v[48:51], v[68:71], v[168:171]
    ds_read_b64_tr_b16 v[124:125], v9 offset:8192
    ds_read_b64_tr_b16 v[126:127], v9 offset:9216
    v_mfma_f32_16x16x32_bf16 v[172:175], v[52:55], v[68:71], v[172:175]
    ds_read_b64_tr_b16 v[128:129], v10 offset:8192
    ds_read_b64_tr_b16 v[130:131], v10 offset:9216
    v_mfma_f32_16x16x32_bf16 v[176:179], v[48:51], v[72:75], v[176:179]
    ds_read_b64_tr_b16 v[132:133], v11 offset:8192
    ds_read_b64_tr_b16 v[134:135], v11 offset:9216
    v_mfma_f32_16x16x32_bf16 v[180:183], v[52:55], v[72:75], v[180:183]
    ds_read_b64_tr_b16 v[136:137], v12 offset:8192
    ds_read_b64_tr_b16 v[138:139], v12 offset:9216
    v_mfma_f32_16x16x32_bf16 v[184:187], v[48:51], v[76:79], v[184:187]
    ds_read_b64_tr_b16 v[140:141], v13 offset:8192
    ds_read_b64_tr_b16 v[142:143], v13 offset:9216
    v_mfma_f32_16x16x32_bf16 v[188:191], v[52:55], v[76:79], v[188:191]
    v_add_u32 v208, 0x1000, v2
    v_bfi_b32 v2, s31, v208, v2
    v_mfma_f32_16x16x32_bf16 v[192:195], v[48:51], v[80:83], v[192:195]
    v_add_u32 v208, 0x1000, v3
    v_bfi_b32 v3, s31, v208, v3
    v_mfma_f32_16x16x32_bf16 v[196:199], v[52:55], v[80:83], v[196:199]
    v_add_u16 v4, 0x4000, v4
    v_add_u16 v5, 0x4000, v5
    v_mfma_f32_16x16x32_bf16 v[200:203], v[48:51], v[84:87], v[200:203]
    v_add_u16 v6, 0x4000, v6
    v_add_u16 v7, 0x4000, v7
    v_mfma_f32_16x16x32_bf16 v[204:207], v[52:55], v[84:87], v[204:207]
    v_add_u16 v8, 0x4000, v8
    v_add_u16 v9, 0x4000, v9
    v_mfma_f32_16x16x32_bf16 v[24:27], v[20:23], v[88:91], v[24:27]
    v_add_u16 v10, 0x4000, v10
    v_add_u16 v11, 0x4000, v11
    v_mfma_f32_16x16x32_bf16 v[32:35], v[20:23], v[92:95], v[32:35]
    v_add_u16 v12, 0x4000, v12
    v_add_u16 v13, 0x4000, v13
    s_waitcnt lgkmcnt(0)
    v_mfma_f32_16x16x32_bf16 v[144:147], v[96:99], v[104:107], v[144:147]
    v_mfma_f32_16x16x32_bf16 v[148:151], v[100:103], v[104:107], v[148:151]
    s_cmp_eq_u32 s36, 0
    s_cbranch_scc1 parallel_sum__mha_block__mixer_token_mlp__prompt_kernel_LV_x
    s_barrier
    s_sub_u32 s36, s36, 1
    v_mfma_f32_16x16x32_bf16 v[152:155], v[96:99], v[108:111], v[152:155]
    ds_read_b128 v[48:51], v2 offset:0
    ds_read_b128 v[52:55], v2 offset:2048
    v_mfma_f32_16x16x32_bf16 v[156:159], v[100:103], v[108:111], v[156:159]
    ds_read_b64_tr_b16 v[56:57], v4 offset:0
    ds_read_b64_tr_b16 v[58:59], v4 offset:1024
    v_mfma_f32_16x16x32_bf16 v[160:163], v[96:99], v[112:115], v[160:163]
    ds_read_b64_tr_b16 v[60:61], v5 offset:0
    ds_read_b64_tr_b16 v[62:63], v5 offset:1024
    v_mfma_f32_16x16x32_bf16 v[164:167], v[100:103], v[112:115], v[164:167]
    ds_read_b64_tr_b16 v[64:65], v6 offset:0
    ds_read_b64_tr_b16 v[66:67], v6 offset:1024
    v_mfma_f32_16x16x32_bf16 v[168:171], v[96:99], v[116:119], v[168:171]
    ds_read_b64_tr_b16 v[68:69], v7 offset:0
    ds_read_b64_tr_b16 v[70:71], v7 offset:1024
    v_mfma_f32_16x16x32_bf16 v[172:175], v[100:103], v[116:119], v[172:175]
    ds_read_b64_tr_b16 v[72:73], v8 offset:0
    ds_read_b64_tr_b16 v[74:75], v8 offset:1024
    v_mfma_f32_16x16x32_bf16 v[176:179], v[96:99], v[120:123], v[176:179]
    ds_read_b64_tr_b16 v[76:77], v9 offset:0
    ds_read_b64_tr_b16 v[78:79], v9 offset:1024
    v_mfma_f32_16x16x32_bf16 v[180:183], v[100:103], v[120:123], v[180:183]
    ds_read_b64_tr_b16 v[80:81], v10 offset:0
    ds_read_b64_tr_b16 v[82:83], v10 offset:1024
    v_mfma_f32_16x16x32_bf16 v[184:187], v[96:99], v[124:127], v[184:187]
    ds_read_b64_tr_b16 v[84:85], v11 offset:0
    ds_read_b64_tr_b16 v[86:87], v11 offset:1024
    v_mfma_f32_16x16x32_bf16 v[188:191], v[100:103], v[124:127], v[188:191]
    ds_read_b64_tr_b16 v[88:89], v12 offset:0
    ds_read_b64_tr_b16 v[90:91], v12 offset:1024
    v_mfma_f32_16x16x32_bf16 v[192:195], v[96:99], v[128:131], v[192:195]
    ds_read_b64_tr_b16 v[92:93], v13 offset:0
    ds_read_b64_tr_b16 v[94:95], v13 offset:1024
    v_mfma_f32_16x16x32_bf16 v[196:199], v[100:103], v[128:131], v[196:199]
    v_mfma_f32_16x16x32_bf16 v[200:203], v[96:99], v[132:135], v[200:203]
    v_mfma_f32_16x16x32_bf16 v[204:207], v[100:103], v[132:135], v[204:207]
    v_mfma_f32_16x16x32_bf16 v[24:27], v[20:23], v[136:139], v[24:27]
    v_mfma_f32_16x16x32_bf16 v[32:35], v[20:23], v[140:143], v[32:35]
    s_branch parallel_sum__mha_block__mixer_token_mlp__prompt_kernel_LV
parallel_sum__mha_block__mixer_token_mlp__prompt_kernel_LV_x:
    v_mfma_f32_16x16x32_bf16 v[152:155], v[96:99], v[108:111], v[152:155]
    v_mfma_f32_16x16x32_bf16 v[156:159], v[100:103], v[108:111], v[156:159]
    v_mfma_f32_16x16x32_bf16 v[160:163], v[96:99], v[112:115], v[160:163]
    v_mfma_f32_16x16x32_bf16 v[164:167], v[100:103], v[112:115], v[164:167]
    v_mfma_f32_16x16x32_bf16 v[168:171], v[96:99], v[116:119], v[168:171]
    v_mfma_f32_16x16x32_bf16 v[172:175], v[100:103], v[116:119], v[172:175]
    v_mfma_f32_16x16x32_bf16 v[176:179], v[96:99], v[120:123], v[176:179]
    v_mfma_f32_16x16x32_bf16 v[180:183], v[100:103], v[120:123], v[180:183]
    v_mfma_f32_16x16x32_bf16 v[184:187], v[96:99], v[124:127], v[184:187]
    v_mfma_f32_16x16x32_bf16 v[188:191], v[100:103], v[124:127], v[188:191]
    v_mfma_f32_16x16x32_bf16 v[192:195], v[96:99], v[128:131], v[192:195]
    v_mfma_f32_16x16x32_bf16 v[196:199], v[100:103], v[128:131], v[196:199]
    v_mfma_f32_16x16x32_bf16 v[200:203], v[96:99], v[132:135], v[200:203]
    v_mfma_f32_16x16x32_bf16 v[204:207], v[100:103], v[132:135], v[204:207]
    v_mfma_f32_16x16x32_bf16 v[24:27], v[20:23], v[136:139], v[24:27]
    v_mfma_f32_16x16x32_bf16 v[32:35], v[20:23], v[140:143], v[32:35]
    s_lshl_b32 s28, s3, 7
    s_add_u32 s28, s28, 131072
    v_lshl_add_u32 v208, v1, 2, s28
    s_sub_u32 s28, s11, 11
    s_lshl_b32 s28, s28, 7
    s_mov_b32 s29, 162560
    v_and_b32 v214, 15, v1
    v_lshrrev_b32 v211, 4, v1
    v_add_u32 v100, s28, v214
    v_mul_u32_u24 v209, 3277, v100
    v_lshrrev_b32 v209, 16, v209
    v_lshrrev_b32 v210, 2, v100
    v_sub_u32 v210, v210, v209
    v_xor_b32 v210, v210, v211
    v_and_b32 v210, 3, v210
    v_mul_lo_u32 v209, v209, s29
    v_lshl_add_u32 v100, v100, 6, v209
    v_lshl_add_u32 v100, v210, 4, v100
    v_add_u32 v101, s28, v214
    v_add_u32 v101, 16, v101
    v_mul_u32_u24 v209, 3277, v101
    v_lshrrev_b32 v209, 16, v209
    v_lshrrev_b32 v210, 2, v101
    v_sub_u32 v210, v210, v209
    v_xor_b32 v210, v210, v211
    v_and_b32 v210, 3, v210
    v_mul_lo_u32 v209, v209, s29
    v_lshl_add_u32 v101, v101, 6, v209
    v_lshl_add_u32 v101, v210, 4, v101
    v_add_u32 v102, s28, v214
    v_add_u32 v102, 32, v102
    v_mul_u32_u24 v209, 3277, v102
    v_lshrrev_b32 v209, 16, v209
    v_lshrrev_b32 v210, 2, v102
    v_sub_u32 v210, v210, v209
    v_xor_b32 v210, v210, v211
    v_and_b32 v210, 3, v210
    v_mul_lo_u32 v209, v209, s29
    v_lshl_add_u32 v102, v102, 6, v209
    v_lshl_add_u32 v102, v210, 4, v102
    v_add_u32 v103, s28, v214
    v_add_u32 v103, 48, v103
    v_mul_u32_u24 v209, 3277, v103
    v_lshrrev_b32 v209, 16, v209
    v_lshrrev_b32 v210, 2, v103
    v_sub_u32 v210, v210, v209
    v_xor_b32 v210, v210, v211
    v_and_b32 v210, 3, v210
    v_mul_lo_u32 v209, v209, s29
    v_lshl_add_u32 v103, v103, 6, v209
    v_lshl_add_u32 v103, v210, 4, v103
    v_add_u32 v104, s28, v214
    v_add_u32 v104, 64, v104
    v_mul_u32_u24 v209, 3277, v104
    v_lshrrev_b32 v209, 16, v209
    v_lshrrev_b32 v210, 2, v104
    v_sub_u32 v210, v210, v209
    v_xor_b32 v210, v210, v211
    v_and_b32 v210, 3, v210
    v_mul_lo_u32 v209, v209, s29
    v_lshl_add_u32 v104, v104, 6, v209
    v_lshl_add_u32 v104, v210, 4, v104
    v_add_u32 v105, s28, v214
    v_add_u32 v105, 80, v105
    v_mul_u32_u24 v209, 3277, v105
    v_lshrrev_b32 v209, 16, v209
    v_lshrrev_b32 v210, 2, v105
    v_sub_u32 v210, v210, v209
    v_xor_b32 v210, v210, v211
    v_and_b32 v210, 3, v210
    v_mul_lo_u32 v209, v209, s29
    v_lshl_add_u32 v105, v105, 6, v209
    v_lshl_add_u32 v105, v210, 4, v105
    v_add_u32 v106, s28, v214
    v_add_u32 v106, 96, v106
    v_mul_u32_u24 v209, 3277, v106
    v_lshrrev_b32 v209, 16, v209
    v_lshrrev_b32 v210, 2, v106
    v_sub_u32 v210, v210, v209
    v_xor_b32 v210, v210, v211
    v_and_b32 v210, 3, v210
    v_mul_lo_u32 v209, v209, s29
    v_lshl_add_u32 v106, v106, 6, v209
    v_lshl_add_u32 v106, v210, 4, v106
    v_add_u32 v107, s28, v214
    v_add_u32 v107, 112, v107
    v_mul_u32_u24 v209, 3277, v107
    v_lshrrev_b32 v209, 16, v209
    v_lshrrev_b32 v210, 2, v107
    v_sub_u32 v210, v210, v209
    v_xor_b32 v210, v210, v211
    v_and_b32 v210, 3, v210
    v_mul_lo_u32 v209, v209, s29
    v_lshl_add_u32 v107, v107, 6, v209
    v_lshl_add_u32 v107, v210, 4, v107
    s_lshl_b32 s28, s3, 8
    s_add_u32 s28, s28, 131584
    v_lshl_add_u32 v209, v211, 4, s28
    v_lshlrev_b32 v210, 2, v214
    v_add_u32 v210, 131072, v210
    s_mov_b64 exec, 0xffff
    ds_write2_b32 v208, v24, v32 offset0:0 offset1:16
    s_mov_b64 exec, -1
    s_waitcnt lgkmcnt(0)
    s_setprio 3
    s_barrier
    v_mov_b32 v138, 159744
    ds_read_b64 v[140:141], v138 offset:32
    ds_read_b32 v64, v210 offset:0
    ds_read_b32 v66, v210 offset:64
    ds_read_b32 v68, v210 offset:128
    ds_read_b32 v70, v210 offset:192
    ds_read_b32 v72, v210 offset:256
    ds_read_b32 v74, v210 offset:320
    ds_read_b32 v76, v210 offset:384
    ds_read_b32 v78, v210 offset:448
    ds_read_b128 v[48:51], v209 offset:0
    ds_read_b128 v[56:59], v209 offset:128
    ds_read_b128 v[52:55], v209 offset:64
    ds_read_b128 v[60:63], v209 offset:192
    s_lshl_b32 s28, s10, 2
    s_add_u32 s28, s28, s3
    s_mul_i32 s28, s28, 2560
    s_add_u32 s28, s28, 4195584
    s_waitcnt lgkmcnt(4)
    v_mov_b32 v65, v64
    v_mov_b32 v67, v66
    v_mov_b32 v69, v68
    v_mov_b32 v71, v70
    v_mov_b32 v73, v72
    v_mov_b32 v75, v74
    v_mov_b32 v77, v76
    v_mov_b32 v79, v78
    s_waitcnt lgkmcnt(0)
    v_pk_fma_f32 v[144:145], v[48:49], v[64:65], v[144:145] neg_lo:[1,0,0] neg_hi:[1,0,0]
    v_pk_fma_f32 v[146:147], v[50:51], v[64:65], v[146:147] neg_lo:[1,0,0] neg_hi:[1,0,0]
    v_pk_fma_f32 v[148:149], v[52:53], v[64:65], v[148:149] neg_lo:[1,0,0] neg_hi:[1,0,0]
    v_pk_fma_f32 v[150:151], v[54:55], v[64:65], v[150:151] neg_lo:[1,0,0] neg_hi:[1,0,0]
    v_pk_mul_f32 v[144:145], v[144:145], v[56:57]
    v_pk_mul_f32 v[146:147], v[146:147], v[58:59]
    v_pk_mul_f32 v[148:149], v[148:149], v[60:61]
    v_pk_mul_f32 v[150:151], v[150:151], v[62:63]
    v_cvt_pk_bf16_f32 v112, v144, v145
    v_cvt_pk_bf16_f32 v113, v146, v147
    v_cvt_pk_bf16_f32 v114, v148, v149
    v_cvt_pk_bf16_f32 v115, v150, v151
    buffer_store_dwordx4 v[112:115], v100, s[20:23], s28 offen sc1
    v_pk_fma_f32 v[152:153], v[48:49], v[66:67], v[152:153] neg_lo:[1,0,0] neg_hi:[1,0,0]
    v_pk_fma_f32 v[154:155], v[50:51], v[66:67], v[154:155] neg_lo:[1,0,0] neg_hi:[1,0,0]
    v_pk_fma_f32 v[156:157], v[52:53], v[66:67], v[156:157] neg_lo:[1,0,0] neg_hi:[1,0,0]
    v_pk_fma_f32 v[158:159], v[54:55], v[66:67], v[158:159] neg_lo:[1,0,0] neg_hi:[1,0,0]
    v_pk_mul_f32 v[152:153], v[152:153], v[56:57]
    v_pk_mul_f32 v[154:155], v[154:155], v[58:59]
    v_pk_mul_f32 v[156:157], v[156:157], v[60:61]
    v_pk_mul_f32 v[158:159], v[158:159], v[62:63]
    v_cvt_pk_bf16_f32 v116, v152, v153
    v_cvt_pk_bf16_f32 v117, v154, v155
    v_cvt_pk_bf16_f32 v118, v156, v157
    v_cvt_pk_bf16_f32 v119, v158, v159
    buffer_store_dwordx4 v[116:119], v101, s[20:23], s28 offen sc1
    v_pk_fma_f32 v[160:161], v[48:49], v[68:69], v[160:161] neg_lo:[1,0,0] neg_hi:[1,0,0]
    v_pk_fma_f32 v[162:163], v[50:51], v[68:69], v[162:163] neg_lo:[1,0,0] neg_hi:[1,0,0]
    v_pk_fma_f32 v[164:165], v[52:53], v[68:69], v[164:165] neg_lo:[1,0,0] neg_hi:[1,0,0]
    v_pk_fma_f32 v[166:167], v[54:55], v[68:69], v[166:167] neg_lo:[1,0,0] neg_hi:[1,0,0]
    v_pk_mul_f32 v[160:161], v[160:161], v[56:57]
    v_pk_mul_f32 v[162:163], v[162:163], v[58:59]
    v_pk_mul_f32 v[164:165], v[164:165], v[60:61]
    v_pk_mul_f32 v[166:167], v[166:167], v[62:63]
    v_cvt_pk_bf16_f32 v120, v160, v161
    v_cvt_pk_bf16_f32 v121, v162, v163
    v_cvt_pk_bf16_f32 v122, v164, v165
    v_cvt_pk_bf16_f32 v123, v166, v167
    buffer_store_dwordx4 v[120:123], v102, s[20:23], s28 offen sc1
    v_pk_fma_f32 v[168:169], v[48:49], v[70:71], v[168:169] neg_lo:[1,0,0] neg_hi:[1,0,0]
    v_pk_fma_f32 v[170:171], v[50:51], v[70:71], v[170:171] neg_lo:[1,0,0] neg_hi:[1,0,0]
    v_pk_fma_f32 v[172:173], v[52:53], v[70:71], v[172:173] neg_lo:[1,0,0] neg_hi:[1,0,0]
    v_pk_fma_f32 v[174:175], v[54:55], v[70:71], v[174:175] neg_lo:[1,0,0] neg_hi:[1,0,0]
    v_pk_mul_f32 v[168:169], v[168:169], v[56:57]
    v_pk_mul_f32 v[170:171], v[170:171], v[58:59]
    v_pk_mul_f32 v[172:173], v[172:173], v[60:61]
    v_pk_mul_f32 v[174:175], v[174:175], v[62:63]
    v_cvt_pk_bf16_f32 v124, v168, v169
    v_cvt_pk_bf16_f32 v125, v170, v171
    v_cvt_pk_bf16_f32 v126, v172, v173
    v_cvt_pk_bf16_f32 v127, v174, v175
    buffer_store_dwordx4 v[124:127], v103, s[20:23], s28 offen sc1
    v_pk_fma_f32 v[176:177], v[48:49], v[72:73], v[176:177] neg_lo:[1,0,0] neg_hi:[1,0,0]
    v_pk_fma_f32 v[178:179], v[50:51], v[72:73], v[178:179] neg_lo:[1,0,0] neg_hi:[1,0,0]
    v_pk_fma_f32 v[180:181], v[52:53], v[72:73], v[180:181] neg_lo:[1,0,0] neg_hi:[1,0,0]
    v_pk_fma_f32 v[182:183], v[54:55], v[72:73], v[182:183] neg_lo:[1,0,0] neg_hi:[1,0,0]
    v_pk_mul_f32 v[176:177], v[176:177], v[56:57]
    v_pk_mul_f32 v[178:179], v[178:179], v[58:59]
    v_pk_mul_f32 v[180:181], v[180:181], v[60:61]
    v_pk_mul_f32 v[182:183], v[182:183], v[62:63]
    v_cvt_pk_bf16_f32 v112, v176, v177
    v_cvt_pk_bf16_f32 v113, v178, v179
    v_cvt_pk_bf16_f32 v114, v180, v181
    v_cvt_pk_bf16_f32 v115, v182, v183
    buffer_store_dwordx4 v[112:115], v104, s[20:23], s28 offen sc1
    v_pk_fma_f32 v[184:185], v[48:49], v[74:75], v[184:185] neg_lo:[1,0,0] neg_hi:[1,0,0]
    v_pk_fma_f32 v[186:187], v[50:51], v[74:75], v[186:187] neg_lo:[1,0,0] neg_hi:[1,0,0]
    v_pk_fma_f32 v[188:189], v[52:53], v[74:75], v[188:189] neg_lo:[1,0,0] neg_hi:[1,0,0]
    v_pk_fma_f32 v[190:191], v[54:55], v[74:75], v[190:191] neg_lo:[1,0,0] neg_hi:[1,0,0]
    v_pk_mul_f32 v[184:185], v[184:185], v[56:57]
    v_pk_mul_f32 v[186:187], v[186:187], v[58:59]
    v_pk_mul_f32 v[188:189], v[188:189], v[60:61]
    v_pk_mul_f32 v[190:191], v[190:191], v[62:63]
    v_cvt_pk_bf16_f32 v116, v184, v185
    v_cvt_pk_bf16_f32 v117, v186, v187
    v_cvt_pk_bf16_f32 v118, v188, v189
    v_cvt_pk_bf16_f32 v119, v190, v191
    buffer_store_dwordx4 v[116:119], v105, s[20:23], s28 offen sc1
    v_pk_fma_f32 v[192:193], v[48:49], v[76:77], v[192:193] neg_lo:[1,0,0] neg_hi:[1,0,0]
    v_pk_fma_f32 v[194:195], v[50:51], v[76:77], v[194:195] neg_lo:[1,0,0] neg_hi:[1,0,0]
    v_pk_fma_f32 v[196:197], v[52:53], v[76:77], v[196:197] neg_lo:[1,0,0] neg_hi:[1,0,0]
    v_pk_fma_f32 v[198:199], v[54:55], v[76:77], v[198:199] neg_lo:[1,0,0] neg_hi:[1,0,0]
    v_pk_mul_f32 v[192:193], v[192:193], v[56:57]
    v_pk_mul_f32 v[194:195], v[194:195], v[58:59]
    v_pk_mul_f32 v[196:197], v[196:197], v[60:61]
    v_pk_mul_f32 v[198:199], v[198:199], v[62:63]
    v_cvt_pk_bf16_f32 v120, v192, v193
    v_cvt_pk_bf16_f32 v121, v194, v195
    v_cvt_pk_bf16_f32 v122, v196, v197
    v_cvt_pk_bf16_f32 v123, v198, v199
    buffer_store_dwordx4 v[120:123], v106, s[20:23], s28 offen sc1
    v_pk_fma_f32 v[200:201], v[48:49], v[78:79], v[200:201] neg_lo:[1,0,0] neg_hi:[1,0,0]
    v_pk_fma_f32 v[202:203], v[50:51], v[78:79], v[202:203] neg_lo:[1,0,0] neg_hi:[1,0,0]
    v_pk_fma_f32 v[204:205], v[52:53], v[78:79], v[204:205] neg_lo:[1,0,0] neg_hi:[1,0,0]
    v_pk_fma_f32 v[206:207], v[54:55], v[78:79], v[206:207] neg_lo:[1,0,0] neg_hi:[1,0,0]
    v_pk_mul_f32 v[200:201], v[200:201], v[56:57]
    v_pk_mul_f32 v[202:203], v[202:203], v[58:59]
    v_pk_mul_f32 v[204:205], v[204:205], v[60:61]
    v_pk_mul_f32 v[206:207], v[206:207], v[62:63]
    v_cvt_pk_bf16_f32 v124, v200, v201
    v_cvt_pk_bf16_f32 v125, v202, v203
    v_cvt_pk_bf16_f32 v126, v204, v205
    v_cvt_pk_bf16_f32 v127, v206, v207
    buffer_store_dwordx4 v[124:127], v107, s[20:23], s28 offen sc1
parallel_sum__mha_block__mixer_token_mlp__prompt_kernel_A:
    s_waitcnt lgkmcnt(0)
    v_readfirstlane_b32 s100, v140
    v_readfirstlane_b32 s101, v141
    s_lshl_b32 s65, s11, 4
    s_add_u32 s65, s65, s10
    s_lshl_b32 s65, s65, 7
    s_add_u32 s65, s65, 18939904
    s_and_b32 s10, s2, 7
    s_lshr_b32 s11, s2, 3
    v_and_b32 v2, 31, v1
    v_lshrrev_b32 v3, 5, v1
    v_mov_b32 v4, 159744
    s_and_b32 s32, s11, 3
    s_lshl_b32 s28, s10, 2
    s_add_u32 s32, s32, s28
    s_lshr_b32 s33, s11, 2
    s_mov_b32 s40, 0xfffff
    s_mov_b32 s41, 0xfffff
    s_mov_b32 s42, -1
    s_mov_b32 s43, 0
    s_mov_b32 s44, 0
    s_mov_b32 s45, -1
    v_lshlrev_b32 v5, 4, v1
    v_lshlrev_b32 v6, 3, v1
    v_bfe_u32 v8, v1, 2, 2
    v_xor_b32 v8, v8, v3
    v_lshlrev_b32 v8, 4, v8
    v_lshl_add_u32 v7, v2, 6, v8
    s_lshl_b32 s28, s32, 6
    s_lshl_b32 s29, s3, 4
    s_add_u32 s29, s29, s28
    s_mul_i32 s35, s29, 2560
    s_add_u32 s35, s35, 4194304
    s_lshl_b32 s29, s33, 3
    s_add_u32 s38, s28, s29
    s_lshl_b32 s31, s3, 1
    v_cmp_eq_u32 vcc, 20, v2
    v_mov_b32 v8, 0x3f803f80
    s_nop 0
    v_cndmask_b32 v9, 0, v8, vcc
    v_mov_b32 v16, v9
    v_mov_b32 v17, v9
    v_mov_b32 v18, v9
    v_mov_b32 v19, v9
    v_mov_b32 v20, v9
    v_mov_b32 v21, v9
    v_mov_b32 v22, v9
    v_mov_b32 v23, v9
    v_mov_b32 v25, 0
    v_mov_b32 v30, v9
    v_mov_b32 v31, v9
    v_mov_b32 v32, v9
    v_mov_b32 v33, v9
    v_mov_b32 v34, v9
    v_mov_b32 v35, v9
    v_mov_b32 v36, v9
    v_mov_b32 v37, v9
    v_mov_b32 v39, 0
    v_mov_b32 v40, 0
    v_mov_b32 v41, 0
    v_mov_b32 v42, 0
    v_mov_b32 v43, 0
    v_mov_b32 v44, 0
    v_mov_b32 v45, 0
    v_mov_b32 v46, 0
    v_mov_b32 v47, 0
    s_mov_b32 s34, s35
    s_mul_i32 s39, s3, 18432
    s_mov_b32 s46, s39
    s_mov_b32 s47, s39
    s_add_u32 s64, s39, 15360
    v_mfma_f32_32x32x16_bf16 v[128:143], v[40:43], v[40:43], 0
    v_mfma_f32_32x32x16_bf16 v[144:159], v[40:43], v[40:43], 0
    v_mfma_f32_32x32x16_bf16 v[160:175], v[40:43], v[40:43], 0
    v_mfma_f32_32x32x16_bf16 v[176:191], v[40:43], v[40:43], 0
    v_mfma_f32_32x32x16_bf16 v[192:207], v[40:43], v[40:43], 0
    v_mfma_f32_32x32x16_bf16 v[208:223], v[40:43], v[40:43], 0
    v_mfma_f32_32x32x16_bf16 v[224:239], v[40:43], v[40:43], 0
    v_mfma_f32_32x32x16_bf16 v[240:255], v[40:43], v[40:43], 0
    s_add_u32 s66, s32, 32
    s_mul_i32 s67, s66, 43
    s_lshr_b32 s67, s67, 8
    s_mul_i32 s68, s67, 122
    s_add_u32 s67, s68, s66
    s_mul_i32 s68, s32, 20
    s_add_u32 s69, s68, 19
    s_lshr_b32 s68, s68, 7
    s_lshr_b32 s69, s69, 7
    s_lshl_b32 s68, s68, 7
    s_lshl_b32 s69, s69, 7
    s_add_u32 s68, s68, 1376
    s_add_u32 s69, s69, 1344
    s_lshl_b32 s70, s3, 5
    s_add_u32 s67, s67, s70
    s_add_u32 s68, s68, s70
    s_add_u32 s69, s69, s70
    s_mul_i32 s70, s32, 43
    s_lshr_b32 s70, s70, 8
    s_mul_i32 s70, s70, 122
    s_add_u32 s70, s70, s32
    s_lshl_b32 s71, s33, 1
    s_lshr_b32 s66, s3, 1
    s_add_u32 s71, s71, s66
    s_lshl_b32 s71, s71, 3
    s_add_u32 s70, s70, s71
    s_sub_u32 s70, s70, 96
    v_mov_b32 v57, s70
    s_mov_b64 exec, 0xfff
    v_mov_b32 v57, s69
    s_mov_b64 exec, 0xff
    v_mov_b32 v57, s68
    s_mov_b64 exec, 0xf
    v_mov_b32 v57, s67
    s_mov_b64 exec, -1
    v_lshl_add_u32 v57, v1, 3, v57
    v_lshlrev_b32 v57, 4, v57
    s_mov_b32 s67, 18939904
    v_lshl_add_u32 v64, v1, 2, v4
    v_mov_b32 v60, s100
    v_mov_b32 v61, s101
    v_mov_b32 v63, 0
    s_waitcnt vmcnt(0)
    s_mov_b64 exec, 1
    v_mov_b32 v62, 1
    ds_add_rtn_u32 v62, v4, v62 offset:48
    s_mov_b64 exec, -1
    s_waitcnt lgkmcnt(0)
    v_readfirstlane_b32 s28, v62
    s_nop 0
    s_cmp_lg_u32 s28, 3
    s_cbranch_scc1 parallel_sum__mha_block__mixer_token_mlp__prompt_kernel_QR
    s_mov_b64 exec, 0x3f
    ds_read_b32 v62, v64 offset:56
    s_waitcnt lgkmcnt(0)
    buffer_store_dwordx4 v[60:63], v5, s[20:23], s65 offen sc1
    s_mov_b64 exec, -1
parallel_sum__mha_block__mixer_token_mlp__prompt_kernel_QR:
    s_mov_b32 s36, 0x40000
    s_mov_b64 exec, 8191
    s_sleep 8
parallel_sum__mha_block__mixer_token_mlp__prompt_kernel_PVL:
    buffer_load_dwordx3 v[64:66], v57, s[20:23], s67 offen sc1
    s_waitcnt vmcnt(0)
    v_cmp_ne_u64 vcc, s[100:101], v[64:65]
    s_sub_u32 s36, s36, 1
    s_cbranch_scc1 parallel_sum__mha_block__mixer_token_mlp__prompt_kernel_PVX
    s_nop 2
    s_cbranch_vccz parallel_sum__mha_block__mixer_token_mlp__prompt_kernel_PVX
    s_sleep 2
    s_branch parallel_sum__mha_block__mixer_token_mlp__prompt_kernel_PVL
parallel_sum__mha_block__mixer_token_mlp__prompt_kernel_PVX:
    s_mov_b64 exec, 0xf
    ds_max_u32 v4, v66 offset:40
    s_mov_b64 exec, 4096
    ds_max_u32 v4, v66 offset:44
    s_mov_b64 exec, -1
    s_add_u32 s28, s38, s31
    s_lshl_b32 s29, s28, 10
    s_add_u32 s29, s29, 1048576
    s_mov_b32 m0, s64
    s_lshl_b32 s28, s28, 9
    buffer_load_dwordx4 v5, s[20:23], s29 offen sc1 lds
    buffer_load_dwordx4 v5, s[20:23], s29 offen offset:1024 sc1 lds
    s_add_u32 s28, s28, 3143680
    buffer_load_dwordx4 v5, s[20:23], s28 offen offset:2048 sc1 lds
    s_add_u32 m0, s47, 0
    s_nop 0
    buffer_load_dwordx4 v5, s[20:23], s34 offen offset:0 sc1 lds
    buffer_load_dwordx4 v5, s[20:23], s34 offen offset:1024 sc1 lds
    buffer_load_dwordx4 v5, s[20:23], s34 offen offset:2048 sc1 lds
    buffer_load_dwordx4 v5, s[20:23], s34 offen offset:3072 sc1 lds
    s_add_u32 m0, s47, 4096
    s_add_u32 s34, s34, 4096
    buffer_load_dwordx4 v5, s[20:23], s34 offen offset:0 sc1 lds
    s_add_u32 s34, s34, 1024
    s_add_u32 s47, s47, 5120
    s_add_u32 m0, s47, 0
    s_nop 0
    buffer_load_dwordx4 v5, s[20:23], s34 offen offset:0 sc1 lds
    buffer_load_dwordx4 v5, s[20:23], s34 offen offset:1024 sc1 lds
    buffer_load_dwordx4 v5, s[20:23], s34 offen offset:2048 sc1 lds
    buffer_load_dwordx4 v5, s[20:23], s34 offen offset:3072 sc1 lds
    s_add_u32 m0, s47, 4096
    s_add_u32 s34, s34, 4096
    buffer_load_dwordx4 v5, s[20:23], s34 offen offset:0 sc1 lds
    s_add_u32 s34, s34, 1024
    s_add_u32 s47, s47, 5120
    v_add_u32 v8, s46, v5
    v_add_u32 v9, s46, v6
    v_add_u32 v10, s46, v7
    v_xor_b32 v0, 32, v10
    s_xor_b32 s28, s3, 0
    s_mul_i32 s28, s28, 18432
    s_add_u32 s28, s28, 15360
    v_add_u32 v48, s28, v5
    v_add_u32 v49, s28, v6
    s_xor_b32 s28, s3, 1
    s_mul_i32 s28, s28, 18432
    s_add_u32 s28, s28, 15360
    v_add_u32 v50, s28, v5
    v_add_u32 v51, s28, v6
    s_xor_b32 s28, s3, 2
    s_mul_i32 s28, s28, 18432
    s_add_u32 s28, s28, 15360
    v_add_u32 v52, s28, v5
    v_add_u32 v53, s28, v6
    s_xor_b32 s28, s3, 3
    s_mul_i32 s28, s28, 18432
    s_add_u32 s28, s28, 15360
    v_add_u32 v54, s28, v5
    v_add_u32 v55, s28, v6
    s_waitcnt vmcnt(10)
    s_waitcnt lgkmcnt(0)
    s_mov_b64 exec, 1
    v_mov_b32 v11, 1
    ds_add_u32 v4, v11 offset:24
    s_mov_b64 exec, -1
parallel_sum__mha_block__mixer_token_mlp__prompt_kernel_s6:
    ds_read_b32 v11, v4 offset:24
    s_waitcnt lgkmcnt(0)
    v_readfirstlane_b32 s28, v11
    s_nop 0
    s_cmp_ge_u32 s28, 4
    s_cbranch_scc1 parallel_sum__mha_block__mixer_token_mlp__prompt_kernel_s6x
    s_sleep 1
    s_branch parallel_sum__mha_block__mixer_token_mlp__prompt_kernel_s6
parallel_sum__mha_block__mixer_token_mlp__prompt_kernel_s6x:
    ds_read_b64 v[64:65], v4 offset:40
    ds_read_b128 v[80:83], v54 offset:0
    ds_read_b64 v[84:85], v55 offset:2048
    ds_read_b128 v[86:89], v54 offset:1024
    ds_read_b64 v[90:91], v55 offset:2560
    ds_read_b128 v[92:95], v52 offset:0
    ds_read_b64 v[96:97], v53 offset:2048
    ds_read_b128 v[98:101], v52 offset:1024
    ds_read_b64 v[102:103], v53 offset:2560
    ds_read_b128 v[104:107], v50 offset:0
    ds_read_b64 v[108:109], v51 offset:2048
    ds_read_b128 v[110:113], v50 offset:1024
    ds_read_b64 v[114:115], v51 offset:2560
    ds_read_b128 v[116:119], v48 offset:0
    ds_read_b64 v[120:121], v49 offset:2048
    ds_read_b128 v[122:125], v48 offset:1024
    ds_read_b64 v[126:127], v49 offset:2560
    s_waitcnt lgkmcnt(15)
    v_mul_f32 v64, 0x3f810000, v64
    v_mov_b32 v66, 0x426c4ec5
    v_mul_f32 v65, v65, v64
    v_cvt_pk_bf16_f32 v64, v64, v25
    v_cmp_nle_f32 vcc, v65, v66
    v_mov_b32 v24, v64
    v_mov_b32 v38, v64
    s_waitcnt vmcnt(5)
    s_cbranch_vccnz parallel_sum__mha_block__mixer_token_mlp__prompt_kernel_FB
parallel_sum__mha_block__mixer_token_mlp__prompt_kernel_M:
    ds_read_b128 v[12:15], v8 offset:0
    s_mov_b64 exec, s[42:43]
    ds_read_b64 v[24:25], v9 offset:1024
    s_mov_b64 exec, s[40:41]
    ds_read_b128 v[16:19], v10 offset:1280
    ds_read_b128 v[20:23], v0 offset:1280
    s_mov_b64 exec, -1
    s_waitcnt lgkmcnt(0)
    v_mfma_f32_32x32x16_bf16 v[48:63], v[12:15], v[80:83], 0
    v_mfma_f32_32x32x8_bf16 v[48:63], v[24:25], v[84:85], v[48:63]
    s_mov_b32 s36, 8
    s_setprio 1
    s_nop 9
.p2align 3
parallel_sum__mha_block__mixer_token_mlp__prompt_kernel_AL:
    v_mfma_f32_32x32x16_bf16 v[64:79], v[12:15], v[86:89], 0
    v_exp_f32 v48, v48
    v_exp_f32 v49, v49
    v_exp_f32 v50, v50
    v_exp_f32 v51, v51
    v_mfma_f32_32x32x8_bf16 v[64:79], v[24:25], v[90:91], v[64:79]
    v_exp_f32 v52, v52
    v_exp_f32 v53, v53
    v_exp_f32 v54, v54
    v_exp_f32 v55, v55
    v_cvt_pk_bf16_f32 v40, v48, v49
    v_cvt_pk_bf16_f32 v41, v50, v51
    v_mfma_f32_32x32x16_bf16 v[240:255], v[34:37], v[44:47], v[240:255]
    ds_read_b128 v[26:29], v8 offset:2560
    v_cvt_pk_bf16_f32 v42, v52, v53
    v_cvt_pk_bf16_f32 v43, v54, v55
    v_exp_f32 v56, v56
    v_exp_f32 v57, v57
    v_exp_f32 v58, v58
    v_exp_f32 v59, v59
    v_mfma_f32_32x32x16_bf16 v[128:143], v[16:19], v[40:43], v[128:143]
    s_mov_b32 m0, s47
    v_exp_f32 v60, v60
    v_exp_f32 v61, v61
    v_exp_f32 v62, v62
    v_exp_f32 v63, v63
    v_cvt_pk_bf16_f32 v44, v56, v57
    v_cvt_pk_bf16_f32 v45, v58, v59
    v_cvt_pk_bf16_f32 v46, v60, v61
    v_cvt_pk_bf16_f32 v47, v62, v63
    v_mfma_f32_32x32x16_bf16 v[48:63], v[12:15], v[92:95], 0
    s_setprio 3
    buffer_load_dwordx4 v5, s[20:23], s34 offen offset:0 sc1 lds
    buffer_load_dwordx4 v5, s[20:23], s34 offen offset:1024 sc1 lds
    buffer_load_dwordx4 v5, s[20:23], s34 offen offset:2048 sc1 lds
    s_setprio 1
    v_exp_f32 v64, v64
    v_exp_f32 v65, v65
    v_exp_f32 v66, v66
    v_exp_f32 v67, v67
    v_mfma_f32_32x32x8_bf16 v[48:63], v[24:25], v[96:97], v[48:63]
    v_exp_f32 v68, v68
    v_exp_f32 v69, v69
    v_exp_f32 v70, v70
    v_exp_f32 v71, v71
    v_cvt_pk_bf16_f32 v40, v64, v65
    v_cvt_pk_bf16_f32 v41, v66, v67
    v_mfma_f32_32x32x16_bf16 v[128:143], v[20:23], v[44:47], v[128:143]
    s_mov_b64 exec, s[42:43]
    ds_read_b64 v[38:39], v9 offset:3584
    s_mov_b64 exec, -1
    v_cvt_pk_bf16_f32 v42, v68, v69
    v_cvt_pk_bf16_f32 v43, v70, v71
    v_exp_f32 v72, v72
    v_exp_f32 v73, v73
    v_exp_f32 v74, v74
    v_exp_f32 v75, v75
    v_mfma_f32_32x32x16_bf16 v[144:159], v[16:19], v[40:43], v[144:159]
    v_exp_f32 v76, v76
    v_exp_f32 v77, v77
    v_exp_f32 v78, v78
    v_exp_f32 v79, v79
    v_cvt_pk_bf16_f32 v44, v72, v73
    v_cvt_pk_bf16_f32 v45, v74, v75
    v_cvt_pk_bf16_f32 v46, v76, v77
    v_cvt_pk_bf16_f32 v47, v78, v79
    v_mfma_f32_32x32x16_bf16 v[64:79], v[12:15], v[98:101], 0
    v_exp_f32 v48, v48
    v_exp_f32 v49, v49
    v_exp_f32 v50, v50
    v_exp_f32 v51, v51
    v_mfma_f32_32x32x8_bf16 v[64:79], v[24:25], v[102:103], v[64:79]
    v_exp_f32 v52, v52
    v_exp_f32 v53, v53
    v_exp_f32 v54, v54
    v_exp_f32 v55, v55
    v_cvt_pk_bf16_f32 v40, v48, v49
    v_cvt_pk_bf16_f32 v41, v50, v51
    v_mfma_f32_32x32x16_bf16 v[144:159], v[20:23], v[44:47], v[144:159]
    s_mov_b64 exec, s[40:41]
    ds_read_b128 v[30:33], v10 offset:3840
    ds_read_b128 v[34:37], v0 offset:3840
    s_mov_b64 exec, -1
    v_cvt_pk_bf16_f32 v42, v52, v53
    v_cvt_pk_bf16_f32 v43, v54, v55
    v_exp_f32 v56, v56
    v_exp_f32 v57, v57
    v_exp_f32 v58, v58
    v_exp_f32 v59, v59
    v_mfma_f32_32x32x16_bf16 v[160:175], v[16:19], v[40:43], v[160:175]
    v_exp_f32 v60, v60
    v_exp_f32 v61, v61
    v_exp_f32 v62, v62
    v_exp_f32 v63, v63
    v_cvt_pk_bf16_f32 v44, v56, v57
    v_cvt_pk_bf16_f32 v45, v58, v59
    v_cvt_pk_bf16_f32 v46, v60, v61
    v_cvt_pk_bf16_f32 v47, v62, v63
    v_mfma_f32_32x32x16_bf16 v[48:63], v[12:15], v[104:107], 0
    s_setprio 3
    buffer_load_dwordx4 v5, s[20:23], s34 offen offset:3072 sc1 lds
    s_add_u32 m0, s47, 4096
    s_add_u32 s34, s34, 4096
    s_nop 0
    buffer_load_dwordx4 v5, s[20:23], s34 offen offset:0 sc1 lds
    s_add_u32 s34, s34, 1024
    s_setprio 1
    v_exp_f32 v64, v64
    v_exp_f32 v65, v65
    v_exp_f32 v66, v66
    v_exp_f32 v67, v67
    v_mfma_f32_32x32x8_bf16 v[48:63], v[24:25], v[108:109], v[48:63]
    v_exp_f32 v68, v68
    v_exp_f32 v69, v69
    v_exp_f32 v70, v70
    v_exp_f32 v71, v71
    v_cvt_pk_bf16_f32 v40, v64, v65
    v_cvt_pk_bf16_f32 v41, v66, v67
    v_mfma_f32_32x32x16_bf16 v[160:175], v[20:23], v[44:47], v[160:175]
    s_add_u32 s46, s46, 5120
    s_cmp_eq_u32 s46, s64
    s_cselect_b32 s46, s39, s46
    v_cvt_pk_bf16_f32 v42, v68, v69
    v_cvt_pk_bf16_f32 v43, v70, v71
    v_exp_f32 v72, v72
    v_exp_f32 v73, v73
    v_exp_f32 v74, v74
    v_exp_f32 v75, v75
    v_mfma_f32_32x32x16_bf16 v[176:191], v[16:19], v[40:43], v[176:191]
    v_exp_f32 v76, v76
    v_exp_f32 v77, v77
    v_exp_f32 v78, v78
    v_exp_f32 v79, v79
    v_cvt_pk_bf16_f32 v44, v72, v73
    v_cvt_pk_bf16_f32 v45, v74, v75
    v_cvt_pk_bf16_f32 v46, v76, v77
    v_cvt_pk_bf16_f32 v47, v78, v79
    v_mfma_f32_32x32x16_bf16 v[64:79], v[12:15], v[110:113], 0
    v_exp_f32 v48, v48
    v_exp_f32 v49, v49
    v_exp_f32 v50, v50
    v_exp_f32 v51, v51
    v_mfma_f32_32x32x8_bf16 v[64:79], v[24:25], v[114:115], v[64:79]
    v_exp_f32 v52, v52
    v_exp_f32 v53, v53
    v_exp_f32 v54, v54
    v_exp_f32 v55, v55
    v_cvt_pk_bf16_f32 v40, v48, v49
    v_cvt_pk_bf16_f32 v41, v50, v51
    v_mfma_f32_32x32x16_bf16 v[176:191], v[20:23], v[44:47], v[176:191]
    v_cvt_pk_bf16_f32 v42, v52, v53
    v_cvt_pk_bf16_f32 v43, v54, v55
    v_exp_f32 v56, v56
    v_exp_f32 v57, v57
    v_exp_f32 v58, v58
    v_exp_f32 v59, v59
    v_mfma_f32_32x32x16_bf16 v[192:207], v[16:19], v[40:43], v[192:207]
    v_exp_f32 v60, v60
    v_exp_f32 v61, v61
    v_exp_f32 v62, v62
    v_exp_f32 v63, v63
    v_cvt_pk_bf16_f32 v44, v56, v57
    v_cvt_pk_bf16_f32 v45, v58, v59
    v_cvt_pk_bf16_f32 v46, v60, v61
    v_cvt_pk_bf16_f32 v47, v62, v63
    v_mfma_f32_32x32x16_bf16 v[48:63], v[12:15], v[116:119], 0
    v_exp_f32 v64, v64
    v_exp_f32 v65, v65
    v_exp_f32 v66, v66
    v_exp_f32 v67, v67
    v_mfma_f32_32x32x8_bf16 v[48:63], v[24:25], v[120:121], v[48:63]
    v_exp_f32 v68, v68
    v_exp_f32 v69, v69
    v_exp_f32 v70, v70
    v_exp_f32 v71, v71
    v_cvt_pk_bf16_f32 v40, v64, v65
    v_cvt_pk_bf16_f32 v41, v66, v67
    v_mfma_f32_32x32x16_bf16 v[192:207], v[20:23], v[44:47], v[192:207]
    v_cvt_pk_bf16_f32 v42, v68, v69
    v_cvt_pk_bf16_f32 v43, v70, v71
    v_exp_f32 v72, v72
    v_exp_f32 v73, v73
    v_exp_f32 v74, v74
    v_exp_f32 v75, v75
    v_mfma_f32_32x32x16_bf16 v[208:223], v[16:19], v[40:43], v[208:223]
    v_exp_f32 v76, v76
    v_exp_f32 v77, v77
    v_exp_f32 v78, v78
    v_exp_f32 v79, v79
    v_cvt_pk_bf16_f32 v44, v72, v73
    v_cvt_pk_bf16_f32 v45, v74, v75
    v_cvt_pk_bf16_f32 v46, v76, v77
    v_cvt_pk_bf16_f32 v47, v78, v79
    v_mfma_f32_32x32x16_bf16 v[64:79], v[12:15], v[122:125], 0
    s_add_u32 s47, s47, 5120
    s_cmp_eq_u32 s47, s64
    s_cselect_b32 s47, s39, s47
    v_exp_f32 v48, v48
    v_exp_f32 v49, v49
    v_exp_f32 v50, v50
    v_exp_f32 v51, v51
    v_mfma_f32_32x32x8_bf16 v[64:79], v[24:25], v[126:127], v[64:79]
    v_exp_f32 v52, v52
    v_exp_f32 v53, v53
    v_exp_f32 v54, v54
    v_exp_f32 v55, v55
    v_cvt_pk_bf16_f32 v40, v48, v49
    v_cvt_pk_bf16_f32 v41, v50, v51
    v_mfma_f32_32x32x16_bf16 v[208:223], v[20:23], v[44:47], v[208:223]
    v_cvt_pk_bf16_f32 v42, v52, v53
    v_cvt_pk_bf16_f32 v43, v54, v55
    v_exp_f32 v56, v56
    v_exp_f32 v57, v57
    v_exp_f32 v58, v58
    v_exp_f32 v59, v59
    v_mfma_f32_32x32x16_bf16 v[224:239], v[16:19], v[40:43], v[224:239]
    v_exp_f32 v60, v60
    v_exp_f32 v61, v61
    v_exp_f32 v62, v62
    v_exp_f32 v63, v63
    v_cvt_pk_bf16_f32 v44, v56, v57
    v_cvt_pk_bf16_f32 v45, v58, v59
    v_cvt_pk_bf16_f32 v46, v60, v61
    v_cvt_pk_bf16_f32 v47, v62, v63
    s_waitcnt lgkmcnt(0)
    v_mfma_f32_32x32x16_bf16 v[48:63], v[26:29], v[80:83], 0
    v_exp_f32 v64, v64
    v_exp_f32 v65, v65
    v_exp_f32 v66, v66
    v_exp_f32 v67, v67
    v_mfma_f32_32x32x8_bf16 v[48:63], v[38:39], v[84:85], v[48:63]
    v_exp_f32 v68, v68
    v_exp_f32 v69, v69
    v_exp_f32 v70, v70
    v_exp_f32 v71, v71
    v_cvt_pk_bf16_f32 v40, v64, v65
    v_cvt_pk_bf16_f32 v41, v66, v67
    v_mfma_f32_32x32x16_bf16 v[224:239], v[20:23], v[44:47], v[224:239]
    v_add_u32 v8, s46, v5
    v_add_u32 v9, s46, v6
    v_add_u32 v10, s46, v7
    v_xor_b32 v0, 32, v10
    s_waitcnt vmcnt(5)
    v_cvt_pk_bf16_f32 v42, v68, v69
    v_cvt_pk_bf16_f32 v43, v70, v71
    v_exp_f32 v72, v72
    v_exp_f32 v73, v73
    v_exp_f32 v74, v74
    v_exp_f32 v75, v75
    v_mfma_f32_32x32x16_bf16 v[240:255], v[16:19], v[40:43], v[240:255]
    v_exp_f32 v76, v76
    v_exp_f32 v77, v77
    v_exp_f32 v78, v78
    v_exp_f32 v79, v79
    v_cvt_pk_bf16_f32 v44, v72, v73
    v_cvt_pk_bf16_f32 v45, v74, v75
    v_cvt_pk_bf16_f32 v46, v76, v77
    v_cvt_pk_bf16_f32 v47, v78, v79
    v_mfma_f32_32x32x16_bf16 v[64:79], v[26:29], v[86:89], 0
    v_exp_f32 v48, v48
    v_exp_f32 v49, v49
    v_exp_f32 v50, v50
    v_exp_f32 v51, v51
    v_mfma_f32_32x32x8_bf16 v[64:79], v[38:39], v[90:91], v[64:79]
    v_exp_f32 v52, v52
    v_exp_f32 v53, v53
    v_exp_f32 v54, v54
    v_exp_f32 v55, v55
    v_cvt_pk_bf16_f32 v40, v48, v49
    v_cvt_pk_bf16_f32 v41, v50, v51
    v_mfma_f32_32x32x16_bf16 v[240:255], v[20:23], v[44:47], v[240:255]
    ds_read_b128 v[12:15], v8 offset:0
    v_cvt_pk_bf16_f32 v42, v52, v53
    v_cvt_pk_bf16_f32 v43, v54, v55
    v_exp_f32 v56, v56
    v_exp_f32 v57, v57
    v_exp_f32 v58, v58
    v_exp_f32 v59, v59
    v_mfma_f32_32x32x16_bf16 v[128:143], v[30:33], v[40:43], v[128:143]
    v_exp_f32 v60, v60
    v_exp_f32 v61, v61
    v_exp_f32 v62, v62
    v_exp_f32 v63, v63
    v_cvt_pk_bf16_f32 v44, v56, v57
    v_cvt_pk_bf16_f32 v45, v58, v59
    v_cvt_pk_bf16_f32 v46, v60, v61
    v_cvt_pk_bf16_f32 v47, v62, v63
    v_mfma_f32_32x32x16_bf16 v[48:63], v[26:29], v[92:95], 0
    v_exp_f32 v64, v64
    v_exp_f32 v65, v65
    v_exp_f32 v66, v66
    v_exp_f32 v67, v67
    v_mfma_f32_32x32x8_bf16 v[48:63], v[38:39], v[96:97], v[48:63]
    v_exp_f32 v68, v68
    v_exp_f32 v69, v69
    v_exp_f32 v70, v70
    v_exp_f32 v71, v71
    v_cvt_pk_bf16_f32 v40, v64, v65
    v_cvt_pk_bf16_f32 v41, v66, v67
    v_mfma_f32_32x32x16_bf16 v[128:143], v[34:37], v[44:47], v[128:143]
    s_mov_b64 exec, s[42:43]
    ds_read_b64 v[24:25], v9 offset:1024
    s_mov_b64 exec, -1
    v_cvt_pk_bf16_f32 v42, v68, v69
    v_cvt_pk_bf16_f32 v43, v70, v71
    v_exp_f32 v72, v72
    v_exp_f32 v73, v73
    v_exp_f32 v74, v74
    v_exp_f32 v75, v75
    v_mfma_f32_32x32x16_bf16 v[144:159], v[30:33], v[40:43], v[144:159]
    v_exp_f32 v76, v76
    v_exp_f32 v77, v77
    v_exp_f32 v78, v78
    v_exp_f32 v79, v79
    v_cvt_pk_bf16_f32 v44, v72, v73
    v_cvt_pk_bf16_f32 v45, v74, v75
    v_cvt_pk_bf16_f32 v46, v76, v77
    v_cvt_pk_bf16_f32 v47, v78, v79
    v_mfma_f32_32x32x16_bf16 v[64:79], v[26:29], v[98:101], 0
    v_exp_f32 v48, v48
    v_exp_f32 v49, v49
    v_exp_f32 v50, v50
    v_exp_f32 v51, v51
    v_mfma_f32_32x32x8_bf16 v[64:79], v[38:39], v[102:103], v[64:79]
    v_exp_f32 v52, v52
    v_exp_f32 v53, v53
    v_exp_f32 v54, v54
    v_exp_f32 v55, v55
    v_cvt_pk_bf16_f32 v40, v48, v49
    v_cvt_pk_bf16_f32 v41, v50, v51
    v_mfma_f32_32x32x16_bf16 v[144:159], v[34:37], v[44:47], v[144:159]
    s_mov_b64 exec, s[40:41]
    ds_read_b128 v[16:19], v10 offset:1280
    ds_read_b128 v[20:23], v0 offset:1280
    s_mov_b64 exec, -1
    v_cvt_pk_bf16_f32 v42, v52, v53
    v_cvt_pk_bf16_f32 v43, v54, v55
    v_exp_f32 v56, v56
    v_exp_f32 v57, v57
    v_exp_f32 v58, v58
    v_exp_f32 v59, v59
    v_mfma_f32_32x32x16_bf16 v[160:175], v[30:33], v[40:43], v[160:175]
    v_exp_f32 v60, v60
    v_exp_f32 v61, v61
    v_exp_f32 v62, v62
    v_exp_f32 v63, v63
    v_cvt_pk_bf16_f32 v44, v56, v57
    v_cvt_pk_bf16_f32 v45, v58, v59
    v_cvt_pk_bf16_f32 v46, v60, v61
    v_cvt_pk_bf16_f32 v47, v62, v63
    v_mfma_f32_32x32x16_bf16 v[48:63], v[26:29], v[104:107], 0
    v_exp_f32 v64, v64
    v_exp_f32 v65, v65
    v_exp_f32 v66, v66
    v_exp_f32 v67, v67
    v_mfma_f32_32x32x8_bf16 v[48:63], v[38:39], v[108:109], v[48:63]
    v_exp_f32 v68, v68
    v_exp_f32 v69, v69
    v_exp_f32 v70, v70
    v_exp_f32 v71, v71
    v_cvt_pk_bf16_f32 v40, v64, v65
    v_cvt_pk_bf16_f32 v41, v66, v67
    v_mfma_f32_32x32x16_bf16 v[160:175], v[34:37], v[44:47], v[160:175]
    v_cvt_pk_bf16_f32 v42, v68, v69
    v_cvt_pk_bf16_f32 v43, v70, v71
    v_exp_f32 v72, v72
    v_exp_f32 v73, v73
    v_exp_f32 v74, v74
    v_exp_f32 v75, v75
    v_mfma_f32_32x32x16_bf16 v[176:191], v[30:33], v[40:43], v[176:191]
    v_exp_f32 v76, v76
    v_exp_f32 v77, v77
    v_exp_f32 v78, v78
    v_exp_f32 v79, v79
    v_cvt_pk_bf16_f32 v44, v72, v73
    v_cvt_pk_bf16_f32 v45, v74, v75
    v_cvt_pk_bf16_f32 v46, v76, v77
    v_cvt_pk_bf16_f32 v47, v78, v79
    v_mfma_f32_32x32x16_bf16 v[64:79], v[26:29], v[110:113], 0
    v_exp_f32 v48, v48
    v_exp_f32 v49, v49
    v_exp_f32 v50, v50
    v_exp_f32 v51, v51
    v_mfma_f32_32x32x8_bf16 v[64:79], v[38:39], v[114:115], v[64:79]
    v_exp_f32 v52, v52
    v_exp_f32 v53, v53
    v_exp_f32 v54, v54
    v_exp_f32 v55, v55
    v_cvt_pk_bf16_f32 v40, v48, v49
    v_cvt_pk_bf16_f32 v41, v50, v51
    v_mfma_f32_32x32x16_bf16 v[176:191], v[34:37], v[44:47], v[176:191]
    v_cvt_pk_bf16_f32 v42, v52, v53
    v_cvt_pk_bf16_f32 v43, v54, v55
    v_exp_f32 v56, v56
    v_exp_f32 v57, v57
    v_exp_f32 v58, v58
    v_exp_f32 v59, v59
    v_mfma_f32_32x32x16_bf16 v[192:207], v[30:33], v[40:43], v[192:207]
    v_exp_f32 v60, v60
    v_exp_f32 v61, v61
    v_exp_f32 v62, v62
    v_exp_f32 v63, v63
    v_cvt_pk_bf16_f32 v44, v56, v57
    v_cvt_pk_bf16_f32 v45, v58, v59
    v_cvt_pk_bf16_f32 v46, v60, v61
    v_cvt_pk_bf16_f32 v47, v62, v63
    v_mfma_f32_32x32x16_bf16 v[48:63], v[26:29], v[116:119], 0
    v_exp_f32 v64, v64
    v_exp_f32 v65, v65
    v_exp_f32 v66, v66
    v_exp_f32 v67, v67
    v_mfma_f32_32x32x8_bf16 v[48:63], v[38:39], v[120:121], v[48:63]
    v_exp_f32 v68, v68
    v_exp_f32 v69, v69
    v_exp_f32 v70, v70
    v_exp_f32 v71, v71
    v_cvt_pk_bf16_f32 v40, v64, v65
    v_cvt_pk_bf16_f32 v41, v66, v67
    v_mfma_f32_32x32x16_bf16 v[192:207], v[34:37], v[44:47], v[192:207]
    v_cvt_pk_bf16_f32 v42, v68, v69
    v_cvt_pk_bf16_f32 v43, v70, v71
    v_exp_f32 v72, v72
    v_exp_f32 v73, v73
    v_exp_f32 v74, v74
    v_exp_f32 v75, v75
    v_mfma_f32_32x32x16_bf16 v[208:223], v[30:33], v[40:43], v[208:223]
    v_exp_f32 v76, v76
    v_exp_f32 v77, v77
    v_exp_f32 v78, v78
    v_exp_f32 v79, v79
    v_cvt_pk_bf16_f32 v44, v72, v73
    v_cvt_pk_bf16_f32 v45, v74, v75
    v_cvt_pk_bf16_f32 v46, v76, v77
    v_cvt_pk_bf16_f32 v47, v78, v79
    v_mfma_f32_32x32x16_bf16 v[64:79], v[26:29], v[122:125], 0
    v_exp_f32 v48, v48
    v_exp_f32 v49, v49
    v_exp_f32 v50, v50
    v_exp_f32 v51, v51
    v_mfma_f32_32x32x8_bf16 v[64:79], v[38:39], v[126:127], v[64:79]
    v_exp_f32 v52, v52
    v_exp_f32 v53, v53
    v_exp_f32 v54, v54
    v_exp_f32 v55, v55
    v_cvt_pk_bf16_f32 v40, v48, v49
    v_cvt_pk_bf16_f32 v41, v50, v51
    v_mfma_f32_32x32x16_bf16 v[208:223], v[34:37], v[44:47], v[208:223]
    v_cvt_pk_bf16_f32 v42, v52, v53
    v_cvt_pk_bf16_f32 v43, v54, v55
    v_exp_f32 v56, v56
    v_exp_f32 v57, v57
    v_exp_f32 v58, v58
    v_exp_f32 v59, v59
    v_mfma_f32_32x32x16_bf16 v[224:239], v[30:33], v[40:43], v[224:239]
    v_exp_f32 v60, v60
    v_exp_f32 v61, v61
    v_exp_f32 v62, v62
    v_exp_f32 v63, v63
    v_cvt_pk_bf16_f32 v44, v56, v57
    v_cvt_pk_bf16_f32 v45, v58, v59
    v_cvt_pk_bf16_f32 v46, v60, v61
    v_cvt_pk_bf16_f32 v47, v62, v63
    s_waitcnt lgkmcnt(0)
    v_mfma_f32_32x32x16_bf16 v[48:63], v[12:15], v[80:83], 0
    v_exp_f32 v64, v64
    v_exp_f32 v65, v65
    v_exp_f32 v66, v66
    v_exp_f32 v67, v67
    v_mfma_f32_32x32x8_bf16 v[48:63], v[24:25], v[84:85], v[48:63]
    v_exp_f32 v68, v68
    v_exp_f32 v69, v69
    v_exp_f32 v70, v70
    v_exp_f32 v71, v71
    v_cvt_pk_bf16_f32 v40, v64, v65
    v_cvt_pk_bf16_f32 v41, v66, v67
    v_mfma_f32_32x32x16_bf16 v[224:239], v[34:37], v[44:47], v[224:239]
    v_cvt_pk_bf16_f32 v42, v68, v69
    v_cvt_pk_bf16_f32 v43, v70, v71
    v_exp_f32 v72, v72
    v_exp_f32 v73, v73
    v_exp_f32 v74, v74
    v_exp_f32 v75, v75
    v_mfma_f32_32x32x16_bf16 v[240:255], v[30:33], v[40:43], v[240:255]
    s_sub_u32 s36, s36, 1
    s_cmp_lg_u32 s36, 2
    v_exp_f32 v76, v76
    v_exp_f32 v77, v77
    v_exp_f32 v78, v78
    v_exp_f32 v79, v79
    v_cvt_pk_bf16_f32 v44, v72, v73
    v_cvt_pk_bf16_f32 v45, v74, v75
    v_cvt_pk_bf16_f32 v46, v76, v77
    v_cvt_pk_bf16_f32 v47, v78, v79
    s_cbranch_scc1 parallel_sum__mha_block__mixer_token_mlp__prompt_kernel_AL
    v_mfma_f32_32x32x16_bf16 v[64:79], v[12:15], v[86:89], 0
    v_exp_f32 v48, v48
    v_exp_f32 v49, v49
    v_exp_f32 v50, v50
    v_exp_f32 v51, v51
    v_mfma_f32_32x32x8_bf16 v[64:79], v[24:25], v[90:91], v[64:79]
    v_exp_f32 v52, v52
    v_exp_f32 v53, v53
    v_exp_f32 v54, v54
    v_exp_f32 v55, v55
    v_cvt_pk_bf16_f32 v40, v48, v49
    v_cvt_pk_bf16_f32 v41, v50, v51
    v_mfma_f32_32x32x16_bf16 v[240:255], v[34:37], v[44:47], v[240:255]
    ds_read_b128 v[26:29], v8 offset:2560
    v_cvt_pk_bf16_f32 v42, v52, v53
    v_cvt_pk_bf16_f32 v43, v54, v55
    v_exp_f32 v56, v56
    v_exp_f32 v57, v57
    v_exp_f32 v58, v58
    v_exp_f32 v59, v59
    v_mfma_f32_32x32x16_bf16 v[128:143], v[16:19], v[40:43], v[128:143]
    v_exp_f32 v60, v60
    v_exp_f32 v61, v61
    v_exp_f32 v62, v62
    v_exp_f32 v63, v63
    v_cvt_pk_bf16_f32 v44, v56, v57
    v_cvt_pk_bf16_f32 v45, v58, v59
    v_cvt_pk_bf16_f32 v46, v60, v61
    v_cvt_pk_bf16_f32 v47, v62, v63
    v_mfma_f32_32x32x16_bf16 v[48:63], v[12:15], v[92:95], 0
    v_exp_f32 v64, v64
    v_exp_f32 v65, v65
    v_exp_f32 v66, v66
    v_exp_f32 v67, v67
    v_mfma_f32_32x32x8_bf16 v[48:63], v[24:25], v[96:97], v[48:63]
    v_exp_f32 v68, v68
    v_exp_f32 v69, v69
    v_exp_f32 v70, v70
    v_exp_f32 v71, v71
    v_cvt_pk_bf16_f32 v40, v64, v65
    v_cvt_pk_bf16_f32 v41, v66, v67
    v_mfma_f32_32x32x16_bf16 v[128:143], v[20:23], v[44:47], v[128:143]
    s_mov_b64 exec, s[42:43]
    ds_read_b64 v[38:39], v9 offset:3584
    s_mov_b64 exec, -1
    v_cvt_pk_bf16_f32 v42, v68, v69
    v_cvt_pk_bf16_f32 v43, v70, v71
    v_exp_f32 v72, v72
    v_exp_f32 v73, v73
    v_exp_f32 v74, v74
    v_exp_f32 v75, v75
    v_mfma_f32_32x32x16_bf16 v[144:159], v[16:19], v[40:43], v[144:159]
    v_exp_f32 v76, v76
    v_exp_f32 v77, v77
    v_exp_f32 v78, v78
    v_exp_f32 v79, v79
    v_cvt_pk_bf16_f32 v44, v72, v73
    v_cvt_pk_bf16_f32 v45, v74, v75
    v_cvt_pk_bf16_f32 v46, v76, v77
    v_cvt_pk_bf16_f32 v47, v78, v79
    v_mfma_f32_32x32x16_bf16 v[64:79], v[12:15], v[98:101], 0
    v_exp_f32 v48, v48
    v_exp_f32 v49, v49
    v_exp_f32 v50, v50
    v_exp_f32 v51, v51
    v_mfma_f32_32x32x8_bf16 v[64:79], v[24:25], v[102:103], v[64:79]
    v_exp_f32 v52, v52
    v_exp_f32 v53, v53
    v_exp_f32 v54, v54
    v_exp_f32 v55, v55
    v_cvt_pk_bf16_f32 v40, v48, v49
    v_cvt_pk_bf16_f32 v41, v50, v51
    v_mfma_f32_32x32x16_bf16 v[144:159], v[20:23], v[44:47], v[144:159]
    s_mov_b64 exec, s[40:41]
    ds_read_b128 v[30:33], v10 offset:3840
    ds_read_b128 v[34:37], v0 offset:3840
    s_mov_b64 exec, -1
    v_cvt_pk_bf16_f32 v42, v52, v53
    v_cvt_pk_bf16_f32 v43, v54, v55
    v_exp_f32 v56, v56
    v_exp_f32 v57, v57
    v_exp_f32 v58, v58
    v_exp_f32 v59, v59
    v_mfma_f32_32x32x16_bf16 v[160:175], v[16:19], v[40:43], v[160:175]
    v_exp_f32 v60, v60
    v_exp_f32 v61, v61
    v_exp_f32 v62, v62
    v_exp_f32 v63, v63
    v_cvt_pk_bf16_f32 v44, v56, v57
    v_cvt_pk_bf16_f32 v45, v58, v59
    v_cvt_pk_bf16_f32 v46, v60, v61
    v_cvt_pk_bf16_f32 v47, v62, v63
    v_mfma_f32_32x32x16_bf16 v[48:63], v[12:15], v[104:107], 0
    v_exp_f32 v64, v64
    v_exp_f32 v65, v65
    v_exp_f32 v66, v66
    v_exp_f32 v67, v67
    v_mfma_f32_32x32x8_bf16 v[48:63], v[24:25], v[108:109], v[48:63]
    v_exp_f32 v68, v68
    v_exp_f32 v69, v69
    v_exp_f32 v70, v70
    v_exp_f32 v71, v71
    v_cvt_pk_bf16_f32 v40, v64, v65
    v_cvt_pk_bf16_f32 v41, v66, v67
    v_mfma_f32_32x32x16_bf16 v[160:175], v[20:23], v[44:47], v[160:175]
    s_add_u32 s46, s46, 5120
    s_cmp_eq_u32 s46, s64
    s_cselect_b32 s46, s39, s46
    v_cvt_pk_bf16_f32 v42, v68, v69
    v_cvt_pk_bf16_f32 v43, v70, v71
    v_exp_f32 v72, v72
    v_exp_f32 v73, v73
    v_exp_f32 v74, v74
    v_exp_f32 v75, v75
    v_mfma_f32_32x32x16_bf16 v[176:191], v[16:19], v[40:43], v[176:191]
    v_exp_f32 v76, v76
    v_exp_f32 v77, v77
    v_exp_f32 v78, v78
    v_exp_f32 v79, v79
    v_cvt_pk_bf16_f32 v44, v72, v73
    v_cvt_pk_bf16_f32 v45, v74, v75
    v_cvt_pk_bf16_f32 v46, v76, v77
    v_cvt_pk_bf16_f32 v47, v78, v79
    v_mfma_f32_32x32x16_bf16 v[64:79], v[12:15], v[110:113], 0
    v_exp_f32 v48, v48
    v_exp_f32 v49, v49
    v_exp_f32 v50, v50
    v_exp_f32 v51, v51
    v_mfma_f32_32x32x8_bf16 v[64:79], v[24:25], v[114:115], v[64:79]
    v_exp_f32 v52, v52
    v_exp_f32 v53, v53
    v_exp_f32 v54, v54
    v_exp_f32 v55, v55
    v_cvt_pk_bf16_f32 v40, v48, v49
    v_cvt_pk_bf16_f32 v41, v50, v51
    v_mfma_f32_32x32x16_bf16 v[176:191], v[20:23], v[44:47], v[176:191]
    v_cvt_pk_bf16_f32 v42, v52, v53
    v_cvt_pk_bf16_f32 v43, v54, v55
    v_exp_f32 v56, v56
    v_exp_f32 v57, v57
    v_exp_f32 v58, v58
    v_exp_f32 v59, v59
    v_mfma_f32_32x32x16_bf16 v[192:207], v[16:19], v[40:43], v[192:207]
    v_exp_f32 v60, v60
    v_exp_f32 v61, v61
    v_exp_f32 v62, v62
    v_exp_f32 v63, v63
    v_cvt_pk_bf16_f32 v44, v56, v57
    v_cvt_pk_bf16_f32 v45, v58, v59
    v_cvt_pk_bf16_f32 v46, v60, v61
    v_cvt_pk_bf16_f32 v47, v62, v63
    v_mfma_f32_32x32x16_bf16 v[48:63], v[12:15], v[116:119], 0
    v_exp_f32 v64, v64
    v_exp_f32 v65, v65
    v_exp_f32 v66, v66
    v_exp_f32 v67, v67
    v_mfma_f32_32x32x8_bf16 v[48:63], v[24:25], v[120:121], v[48:63]
    v_exp_f32 v68, v68
    v_exp_f32 v69, v69
    v_exp_f32 v70, v70
    v_exp_f32 v71, v71
    v_cvt_pk_bf16_f32 v40, v64, v65
    v_cvt_pk_bf16_f32 v41, v66, v67
    v_mfma_f32_32x32x16_bf16 v[192:207], v[20:23], v[44:47], v[192:207]
    v_cvt_pk_bf16_f32 v42, v68, v69
    v_cvt_pk_bf16_f32 v43, v70, v71
    v_exp_f32 v72, v72
    v_exp_f32 v73, v73
    v_exp_f32 v74, v74
    v_exp_f32 v75, v75
    v_mfma_f32_32x32x16_bf16 v[208:223], v[16:19], v[40:43], v[208:223]
    v_exp_f32 v76, v76
    v_exp_f32 v77, v77
    v_exp_f32 v78, v78
    v_exp_f32 v79, v79
    v_cvt_pk_bf16_f32 v44, v72, v73
    v_cvt_pk_bf16_f32 v45, v74, v75
    v_cvt_pk_bf16_f32 v46, v76, v77
    v_cvt_pk_bf16_f32 v47, v78, v79
    v_mfma_f32_32x32x16_bf16 v[64:79], v[12:15], v[122:125], 0
    v_exp_f32 v48, v48
    v_exp_f32 v49, v49
    v_exp_f32 v50, v50
    v_exp_f32 v51, v51
    v_mfma_f32_32x32x8_bf16 v[64:79], v[24:25], v[126:127], v[64:79]
    v_exp_f32 v52, v52
    v_exp_f32 v53, v53
    v_exp_f32 v54, v54
    v_exp_f32 v55, v55
    v_cvt_pk_bf16_f32 v40, v48, v49
    v_cvt_pk_bf16_f32 v41, v50, v51
    v_mfma_f32_32x32x16_bf16 v[208:223], v[20:23], v[44:47], v[208:223]
    v_cvt_pk_bf16_f32 v42, v52, v53
    v_cvt_pk_bf16_f32 v43, v54, v55
    v_exp_f32 v56, v56
    v_exp_f32 v57, v57
    v_exp_f32 v58, v58
    v_exp_f32 v59, v59
    v_mfma_f32_32x32x16_bf16 v[224:239], v[16:19], v[40:43], v[224:239]
    v_exp_f32 v60, v60
    v_exp_f32 v61, v61
    v_exp_f32 v62, v62
    v_exp_f32 v63, v63
    v_cvt_pk_bf16_f32 v44, v56, v57
    v_cvt_pk_bf16_f32 v45, v58, v59
    v_cvt_pk_bf16_f32 v46, v60, v61
    v_cvt_pk_bf16_f32 v47, v62, v63
    s_waitcnt lgkmcnt(0)
    v_mfma_f32_32x32x16_bf16 v[48:63], v[26:29], v[80:83], 0
    v_exp_f32 v64, v64
    v_exp_f32 v65, v65
    v_exp_f32 v66, v66
    v_exp_f32 v67, v67
    v_mfma_f32_32x32x8_bf16 v[48:63], v[38:39], v[84:85], v[48:63]
    v_exp_f32 v68, v68
    v_exp_f32 v69, v69
    v_exp_f32 v70, v70
    v_exp_f32 v71, v71
    v_cvt_pk_bf16_f32 v40, v64, v65
    v_cvt_pk_bf16_f32 v41, v66, v67
    v_mfma_f32_32x32x16_bf16 v[224:239], v[20:23], v[44:47], v[224:239]
    v_add_u32 v8, s46, v5
    v_add_u32 v9, s46, v6
    v_add_u32 v10, s46, v7
    v_xor_b32 v0, 32, v10
    s_waitcnt vmcnt(0)
    v_cvt_pk_bf16_f32 v42, v68, v69
    v_cvt_pk_bf16_f32 v43, v70, v71
    v_exp_f32 v72, v72
    v_exp_f32 v73, v73
    v_exp_f32 v74, v74
    v_exp_f32 v75, v75
    v_mfma_f32_32x32x16_bf16 v[240:255], v[16:19], v[40:43], v[240:255]
    v_exp_f32 v76, v76
    v_exp_f32 v77, v77
    v_exp_f32 v78, v78
    v_exp_f32 v79, v79
    v_cvt_pk_bf16_f32 v44, v72, v73
    v_cvt_pk_bf16_f32 v45, v74, v75
    v_cvt_pk_bf16_f32 v46, v76, v77
    v_cvt_pk_bf16_f32 v47, v78, v79
    v_mfma_f32_32x32x16_bf16 v[64:79], v[26:29], v[86:89], 0
    v_exp_f32 v48, v48
    v_exp_f32 v49, v49
    v_exp_f32 v50, v50
    v_exp_f32 v51, v51
    v_mfma_f32_32x32x8_bf16 v[64:79], v[38:39], v[90:91], v[64:79]
    v_exp_f32 v52, v52
    v_exp_f32 v53, v53
    v_exp_f32 v54, v54
    v_exp_f32 v55, v55
    v_cvt_pk_bf16_f32 v40, v48, v49
    v_cvt_pk_bf16_f32 v41, v50, v51
    v_mfma_f32_32x32x16_bf16 v[240:255], v[20:23], v[44:47], v[240:255]
    ds_read_b128 v[12:15], v8 offset:0
    v_cvt_pk_bf16_f32 v42, v52, v53
    v_cvt_pk_bf16_f32 v43, v54, v55
    v_exp_f32 v56, v56
    v_exp_f32 v57, v57
    v_exp_f32 v58, v58
    v_exp_f32 v59, v59
    v_mfma_f32_32x32x16_bf16 v[128:143], v[30:33], v[40:43], v[128:143]
    v_exp_f32 v60, v60
    v_exp_f32 v61, v61
    v_exp_f32 v62, v62
    v_exp_f32 v63, v63
    v_cvt_pk_bf16_f32 v44, v56, v57
    v_cvt_pk_bf16_f32 v45, v58, v59
    v_cvt_pk_bf16_f32 v46, v60, v61
    v_cvt_pk_bf16_f32 v47, v62, v63
    v_mfma_f32_32x32x16_bf16 v[48:63], v[26:29], v[92:95], 0
    v_exp_f32 v64, v64
    v_exp_f32 v65, v65
    v_exp_f32 v66, v66
    v_exp_f32 v67, v67
    v_mfma_f32_32x32x8_bf16 v[48:63], v[38:39], v[96:97], v[48:63]
    v_exp_f32 v68, v68
    v_exp_f32 v69, v69
    v_exp_f32 v70, v70
    v_exp_f32 v71, v71
    v_cvt_pk_bf16_f32 v40, v64, v65
    v_cvt_pk_bf16_f32 v41, v66, v67
    v_mfma_f32_32x32x16_bf16 v[128:143], v[34:37], v[44:47], v[128:143]
    s_mov_b64 exec, s[42:43]
    ds_read_b64 v[24:25], v9 offset:1024
    s_mov_b64 exec, -1
    v_cvt_pk_bf16_f32 v42, v68, v69
    v_cvt_pk_bf16_f32 v43, v70, v71
    v_exp_f32 v72, v72
    v_exp_f32 v73, v73
    v_exp_f32 v74, v74
    v_exp_f32 v75, v75
    v_mfma_f32_32x32x16_bf16 v[144:159], v[30:33], v[40:43], v[144:159]
    v_exp_f32 v76, v76
    v_exp_f32 v77, v77
    v_exp_f32 v78, v78
    v_exp_f32 v79, v79
    v_cvt_pk_bf16_f32 v44, v72, v73
    v_cvt_pk_bf16_f32 v45, v74, v75
    v_cvt_pk_bf16_f32 v46, v76, v77
    v_cvt_pk_bf16_f32 v47, v78, v79
    v_mfma_f32_32x32x16_bf16 v[64:79], v[26:29], v[98:101], 0
    v_exp_f32 v48, v48
    v_exp_f32 v49, v49
    v_exp_f32 v50, v50
    v_exp_f32 v51, v51
    v_mfma_f32_32x32x8_bf16 v[64:79], v[38:39], v[102:103], v[64:79]
    v_exp_f32 v52, v52
    v_exp_f32 v53, v53
    v_exp_f32 v54, v54
    v_exp_f32 v55, v55
    v_cvt_pk_bf16_f32 v40, v48, v49
    v_cvt_pk_bf16_f32 v41, v50, v51
    v_mfma_f32_32x32x16_bf16 v[144:159], v[34:37], v[44:47], v[144:159]
    s_mov_b64 exec, s[40:41]
    ds_read_b128 v[16:19], v10 offset:1280
    ds_read_b128 v[20:23], v0 offset:1280
    s_mov_b64 exec, -1
    v_cvt_pk_bf16_f32 v42, v52, v53
    v_cvt_pk_bf16_f32 v43, v54, v55
    v_exp_f32 v56, v56
    v_exp_f32 v57, v57
    v_exp_f32 v58, v58
    v_exp_f32 v59, v59
    v_mfma_f32_32x32x16_bf16 v[160:175], v[30:33], v[40:43], v[160:175]
    v_exp_f32 v60, v60
    v_exp_f32 v61, v61
    v_exp_f32 v62, v62
    v_exp_f32 v63, v63
    v_cvt_pk_bf16_f32 v44, v56, v57
    v_cvt_pk_bf16_f32 v45, v58, v59
    v_cvt_pk_bf16_f32 v46, v60, v61
    v_cvt_pk_bf16_f32 v47, v62, v63
    v_mfma_f32_32x32x16_bf16 v[48:63], v[26:29], v[104:107], 0
    v_exp_f32 v64, v64
    v_exp_f32 v65, v65
    v_exp_f32 v66, v66
    v_exp_f32 v67, v67
    v_mfma_f32_32x32x8_bf16 v[48:63], v[38:39], v[108:109], v[48:63]
    v_exp_f32 v68, v68
    v_exp_f32 v69, v69
    v_exp_f32 v70, v70
    v_exp_f32 v71, v71
    v_cvt_pk_bf16_f32 v40, v64, v65
    v_cvt_pk_bf16_f32 v41, v66, v67
    v_mfma_f32_32x32x16_bf16 v[160:175], v[34:37], v[44:47], v[160:175]
    v_cvt_pk_bf16_f32 v42, v68, v69
    v_cvt_pk_bf16_f32 v43, v70, v71
    v_exp_f32 v72, v72
    v_exp_f32 v73, v73
    v_exp_f32 v74, v74
    v_exp_f32 v75, v75
    v_mfma_f32_32x32x16_bf16 v[176:191], v[30:33], v[40:43], v[176:191]
    v_exp_f32 v76, v76
    v_exp_f32 v77, v77
    v_exp_f32 v78, v78
    v_exp_f32 v79, v79
    v_cvt_pk_bf16_f32 v44, v72, v73
    v_cvt_pk_bf16_f32 v45, v74, v75
    v_cvt_pk_bf16_f32 v46, v76, v77
    v_cvt_pk_bf16_f32 v47, v78, v79
    v_mfma_f32_32x32x16_bf16 v[64:79], v[26:29], v[110:113], 0
    v_exp_f32 v48, v48
    v_exp_f32 v49, v49
    v_exp_f32 v50, v50
    v_exp_f32 v51, v51
    v_mfma_f32_32x32x8_bf16 v[64:79], v[38:39], v[114:115], v[64:79]
    v_exp_f32 v52, v52
    v_exp_f32 v53, v53
    v_exp_f32 v54, v54
    v_exp_f32 v55, v55
    v_cvt_pk_bf16_f32 v40, v48, v49
    v_cvt_pk_bf16_f32 v41, v50, v51
    v_mfma_f32_32x32x16_bf16 v[176:191], v[34:37], v[44:47], v[176:191]
    v_cvt_pk_bf16_f32 v42, v52, v53
    v_cvt_pk_bf16_f32 v43, v54, v55
    v_exp_f32 v56, v56
    v_exp_f32 v57, v57
    v_exp_f32 v58, v58
    v_exp_f32 v59, v59
    v_mfma_f32_32x32x16_bf16 v[192:207], v[30:33], v[40:43], v[192:207]
    v_exp_f32 v60, v60
    v_exp_f32 v61, v61
    v_exp_f32 v62, v62
    v_exp_f32 v63, v63
    v_cvt_pk_bf16_f32 v44, v56, v57
    v_cvt_pk_bf16_f32 v45, v58, v59
    v_cvt_pk_bf16_f32 v46, v60, v61
    v_cvt_pk_bf16_f32 v47, v62, v63
    v_mfma_f32_32x32x16_bf16 v[48:63], v[26:29], v[116:119], 0
    v_exp_f32 v64, v64
    v_exp_f32 v65, v65
    v_exp_f32 v66, v66
    v_exp_f32 v67, v67
    v_mfma_f32_32x32x8_bf16 v[48:63], v[38:39], v[120:121], v[48:63]
    v_exp_f32 v68, v68
    v_exp_f32 v69, v69
    v_exp_f32 v70, v70
    v_exp_f32 v71, v71
    v_cvt_pk_bf16_f32 v40, v64, v65
    v_cvt_pk_bf16_f32 v41, v66, v67
    v_mfma_f32_32x32x16_bf16 v[192:207], v[34:37], v[44:47], v[192:207]
    v_cvt_pk_bf16_f32 v42, v68, v69
    v_cvt_pk_bf16_f32 v43, v70, v71
    v_exp_f32 v72, v72
    v_exp_f32 v73, v73
    v_exp_f32 v74, v74
    v_exp_f32 v75, v75
    v_mfma_f32_32x32x16_bf16 v[208:223], v[30:33], v[40:43], v[208:223]
    v_exp_f32 v76, v76
    v_exp_f32 v77, v77
    v_exp_f32 v78, v78
    v_exp_f32 v79, v79
    v_cvt_pk_bf16_f32 v44, v72, v73
    v_cvt_pk_bf16_f32 v45, v74, v75
    v_cvt_pk_bf16_f32 v46, v76, v77
    v_cvt_pk_bf16_f32 v47, v78, v79
    v_mfma_f32_32x32x16_bf16 v[64:79], v[26:29], v[122:125], 0
    v_exp_f32 v48, v48
    v_exp_f32 v49, v49
    v_exp_f32 v50, v50
    v_exp_f32 v51, v51
    v_mfma_f32_32x32x8_bf16 v[64:79], v[38:39], v[126:127], v[64:79]
    v_exp_f32 v52, v52
    v_exp_f32 v53, v53
    v_exp_f32 v54, v54
    v_exp_f32 v55, v55
    v_cvt_pk_bf16_f32 v40, v48, v49
    v_cvt_pk_bf16_f32 v41, v50, v51
    v_mfma_f32_32x32x16_bf16 v[208:223], v[34:37], v[44:47], v[208:223]
    v_cvt_pk_bf16_f32 v42, v52, v53
    v_cvt_pk_bf16_f32 v43, v54, v55
    v_exp_f32 v56, v56
    v_exp_f32 v57, v57
    v_exp_f32 v58, v58
    v_exp_f32 v59, v59
    v_mfma_f32_32x32x16_bf16 v[224:239], v[30:33], v[40:43], v[224:239]
    v_exp_f32 v60, v60
    v_exp_f32 v61, v61
    v_exp_f32 v62, v62
    v_exp_f32 v63, v63
    v_cvt_pk_bf16_f32 v44, v56, v57
    v_cvt_pk_bf16_f32 v45, v58, v59
    v_cvt_pk_bf16_f32 v46, v60, v61
    v_cvt_pk_bf16_f32 v47, v62, v63
    s_waitcnt lgkmcnt(0)
    v_mfma_f32_32x32x16_bf16 v[48:63], v[12:15], v[80:83], 0
    v_exp_f32 v64, v64
    v_exp_f32 v65, v65
    v_exp_f32 v66, v66
    v_exp_f32 v67, v67
    v_mfma_f32_32x32x8_bf16 v[48:63], v[24:25], v[84:85], v[48:63]
    v_exp_f32 v68, v68
    v_exp_f32 v69, v69
    v_exp_f32 v70, v70
    v_exp_f32 v71, v71
    v_cvt_pk_bf16_f32 v40, v64, v65
    v_cvt_pk_bf16_f32 v41, v66, v67
    v_mfma_f32_32x32x16_bf16 v[224:239], v[34:37], v[44:47], v[224:239]
    v_cvt_pk_bf16_f32 v42, v68, v69
    v_cvt_pk_bf16_f32 v43, v70, v71
    v_exp_f32 v72, v72
    v_exp_f32 v73, v73
    v_exp_f32 v74, v74
    v_exp_f32 v75, v75
    v_mfma_f32_32x32x16_bf16 v[240:255], v[30:33], v[40:43], v[240:255]
    v_exp_f32 v76, v76
    v_exp_f32 v77, v77
    v_exp_f32 v78, v78
    v_exp_f32 v79, v79
    v_cvt_pk_bf16_f32 v44, v72, v73
    v_cvt_pk_bf16_f32 v45, v74, v75
    v_cvt_pk_bf16_f32 v46, v76, v77
    v_cvt_pk_bf16_f32 v47, v78, v79
    v_mfma_f32_32x32x16_bf16 v[64:79], v[12:15], v[86:89], 0
    v_exp_f32 v48, v48
    v_exp_f32 v49, v49
    v_exp_f32 v50, v50
    v_exp_f32 v51, v51
    v_mfma_f32_32x32x8_bf16 v[64:79], v[24:25], v[90:91], v[64:79]
    v_exp_f32 v52, v52
    v_exp_f32 v53, v53
    v_exp_f32 v54, v54
    v_exp_f32 v55, v55
    v_cvt_pk_bf16_f32 v40, v48, v49
    v_cvt_pk_bf16_f32 v41, v50, v51
    v_mfma_f32_32x32x16_bf16 v[240:255], v[34:37], v[44:47], v[240:255]
    ds_read_b128 v[26:29], v8 offset:2560
    v_cvt_pk_bf16_f32 v42, v52, v53
    v_cvt_pk_bf16_f32 v43, v54, v55
    v_exp_f32 v56, v56
    v_exp_f32 v57, v57
    v_exp_f32 v58, v58
    v_exp_f32 v59, v59
    v_mfma_f32_32x32x16_bf16 v[128:143], v[16:19], v[40:43], v[128:143]
    v_exp_f32 v60, v60
    v_exp_f32 v61, v61
    v_exp_f32 v62, v62
    v_exp_f32 v63, v63
    v_cvt_pk_bf16_f32 v44, v56, v57
    v_cvt_pk_bf16_f32 v45, v58, v59
    v_cvt_pk_bf16_f32 v46, v60, v61
    v_cvt_pk_bf16_f32 v47, v62, v63
    v_mfma_f32_32x32x16_bf16 v[48:63], v[12:15], v[92:95], 0
    v_exp_f32 v64, v64
    v_exp_f32 v65, v65
    v_exp_f32 v66, v66
    v_exp_f32 v67, v67
    v_mfma_f32_32x32x8_bf16 v[48:63], v[24:25], v[96:97], v[48:63]
    v_exp_f32 v68, v68
    v_exp_f32 v69, v69
    v_exp_f32 v70, v70
    v_exp_f32 v71, v71
    v_cvt_pk_bf16_f32 v40, v64, v65
    v_cvt_pk_bf16_f32 v41, v66, v67
    v_mfma_f32_32x32x16_bf16 v[128:143], v[20:23], v[44:47], v[128:143]
    s_mov_b64 exec, s[42:43]
    ds_read_b64 v[38:39], v9 offset:3584
    s_mov_b64 exec, -1
    v_cvt_pk_bf16_f32 v42, v68, v69
    v_cvt_pk_bf16_f32 v43, v70, v71
    v_exp_f32 v72, v72
    v_exp_f32 v73, v73
    v_exp_f32 v74, v74
    v_exp_f32 v75, v75
    v_mfma_f32_32x32x16_bf16 v[144:159], v[16:19], v[40:43], v[144:159]
    v_exp_f32 v76, v76
    v_exp_f32 v77, v77
    v_exp_f32 v78, v78
    v_exp_f32 v79, v79
    v_cvt_pk_bf16_f32 v44, v72, v73
    v_cvt_pk_bf16_f32 v45, v74, v75
    v_cvt_pk_bf16_f32 v46, v76, v77
    v_cvt_pk_bf16_f32 v47, v78, v79
    v_mfma_f32_32x32x16_bf16 v[64:79], v[12:15], v[98:101], 0
    v_exp_f32 v48, v48
    v_exp_f32 v49, v49
    v_exp_f32 v50, v50
    v_exp_f32 v51, v51
    v_mfma_f32_32x32x8_bf16 v[64:79], v[24:25], v[102:103], v[64:79]
    v_exp_f32 v52, v52
    v_exp_f32 v53, v53
    v_exp_f32 v54, v54
    v_exp_f32 v55, v55
    v_cvt_pk_bf16_f32 v40, v48, v49
    v_cvt_pk_bf16_f32 v41, v50, v51
    v_mfma_f32_32x32x16_bf16 v[144:159], v[20:23], v[44:47], v[144:159]
    s_mov_b64 exec, s[40:41]
    ds_read_b128 v[30:33], v10 offset:3840
    ds_read_b128 v[34:37], v0 offset:3840
    s_mov_b64 exec, -1
    v_cvt_pk_bf16_f32 v42, v52, v53
    v_cvt_pk_bf16_f32 v43, v54, v55
    v_exp_f32 v56, v56
    v_exp_f32 v57, v57
    v_exp_f32 v58, v58
    v_exp_f32 v59, v59
    v_mfma_f32_32x32x16_bf16 v[160:175], v[16:19], v[40:43], v[160:175]
    v_exp_f32 v60, v60
    v_exp_f32 v61, v61
    v_exp_f32 v62, v62
    v_exp_f32 v63, v63
    v_cvt_pk_bf16_f32 v44, v56, v57
    v_cvt_pk_bf16_f32 v45, v58, v59
    v_cvt_pk_bf16_f32 v46, v60, v61
    v_cvt_pk_bf16_f32 v47, v62, v63
    v_mfma_f32_32x32x16_bf16 v[48:63], v[12:15], v[104:107], 0
    v_exp_f32 v64, v64
    v_exp_f32 v65, v65
    v_exp_f32 v66, v66
    v_exp_f32 v67, v67
    v_mfma_f32_32x32x8_bf16 v[48:63], v[24:25], v[108:109], v[48:63]
    v_exp_f32 v68, v68
    v_exp_f32 v69, v69
    v_exp_f32 v70, v70
    v_exp_f32 v71, v71
    v_cvt_pk_bf16_f32 v40, v64, v65
    v_cvt_pk_bf16_f32 v41, v66, v67
    v_mfma_f32_32x32x16_bf16 v[160:175], v[20:23], v[44:47], v[160:175]
    v_cvt_pk_bf16_f32 v42, v68, v69
    v_cvt_pk_bf16_f32 v43, v70, v71
    v_exp_f32 v72, v72
    v_exp_f32 v73, v73
    v_exp_f32 v74, v74
    v_exp_f32 v75, v75
    v_mfma_f32_32x32x16_bf16 v[176:191], v[16:19], v[40:43], v[176:191]
    v_exp_f32 v76, v76
    v_exp_f32 v77, v77
    v_exp_f32 v78, v78
    v_exp_f32 v79, v79
    v_cvt_pk_bf16_f32 v44, v72, v73
    v_cvt_pk_bf16_f32 v45, v74, v75
    v_cvt_pk_bf16_f32 v46, v76, v77
    v_cvt_pk_bf16_f32 v47, v78, v79
    v_mfma_f32_32x32x16_bf16 v[64:79], v[12:15], v[110:113], 0
    v_exp_f32 v48, v48
    v_exp_f32 v49, v49
    v_exp_f32 v50, v50
    v_exp_f32 v51, v51
    v_mfma_f32_32x32x8_bf16 v[64:79], v[24:25], v[114:115], v[64:79]
    v_exp_f32 v52, v52
    v_exp_f32 v53, v53
    v_exp_f32 v54, v54
    v_exp_f32 v55, v55
    v_cvt_pk_bf16_f32 v40, v48, v49
    v_cvt_pk_bf16_f32 v41, v50, v51
    v_mfma_f32_32x32x16_bf16 v[176:191], v[20:23], v[44:47], v[176:191]
    v_cvt_pk_bf16_f32 v42, v52, v53
    v_cvt_pk_bf16_f32 v43, v54, v55
    v_exp_f32 v56, v56
    v_exp_f32 v57, v57
    v_exp_f32 v58, v58
    v_exp_f32 v59, v59
    v_mfma_f32_32x32x16_bf16 v[192:207], v[16:19], v[40:43], v[192:207]
    v_exp_f32 v60, v60
    v_exp_f32 v61, v61
    v_exp_f32 v62, v62
    v_exp_f32 v63, v63
    v_cvt_pk_bf16_f32 v44, v56, v57
    v_cvt_pk_bf16_f32 v45, v58, v59
    v_cvt_pk_bf16_f32 v46, v60, v61
    v_cvt_pk_bf16_f32 v47, v62, v63
    v_mfma_f32_32x32x16_bf16 v[48:63], v[12:15], v[116:119], 0
    v_exp_f32 v64, v64
    v_exp_f32 v65, v65
    v_exp_f32 v66, v66
    v_exp_f32 v67, v67
    v_mfma_f32_32x32x8_bf16 v[48:63], v[24:25], v[120:121], v[48:63]
    v_exp_f32 v68, v68
    v_exp_f32 v69, v69
    v_exp_f32 v70, v70
    v_exp_f32 v71, v71
    v_cvt_pk_bf16_f32 v40, v64, v65
    v_cvt_pk_bf16_f32 v41, v66, v67
    v_mfma_f32_32x32x16_bf16 v[192:207], v[20:23], v[44:47], v[192:207]
    v_cvt_pk_bf16_f32 v42, v68, v69
    v_cvt_pk_bf16_f32 v43, v70, v71
    v_exp_f32 v72, v72
    v_exp_f32 v73, v73
    v_exp_f32 v74, v74
    v_exp_f32 v75, v75
    v_mfma_f32_32x32x16_bf16 v[208:223], v[16:19], v[40:43], v[208:223]
    v_exp_f32 v76, v76
    v_exp_f32 v77, v77
    v_exp_f32 v78, v78
    v_exp_f32 v79, v79
    v_cvt_pk_bf16_f32 v44, v72, v73
    v_cvt_pk_bf16_f32 v45, v74, v75
    v_cvt_pk_bf16_f32 v46, v76, v77
    v_cvt_pk_bf16_f32 v47, v78, v79
    v_mfma_f32_32x32x16_bf16 v[64:79], v[12:15], v[122:125], 0
    v_exp_f32 v48, v48
    v_exp_f32 v49, v49
    v_exp_f32 v50, v50
    v_exp_f32 v51, v51
    v_mfma_f32_32x32x8_bf16 v[64:79], v[24:25], v[126:127], v[64:79]
    v_exp_f32 v52, v52
    v_exp_f32 v53, v53
    v_exp_f32 v54, v54
    v_exp_f32 v55, v55
    v_cvt_pk_bf16_f32 v40, v48, v49
    v_cvt_pk_bf16_f32 v41, v50, v51
    v_mfma_f32_32x32x16_bf16 v[208:223], v[20:23], v[44:47], v[208:223]
    v_cvt_pk_bf16_f32 v42, v52, v53
    v_cvt_pk_bf16_f32 v43, v54, v55
    v_exp_f32 v56, v56
    v_exp_f32 v57, v57
    v_exp_f32 v58, v58
    v_exp_f32 v59, v59
    v_mfma_f32_32x32x16_bf16 v[224:239], v[16:19], v[40:43], v[224:239]
    v_exp_f32 v60, v60
    v_exp_f32 v61, v61
    v_exp_f32 v62, v62
    v_exp_f32 v63, v63
    v_cvt_pk_bf16_f32 v44, v56, v57
    v_cvt_pk_bf16_f32 v45, v58, v59
    v_cvt_pk_bf16_f32 v46, v60, v61
    v_cvt_pk_bf16_f32 v47, v62, v63
    s_waitcnt lgkmcnt(0)
    v_mfma_f32_32x32x16_bf16 v[48:63], v[26:29], v[80:83], 0
    v_exp_f32 v64, v64
    v_exp_f32 v65, v65
    v_exp_f32 v66, v66
    v_exp_f32 v67, v67
    v_mfma_f32_32x32x8_bf16 v[48:63], v[38:39], v[84:85], v[48:63]
    v_exp_f32 v68, v68
    v_exp_f32 v69, v69
    v_exp_f32 v70, v70
    v_exp_f32 v71, v71
    v_cvt_pk_bf16_f32 v40, v64, v65
    v_cvt_pk_bf16_f32 v41, v66, v67
    v_mfma_f32_32x32x16_bf16 v[224:239], v[20:23], v[44:47], v[224:239]
    v_add_u32 v11, s39, v5
    v_cvt_pk_bf16_f32 v42, v68, v69
    v_cvt_pk_bf16_f32 v43, v70, v71
    v_exp_f32 v72, v72
    v_exp_f32 v73, v73
    v_exp_f32 v74, v74
    v_exp_f32 v75, v75
    v_mfma_f32_32x32x16_bf16 v[240:255], v[16:19], v[40:43], v[240:255]
    v_exp_f32 v76, v76
    v_exp_f32 v77, v77
    v_exp_f32 v78, v78
    v_exp_f32 v79, v79
    v_cvt_pk_bf16_f32 v44, v72, v73
    v_cvt_pk_bf16_f32 v45, v74, v75
    v_cvt_pk_bf16_f32 v46, v76, v77
    v_cvt_pk_bf16_f32 v47, v78, v79
    v_mfma_f32_32x32x16_bf16 v[64:79], v[26:29], v[86:89], 0
    v_exp_f32 v48, v48
    v_exp_f32 v49, v49
    v_exp_f32 v50, v50
    v_exp_f32 v51, v51
    v_mfma_f32_32x32x8_bf16 v[64:79], v[38:39], v[90:91], v[64:79]
    v_exp_f32 v52, v52
    v_exp_f32 v53, v53
    v_exp_f32 v54, v54
    v_exp_f32 v55, v55
    v_cvt_pk_bf16_f32 v40, v48, v49
    v_cvt_pk_bf16_f32 v41, v50, v51
    v_mfma_f32_32x32x16_bf16 v[240:255], v[20:23], v[44:47], v[240:255]
    v_cvt_pk_bf16_f32 v42, v52, v53
    v_cvt_pk_bf16_f32 v43, v54, v55
    v_exp_f32 v56, v56
    v_exp_f32 v57, v57
    v_exp_f32 v58, v58
    v_exp_f32 v59, v59
    v_mfma_f32_32x32x16_bf16 v[128:143], v[30:33], v[40:43], v[128:143]
    v_exp_f32 v60, v60
    v_exp_f32 v61, v61
    v_exp_f32 v62, v62
    v_exp_f32 v63, v63
    v_cvt_pk_bf16_f32 v44, v56, v57
    v_cvt_pk_bf16_f32 v45, v58, v59
    v_cvt_pk_bf16_f32 v46, v60, v61
    v_cvt_pk_bf16_f32 v47, v62, v63
    v_mfma_f32_32x32x16_bf16 v[48:63], v[26:29], v[92:95], 0
    v_exp_f32 v64, v64
    v_exp_f32 v65, v65
    v_exp_f32 v66, v66
    v_exp_f32 v67, v67
    v_mfma_f32_32x32x8_bf16 v[48:63], v[38:39], v[96:97], v[48:63]
    v_exp_f32 v68, v68
    v_exp_f32 v69, v69
    v_exp_f32 v70, v70
    v_exp_f32 v71, v71
    v_cvt_pk_bf16_f32 v40, v64, v65
    v_cvt_pk_bf16_f32 v41, v66, v67
    v_mfma_f32_32x32x16_bf16 v[128:143], v[34:37], v[44:47], v[128:143]
    v_cvt_pk_bf16_f32 v42, v68, v69
    v_cvt_pk_bf16_f32 v43, v70, v71
    v_exp_f32 v72, v72
    v_exp_f32 v73, v73
    v_exp_f32 v74, v74
    v_exp_f32 v75, v75
    v_mfma_f32_32x32x16_bf16 v[144:159], v[30:33], v[40:43], v[144:159]
    v_exp_f32 v76, v76
    v_exp_f32 v77, v77
    v_exp_f32 v78, v78
    v_exp_f32 v79, v79
    v_cvt_pk_bf16_f32 v44, v72, v73
    v_cvt_pk_bf16_f32 v45, v74, v75
    v_cvt_pk_bf16_f32 v46, v76, v77
    v_cvt_pk_bf16_f32 v47, v78, v79
    v_mfma_f32_32x32x16_bf16 v[64:79], v[26:29], v[98:101], 0
    ds_write_b128 v11, v[128:131] offset:0
    ds_write_b128 v11, v[132:135] offset:1024
    ds_write_b128 v11, v[136:139] offset:2048
    v_exp_f32 v48, v48
    v_exp_f32 v49, v49
    v_exp_f32 v50, v50
    v_exp_f32 v51, v51
    v_mfma_f32_32x32x8_bf16 v[64:79], v[38:39], v[102:103], v[64:79]
    v_exp_f32 v52, v52
    v_exp_f32 v53, v53
    v_exp_f32 v54, v54
    v_exp_f32 v55, v55
    v_cvt_pk_bf16_f32 v40, v48, v49
    v_cvt_pk_bf16_f32 v41, v50, v51
    v_mfma_f32_32x32x16_bf16 v[144:159], v[34:37], v[44:47], v[144:159]
    v_cvt_pk_bf16_f32 v42, v52, v53
    v_cvt_pk_bf16_f32 v43, v54, v55
    v_exp_f32 v56, v56
    v_exp_f32 v57, v57
    v_exp_f32 v58, v58
    v_exp_f32 v59, v59
    v_mfma_f32_32x32x16_bf16 v[160:175], v[30:33], v[40:43], v[160:175]
    v_exp_f32 v60, v60
    v_exp_f32 v61, v61
    v_exp_f32 v62, v62
    v_exp_f32 v63, v63
    v_cvt_pk_bf16_f32 v44, v56, v57
    v_cvt_pk_bf16_f32 v45, v58, v59
    v_cvt_pk_bf16_f32 v46, v60, v61
    v_cvt_pk_bf16_f32 v47, v62, v63
    v_mfma_f32_32x32x16_bf16 v[48:63], v[26:29], v[104:107], 0
    ds_write_b128 v11, v[144:147] offset:3072
    ds_write_b128 v11, v[148:151] offset:4096
    ds_write_b128 v11, v[152:155] offset:5120
    v_exp_f32 v64, v64
    v_exp_f32 v65, v65
    v_exp_f32 v66, v66
    v_exp_f32 v67, v67
    v_mfma_f32_32x32x8_bf16 v[48:63], v[38:39], v[108:109], v[48:63]
    v_exp_f32 v68, v68
    v_exp_f32 v69, v69
    v_exp_f32 v70, v70
    v_exp_f32 v71, v71
    v_cvt_pk_bf16_f32 v40, v64, v65
    v_cvt_pk_bf16_f32 v41, v66, v67
    v_mfma_f32_32x32x16_bf16 v[160:175], v[34:37], v[44:47], v[160:175]
    v_cvt_pk_bf16_f32 v42, v68, v69
    v_cvt_pk_bf16_f32 v43, v70, v71
    v_exp_f32 v72, v72
    v_exp_f32 v73, v73
    v_exp_f32 v74, v74
    v_exp_f32 v75, v75
    v_mfma_f32_32x32x16_bf16 v[176:191], v[30:33], v[40:43], v[176:191]
    v_exp_f32 v76, v76
    v_exp_f32 v77, v77
    v_exp_f32 v78, v78
    v_exp_f32 v79, v79
    v_cvt_pk_bf16_f32 v44, v72, v73
    v_cvt_pk_bf16_f32 v45, v74, v75
    v_cvt_pk_bf16_f32 v46, v76, v77
    v_cvt_pk_bf16_f32 v47, v78, v79
    v_mfma_f32_32x32x16_bf16 v[64:79], v[26:29], v[110:113], 0
    ds_write_b128 v11, v[160:163] offset:6144
    ds_write_b128 v11, v[164:167] offset:7168
    ds_write_b128 v11, v[168:171] offset:8192
    v_exp_f32 v48, v48
    v_exp_f32 v49, v49
    v_exp_f32 v50, v50
    v_exp_f32 v51, v51
    v_mfma_f32_32x32x8_bf16 v[64:79], v[38:39], v[114:115], v[64:79]
    v_exp_f32 v52, v52
    v_exp_f32 v53, v53
    v_exp_f32 v54, v54
    v_exp_f32 v55, v55
    v_cvt_pk_bf16_f32 v40, v48, v49
    v_cvt_pk_bf16_f32 v41, v50, v51
    v_mfma_f32_32x32x16_bf16 v[176:191], v[34:37], v[44:47], v[176:191]
    v_cvt_pk_bf16_f32 v42, v52, v53
    v_cvt_pk_bf16_f32 v43, v54, v55
    v_exp_f32 v56, v56
    v_exp_f32 v57, v57
    v_exp_f32 v58, v58
    v_exp_f32 v59, v59
    v_mfma_f32_32x32x16_bf16 v[192:207], v[30:33], v[40:43], v[192:207]
    v_exp_f32 v60, v60
    v_exp_f32 v61, v61
    v_exp_f32 v62, v62
    v_exp_f32 v63, v63
    v_cvt_pk_bf16_f32 v44, v56, v57
    v_cvt_pk_bf16_f32 v45, v58, v59
    v_cvt_pk_bf16_f32 v46, v60, v61
    v_cvt_pk_bf16_f32 v47, v62, v63
    v_mfma_f32_32x32x16_bf16 v[48:63], v[26:29], v[116:119], 0
    ds_write_b128 v11, v[176:179] offset:9216
    ds_write_b128 v11, v[180:183] offset:10240
    ds_write_b128 v11, v[184:187] offset:11264
    v_exp_f32 v64, v64
    v_exp_f32 v65, v65
    v_exp_f32 v66, v66
    v_exp_f32 v67, v67
    v_mfma_f32_32x32x8_bf16 v[48:63], v[38:39], v[120:121], v[48:63]
    v_exp_f32 v68, v68
    v_exp_f32 v69, v69
    v_exp_f32 v70, v70
    v_exp_f32 v71, v71
    v_cvt_pk_bf16_f32 v40, v64, v65
    v_cvt_pk_bf16_f32 v41, v66, v67
    v_mfma_f32_32x32x16_bf16 v[192:207], v[34:37], v[44:47], v[192:207]
    v_cvt_pk_bf16_f32 v42, v68, v69
    v_cvt_pk_bf16_f32 v43, v70, v71
    v_exp_f32 v72, v72
    v_exp_f32 v73, v73
    v_exp_f32 v74, v74
    v_exp_f32 v75, v75
    v_mfma_f32_32x32x16_bf16 v[208:223], v[30:33], v[40:43], v[208:223]
    v_exp_f32 v76, v76
    v_exp_f32 v77, v77
    v_exp_f32 v78, v78
    v_exp_f32 v79, v79
    v_cvt_pk_bf16_f32 v44, v72, v73
    v_cvt_pk_bf16_f32 v45, v74, v75
    v_cvt_pk_bf16_f32 v46, v76, v77
    v_cvt_pk_bf16_f32 v47, v78, v79
    v_mfma_f32_32x32x16_bf16 v[64:79], v[26:29], v[122:125], 0
    ds_write_b128 v11, v[192:195] offset:12288
    ds_write_b128 v11, v[196:199] offset:13312
    ds_write_b128 v11, v[200:203] offset:14336
    v_exp_f32 v48, v48
    v_exp_f32 v49, v49
    v_exp_f32 v50, v50
    v_exp_f32 v51, v51
    v_mfma_f32_32x32x8_bf16 v[64:79], v[38:39], v[126:127], v[64:79]
    v_exp_f32 v52, v52
    v_exp_f32 v53, v53
    v_exp_f32 v54, v54
    v_exp_f32 v55, v55
    v_cvt_pk_bf16_f32 v40, v48, v49
    v_cvt_pk_bf16_f32 v41, v50, v51
    v_mfma_f32_32x32x16_bf16 v[208:223], v[34:37], v[44:47], v[208:223]
    v_cvt_pk_bf16_f32 v42, v52, v53
    v_cvt_pk_bf16_f32 v43, v54, v55
    v_exp_f32 v56, v56
    v_exp_f32 v57, v57
    v_exp_f32 v58, v58
    v_exp_f32 v59, v59
    v_mfma_f32_32x32x16_bf16 v[224:239], v[30:33], v[40:43], v[224:239]
    v_exp_f32 v60, v60
    v_exp_f32 v61, v61
    v_exp_f32 v62, v62
    v_exp_f32 v63, v63
    v_cvt_pk_bf16_f32 v44, v56, v57
    v_cvt_pk_bf16_f32 v45, v58, v59
    v_cvt_pk_bf16_f32 v46, v60, v61
    v_cvt_pk_bf16_f32 v47, v62, v63
    v_mfma_f32_32x32x16_bf16 v[48:63], v[12:15], v[80:83], 0
    ds_write_b128 v11, v[208:211] offset:15360
    ds_write_b128 v11, v[212:215] offset:16384
    ds_write_b128 v11, v[216:219] offset:17408
    v_exp_f32 v64, v64
    v_exp_f32 v65, v65
    v_exp_f32 v66, v66
    v_exp_f32 v67, v67
    v_mfma_f32_32x32x8_bf16 v[48:63], v[24:25], v[84:85], v[48:63]
    v_exp_f32 v68, v68
    v_exp_f32 v69, v69
    v_exp_f32 v70, v70
    v_exp_f32 v71, v71
    v_cvt_pk_bf16_f32 v40, v64, v65
    v_cvt_pk_bf16_f32 v41, v66, v67
    v_mfma_f32_32x32x16_bf16 v[224:239], v[34:37], v[44:47], v[224:239]
    v_cvt_pk_bf16_f32 v42, v68, v69
    v_cvt_pk_bf16_f32 v43, v70, v71
    v_exp_f32 v72, v72
    v_exp_f32 v73, v73
    v_exp_f32 v74, v74
    v_exp_f32 v75, v75
    v_mfma_f32_32x32x16_bf16 v[240:255], v[30:33], v[40:43], v[240:255]
    v_exp_f32 v76, v76
    v_exp_f32 v77, v77
    v_exp_f32 v78, v78
    v_exp_f32 v79, v79
    v_cvt_pk_bf16_f32 v44, v72, v73
    v_cvt_pk_bf16_f32 v45, v74, v75
    v_cvt_pk_bf16_f32 v46, v76, v77
    v_cvt_pk_bf16_f32 v47, v78, v79
    s_setprio 3
    s_waitcnt lgkmcnt(0)
    s_mov_b64 exec, 1
    v_mov_b32 v8, 1
    ds_add_u32 v4, v8 offset:0
    s_mov_b64 exec, -1
    s_nop 0
    v_mfma_f32_32x32x16_bf16 v[240:255], v[34:37], v[44:47], v[240:255]
    s_xor_b32 s29, s3, 1
    s_mul_i32 s29, s29, 18432
    s_add_u32 s29, s29, 12288
    v_add_u32 v9, s29, v5
    s_xor_b32 s29, s3, 2
    s_mul_i32 s29, s29, 18432
    s_add_u32 s29, s29, 6144
    v_add_u32 v10, s29, v5
    s_xor_b32 s29, s3, 3
    s_mul_i32 s29, s29, 18432
    s_add_u32 s29, s29, 0
    v_add_u32 v11, s29, v5
    s_lshl_b32 s28, s33, 2
    s_add_u32 s31, s28, s3
    s_lshl_b32 s28, s31, 7
    s_add_u32 s28, s28, s32
    s_lshl_b32 s29, s28, 7
    s_add_u32 s29, s29, 16777216
    s_lshl_b32 s28, s28, 9
    s_add_u32 s28, s28, 14680064
    v_bfe_u32 v7, v1, 4, 1
    v_and_b32 v6, 15, v1
    v_lshlrev_b32 v5, 4, v6
    v_lshl_add_u32 v5, v3, 8, v5
    v_lshl_add_u32 v5, v7, 14, v5
    v_lshlrev_b32 v6, 3, v6
    v_lshl_add_u32 v6, v7, 12, v6
    s_lshl_b32 s34, s31, 5
    s_add_u32 s34, s34, s32
    s_lshl_b32 s34, s34, 7
    s_add_u32 s34, s34, 19005440
parallel_sum__mha_block__mixer_token_mlp__prompt_kernel_s0:
    ds_read_b32 v8, v4 offset:0
    s_waitcnt lgkmcnt(0)
    v_readfirstlane_b32 s30, v8
    s_nop 0
    s_cmp_ge_u32 s30, 4
    s_cbranch_scc1 parallel_sum__mha_block__mixer_token_mlp__prompt_kernel_s0x
    s_sleep 1
    s_branch parallel_sum__mha_block__mixer_token_mlp__prompt_kernel_s0
parallel_sum__mha_block__mixer_token_mlp__prompt_kernel_s0x:
    ds_read_b128 v[12:15], v9 offset:0
    ds_read_b128 v[16:19], v9 offset:1024
    ds_read_b128 v[20:23], v9 offset:2048
    ds_read_b128 v[24:27], v9 offset:3072
    ds_read_b128 v[28:31], v9 offset:4096
    ds_read_b128 v[32:35], v9 offset:5120
    ds_read_b128 v[36:39], v10 offset:0
    ds_read_b128 v[40:43], v10 offset:1024
    ds_read_b128 v[44:47], v10 offset:2048
    ds_read_b128 v[48:51], v10 offset:3072
    ds_read_b128 v[52:55], v10 offset:4096
    ds_read_b128 v[56:59], v10 offset:5120
    ds_read_b128 v[60:63], v11 offset:0
    ds_read_b128 v[64:67], v11 offset:1024
    ds_read_b128 v[68:71], v11 offset:2048
    ds_read_b128 v[72:75], v11 offset:3072
    ds_read_b128 v[76:79], v11 offset:4096
    ds_read_b128 v[80:83], v11 offset:5120
    s_waitcnt lgkmcnt(12)
    v_pk_add_f32 v[224:225], v[224:225], v[12:13]
    v_pk_add_f32 v[226:227], v[226:227], v[14:15]
    v_pk_add_f32 v[228:229], v[228:229], v[16:17]
    v_pk_add_f32 v[230:231], v[230:231], v[18:19]
    v_pk_add_f32 v[232:233], v[232:233], v[20:21]
    v_pk_add_f32 v[234:235], v[234:235], v[22:23]
    v_pk_add_f32 v[240:241], v[240:241], v[24:25]
    v_pk_add_f32 v[242:243], v[242:243], v[26:27]
    v_pk_add_f32 v[244:245], v[244:245], v[28:29]
    v_pk_add_f32 v[246:247], v[246:247], v[30:31]
    v_pk_add_f32 v[248:249], v[248:249], v[32:33]
    v_pk_add_f32 v[250:251], v[250:251], v[34:35]
    s_waitcnt lgkmcnt(6)
    v_pk_add_f32 v[224:225], v[224:225], v[36:37]
    v_pk_add_f32 v[226:227], v[226:227], v[38:39]
    v_pk_add_f32 v[228:229], v[228:229], v[40:41]
    v_pk_add_f32 v[230:231], v[230:231], v[42:43]
    v_pk_add_f32 v[232:233], v[232:233], v[44:45]
    v_pk_add_f32 v[234:235], v[234:235], v[46:47]
    v_pk_add_f32 v[240:241], v[240:241], v[48:49]
    v_pk_add_f32 v[242:243], v[242:243], v[50:51]
    v_pk_add_f32 v[244:245], v[244:245], v[52:53]
    v_pk_add_f32 v[246:247], v[246:247], v[54:55]
    v_pk_add_f32 v[248:249], v[248:249], v[56:57]
    v_pk_add_f32 v[250:251], v[250:251], v[58:59]
    s_waitcnt lgkmcnt(0)
    v_pk_add_f32 v[224:225], v[224:225], v[60:61]
    v_pk_add_f32 v[226:227], v[226:227], v[62:63]
    v_pk_add_f32 v[228:229], v[228:229], v[64:65]
    v_pk_add_f32 v[230:231], v[230:231], v[66:67]
    v_pk_add_f32 v[232:233], v[232:233], v[68:69]
    v_pk_add_f32 v[234:235], v[234:235], v[70:71]
    v_pk_add_f32 v[240:241], v[240:241], v[72:73]
    v_pk_add_f32 v[242:243], v[242:243], v[74:75]
    v_pk_add_f32 v[244:245], v[244:245], v[76:77]
    v_pk_add_f32 v[246:247], v[246:247], v[78:79]
    v_pk_add_f32 v[248:249], v[248:249], v[80:81]
    v_pk_add_f32 v[250:251], v[250:251], v[82:83]
    v_mov_b32 v88, v232
    v_mov_b32 v89, v232
    v_mov_b32 v90, v248
    v_mov_b32 v91, v248
    s_nop 0
    v_permlane32_swap_b32 v88, v89
    v_permlane32_swap_b32 v90, v91
    v_rcp_f32 v88, v89
    v_rcp_f32 v90, v91
    s_nop 0
    v_mov_b32 v89, v88
    v_mov_b32 v91, v90
    v_pk_mul_f32 v[224:225], v[224:225], v[88:89]
    v_pk_mul_f32 v[226:227], v[226:227], v[88:89]
    v_pk_mul_f32 v[228:229], v[228:229], v[88:89]
    v_pk_mul_f32 v[230:231], v[230:231], v[88:89]
    v_pk_mul_f32 v[232:233], v[232:233], v[88:89]
    v_pk_mul_f32 v[234:235], v[234:235], v[88:89]
    v_cvt_pk_bf16_f32 v96, v224, v225
    v_cvt_pk_bf16_f32 v97, v226, v227
    v_cvt_pk_bf16_f32 v98, v228, v229
    v_cvt_pk_bf16_f32 v99, v230, v231
    v_cvt_pk_bf16_f32 v100, v232, v233
    v_cvt_pk_bf16_f32 v101, v234, v235
    buffer_store_dwordx4 v[96:99], v5, s[20:23], s28 offen sc1
    s_mov_b64 exec, s[42:43]
    buffer_store_dwordx2 v[100:101], v6, s[20:23], s29 offen sc1
    s_mov_b64 exec, -1
    s_add_u32 s28, s28, 32768
    s_add_u32 s29, s29, 8192
    v_pk_mul_f32 v[240:241], v[240:241], v[90:91]
    v_pk_mul_f32 v[242:243], v[242:243], v[90:91]
    v_pk_mul_f32 v[244:245], v[244:245], v[90:91]
    v_pk_mul_f32 v[246:247], v[246:247], v[90:91]
    v_pk_mul_f32 v[248:249], v[248:249], v[90:91]
    v_pk_mul_f32 v[250:251], v[250:251], v[90:91]
    v_cvt_pk_bf16_f32 v104, v240, v241
    v_cvt_pk_bf16_f32 v105, v242, v243
    v_cvt_pk_bf16_f32 v106, v244, v245
    v_cvt_pk_bf16_f32 v107, v246, v247
    v_cvt_pk_bf16_f32 v108, v248, v249
    v_cvt_pk_bf16_f32 v109, v250, v251
    buffer_store_dwordx4 v[104:107], v5, s[20:23], s28 offen sc1
    s_mov_b64 exec, s[42:43]
    buffer_store_dwordx2 v[108:109], v6, s[20:23], s29 offen sc1
    s_mov_b64 exec, -1
    s_waitcnt vmcnt(0)
    v_mov_b32 v8, s100
    v_mov_b32 v9, s101
    v_mov_b32 v10, 0
    s_mov_b64 exec, 1
    buffer_store_dwordx2 v[8:9], v10, s[20:23], s34 offen sc1
    s_mov_b64 exec, -1
    s_endpgm
parallel_sum__mha_block__mixer_token_mlp__prompt_kernel_FB:
    s_waitcnt lgkmcnt(0)
    s_mov_b64 exec, 1
    v_mov_b32 v8, 1
    ds_add_u32 v4, v8 offset:20
    s_mov_b64 exec, -1
parallel_sum__mha_block__mixer_token_mlp__prompt_kernel_s5:
    ds_read_b32 v8, v4 offset:20
    s_waitcnt lgkmcnt(0)
    v_readfirstlane_b32 s28, v8
    s_nop 0
    s_cmp_ge_u32 s28, 4
    s_cbranch_scc1 parallel_sum__mha_block__mixer_token_mlp__prompt_kernel_s5x
    s_sleep 1
    s_branch parallel_sum__mha_block__mixer_token_mlp__prompt_kernel_s5
parallel_sum__mha_block__mixer_token_mlp__prompt_kernel_s5x:
    s_mov_b64 exec, s[44:45]
    v_mov_b32 v84, 0
    v_mov_b32 v90, 0
    v_mov_b32 v96, 0
    v_mov_b32 v102, 0
    v_mov_b32 v108, 0
    v_mov_b32 v114, 0
    v_mov_b32 v120, 0
    v_mov_b32 v126, 0
    v_mov_b32 v24, 0x3f803f80
    v_mov_b32 v25, 0x3f80
    v_mov_b32 v38, 0x3f803f80
    v_mov_b32 v39, 0x3f80
    s_mov_b64 exec, -1
    v_mov_b32 v128, 0xff800000
    v_mov_b32 v129, 0xff800000
    v_mov_b32 v130, 0xff800000
    v_mov_b32 v131, 0xff800000
    v_mov_b32 v132, 0xff800000
    v_mov_b32 v133, 0xff800000
    v_mov_b32 v134, 0xff800000
    v_mov_b32 v135, 0xff800000
    s_mov_b32 s36, 16
parallel_sum__mha_block__mixer_token_mlp__prompt_kernel_FL:
    buffer_load_dwordx4 v[26:29], v5, s[20:23], s35 offen sc1
    s_mov_b64 exec, s[42:43]
    buffer_load_dwordx2 v[38:39], v6, s[20:23], s35 offen offset:1024 sc1
    s_mov_b64 exec, -1
    s_add_u32 s35, s35, 2560
    s_waitcnt vmcnt(0)
    v_mfma_f32_32x32x16_bf16 v[48:63], v[26:29], v[80:83], 0
    v_mfma_f32_32x32x8_bf16 v[48:63], v[38:39], v[84:85], v[48:63]
    s_nop 11
    v_max3_f32 v128, v128, v48, v49
    v_max3_f32 v128, v128, v50, v51
    v_max3_f32 v128, v128, v52, v53
    v_max3_f32 v128, v128, v54, v55
    v_max3_f32 v128, v128, v56, v57
    v_max3_f32 v128, v128, v58, v59
    v_max3_f32 v128, v128, v60, v61
    v_max3_f32 v128, v128, v62, v63
    v_mfma_f32_32x32x16_bf16 v[64:79], v[26:29], v[86:89], 0
    v_mfma_f32_32x32x8_bf16 v[64:79], v[38:39], v[90:91], v[64:79]
    s_nop 11
    v_max3_f32 v129, v129, v64, v65
    v_max3_f32 v129, v129, v66, v67
    v_max3_f32 v129, v129, v68, v69
    v_max3_f32 v129, v129, v70, v71
    v_max3_f32 v129, v129, v72, v73
    v_max3_f32 v129, v129, v74, v75
    v_max3_f32 v129, v129, v76, v77
    v_max3_f32 v129, v129, v78, v79
    v_mfma_f32_32x32x16_bf16 v[48:63], v[26:29], v[92:95], 0
    v_mfma_f32_32x32x8_bf16 v[48:63], v[38:39], v[96:97], v[48:63]
    s_nop 11
    v_max3_f32 v130, v130, v48, v49
    v_max3_f32 v130, v130, v50, v51
    v_max3_f32 v130, v130, v52, v53
    v_max3_f32 v130, v130, v54, v55
    v_max3_f32 v130, v130, v56, v57
    v_max3_f32 v130, v130, v58, v59
    v_max3_f32 v130, v130, v60, v61
    v_max3_f32 v130, v130, v62, v63
    v_mfma_f32_32x32x16_bf16 v[64:79], v[26:29], v[98:101], 0
    v_mfma_f32_32x32x8_bf16 v[64:79], v[38:39], v[102:103], v[64:79]
    s_nop 11
    v_max3_f32 v131, v131, v64, v65
    v_max3_f32 v131, v131, v66, v67
    v_max3_f32 v131, v131, v68, v69
    v_max3_f32 v131, v131, v70, v71
    v_max3_f32 v131, v131, v72, v73
    v_max3_f32 v131, v131, v74, v75
    v_max3_f32 v131, v131, v76, v77
    v_max3_f32 v131, v131, v78, v79
    v_mfma_f32_32x32x16_bf16 v[48:63], v[26:29], v[104:107], 0
    v_mfma_f32_32x32x8_bf16 v[48:63], v[38:39], v[108:109], v[48:63]
    s_nop 11
    v_max3_f32 v132, v132, v48, v49
    v_max3_f32 v132, v132, v50, v51
    v_max3_f32 v132, v132, v52, v53
    v_max3_f32 v132, v132, v54, v55
    v_max3_f32 v132, v132, v56, v57
    v_max3_f32 v132, v132, v58, v59
    v_max3_f32 v132, v132, v60, v61
    v_max3_f32 v132, v132, v62, v63
    v_mfma_f32_32x32x16_bf16 v[64:79], v[26:29], v[110:113], 0
    v_mfma_f32_32x32x8_bf16 v[64:79], v[38:39], v[114:115], v[64:79]
    s_nop 11
    v_max3_f32 v133, v133, v64, v65
    v_max3_f32 v133, v133, v66, v67
    v_max3_f32 v133, v133, v68, v69
    v_max3_f32 v133, v133, v70, v71
    v_max3_f32 v133, v133, v72, v73
    v_max3_f32 v133, v133, v74, v75
    v_max3_f32 v133, v133, v76, v77
    v_max3_f32 v133, v133, v78, v79
    v_mfma_f32_32x32x16_bf16 v[48:63], v[26:29], v[116:119], 0
    v_mfma_f32_32x32x8_bf16 v[48:63], v[38:39], v[120:121], v[48:63]
    s_nop 11
    v_max3_f32 v134, v134, v48, v49
    v_max3_f32 v134, v134, v50, v51
    v_max3_f32 v134, v134, v52, v53
    v_max3_f32 v134, v134, v54, v55
    v_max3_f32 v134, v134, v56, v57
    v_max3_f32 v134, v134, v58, v59
    v_max3_f32 v134, v134, v60, v61
    v_max3_f32 v134, v134, v62, v63
    v_mfma_f32_32x32x16_bf16 v[64:79], v[26:29], v[122:125], 0
    v_mfma_f32_32x32x8_bf16 v[64:79], v[38:39], v[126:127], v[64:79]
    s_nop 11
    v_max3_f32 v135, v135, v64, v65
    v_max3_f32 v135, v135, v66, v67
    v_max3_f32 v135, v135, v68, v69
    v_max3_f32 v135, v135, v70, v71
    v_max3_f32 v135, v135, v72, v73
    v_max3_f32 v135, v135, v74, v75
    v_max3_f32 v135, v135, v76, v77
    v_max3_f32 v135, v135, v78, v79
    s_sub_u32 s36, s36, 1
    s_cmp_lg_u32 s36, 0
    s_cbranch_scc1 parallel_sum__mha_block__mixer_token_mlp__prompt_kernel_FL
    v_mov_b32 v136, v128
    v_mov_b32 v137, v129
    v_mov_b32 v138, v130
    v_mov_b32 v139, v131
    v_mov_b32 v140, v132
    v_mov_b32 v141, v133
    v_mov_b32 v142, v134
    v_mov_b32 v143, v135
    s_nop 0
    v_permlane32_swap_b32 v128, v136
    v_permlane32_swap_b32 v129, v137
    v_permlane32_swap_b32 v130, v138
    v_permlane32_swap_b32 v131, v139
    v_permlane32_swap_b32 v132, v140
    v_permlane32_swap_b32 v133, v141
    v_permlane32_swap_b32 v134, v142
    v_permlane32_swap_b32 v135, v143
    v_max_f32 v128, v128, v136
    v_max_f32 v129, v129, v137
    v_max_f32 v130, v130, v138
    v_max_f32 v131, v131, v139
    v_max_f32 v132, v132, v140
    v_max_f32 v133, v133, v141
    v_max_f32 v134, v134, v142
    v_max_f32 v135, v135, v143
    s_lshl_b32 s31, s3, 1
    v_lshlrev_b32 v10, 2, v2
    s_xor_b32 s28, s31, 6
    s_lshl_b32 s28, s28, 7
    s_add_u32 s28, s28, 15360
    v_add_u32 v136, s28, v10
    s_xor_b32 s28, s31, 7
    s_lshl_b32 s28, s28, 7
    s_add_u32 s28, s28, 15360
    v_add_u32 v137, s28, v10
    s_xor_b32 s28, s31, 4
    s_lshl_b32 s28, s28, 7
    s_add_u32 s28, s28, 15360
    v_add_u32 v138, s28, v10
    s_xor_b32 s28, s31, 5
    s_lshl_b32 s28, s28, 7
    s_add_u32 s28, s28, 15360
    v_add_u32 v139, s28, v10
    s_xor_b32 s28, s31, 2
    s_lshl_b32 s28, s28, 7
    s_add_u32 s28, s28, 15360
    v_add_u32 v140, s28, v10
    s_xor_b32 s28, s31, 3
    s_lshl_b32 s28, s28, 7
    s_add_u32 s28, s28, 15360
    v_add_u32 v141, s28, v10
    s_xor_b32 s28, s31, 0
    s_lshl_b32 s28, s28, 7
    s_add_u32 s28, s28, 15360
    v_add_u32 v142, s28, v10
    s_xor_b32 s28, s31, 1
    s_lshl_b32 s28, s28, 7
    s_add_u32 s28, s28, 15360
    v_add_u32 v143, s28, v10
    v_add_u32 v8, s39, v136
    ds_write_b32 v8, v128
    v_add_u32 v8, s39, v137
    ds_write_b32 v8, v129
    v_add_u32 v8, s39, v138
    ds_write_b32 v8, v130
    v_add_u32 v8, s39, v139
    ds_write_b32 v8, v131
    v_add_u32 v8, s39, v140
    ds_write_b32 v8, v132
    v_add_u32 v8, s39, v141
    ds_write_b32 v8, v133
    v_add_u32 v8, s39, v142
    ds_write_b32 v8, v134
    v_add_u32 v8, s39, v143
    ds_write_b32 v8, v135
    s_waitcnt lgkmcnt(0)
    s_mov_b64 exec, 1
    v_mov_b32 v8, 1
    ds_add_u32 v4, v8 offset:8
    s_mov_b64 exec, -1
parallel_sum__mha_block__mixer_token_mlp__prompt_kernel_s2:
    ds_read_b32 v8, v4 offset:8
    s_waitcnt lgkmcnt(0)
    v_readfirstlane_b32 s28, v8
    s_nop 0
    s_cmp_ge_u32 s28, 4
    s_cbranch_scc1 parallel_sum__mha_block__mixer_token_mlp__prompt_kernel_s2x
    s_sleep 1
    s_branch parallel_sum__mha_block__mixer_token_mlp__prompt_kernel_s2
parallel_sum__mha_block__mixer_token_mlp__prompt_kernel_s2x:
    ds_read_b32 v144, v136 offset:0
    ds_read_b32 v145, v136 offset:18432
    ds_read_b32 v146, v136 offset:36864
    ds_read_b32 v147, v136 offset:55296
    ds_read_b32 v148, v137 offset:0
    ds_read_b32 v149, v137 offset:18432
    ds_read_b32 v150, v137 offset:36864
    ds_read_b32 v151, v137 offset:55296
    ds_read_b32 v152, v138 offset:0
    ds_read_b32 v153, v138 offset:18432
    ds_read_b32 v154, v138 offset:36864
    ds_read_b32 v155, v138 offset:55296
    ds_read_b32 v156, v139 offset:0
    ds_read_b32 v157, v139 offset:18432
    ds_read_b32 v158, v139 offset:36864
    ds_read_b32 v159, v139 offset:55296
    ds_read_b32 v160, v140 offset:0
    ds_read_b32 v161, v140 offset:18432
    ds_read_b32 v162, v140 offset:36864
    ds_read_b32 v163, v140 offset:55296
    ds_read_b32 v164, v141 offset:0
    ds_read_b32 v165, v141 offset:18432
    ds_read_b32 v166, v141 offset:36864
    ds_read_b32 v167, v141 offset:55296
    ds_read_b32 v168, v142 offset:0
    ds_read_b32 v169, v142 offset:18432
    ds_read_b32 v170, v142 offset:36864
    ds_read_b32 v171, v142 offset:55296
    ds_read_b32 v172, v143 offset:0
    ds_read_b32 v173, v143 offset:18432
    ds_read_b32 v174, v143 offset:36864
    ds_read_b32 v175, v143 offset:55296
    s_waitcnt lgkmcnt(0)
    s_mov_b64 exec, s[44:45]
    v_max3_f32 v144, v144, v145, v146
    v_max_f32 v144, v144, v147
    v_sub_f32 v144, 0, v144
    v_and_b32 v145, 0xffff0000, v144
    v_sub_f32 v144, v144, v145
    v_and_b32 v146, 0xffff0000, v144
    v_sub_f32 v144, v144, v146
    v_lshrrev_b32 v145, 16, v145
    v_or_b32 v84, v145, v146
    v_lshrrev_b32 v85, 16, v144
    v_max3_f32 v148, v148, v149, v150
    v_max_f32 v148, v148, v151
    v_sub_f32 v148, 0, v148
    v_and_b32 v149, 0xffff0000, v148
    v_sub_f32 v148, v148, v149
    v_and_b32 v150, 0xffff0000, v148
    v_sub_f32 v148, v148, v150
    v_lshrrev_b32 v149, 16, v149
    v_or_b32 v90, v149, v150
    v_lshrrev_b32 v91, 16, v148
    v_max3_f32 v152, v152, v153, v154
    v_max_f32 v152, v152, v155
    v_sub_f32 v152, 0, v152
    v_and_b32 v153, 0xffff0000, v152
    v_sub_f32 v152, v152, v153
    v_and_b32 v154, 0xffff0000, v152
    v_sub_f32 v152, v152, v154
    v_lshrrev_b32 v153, 16, v153
    v_or_b32 v96, v153, v154
    v_lshrrev_b32 v97, 16, v152
    v_max3_f32 v156, v156, v157, v158
    v_max_f32 v156, v156, v159
    v_sub_f32 v156, 0, v156
    v_and_b32 v157, 0xffff0000, v156
    v_sub_f32 v156, v156, v157
    v_and_b32 v158, 0xffff0000, v156
    v_sub_f32 v156, v156, v158
    v_lshrrev_b32 v157, 16, v157
    v_or_b32 v102, v157, v158
    v_lshrrev_b32 v103, 16, v156
    v_max3_f32 v160, v160, v161, v162
    v_max_f32 v160, v160, v163
    v_sub_f32 v160, 0, v160
    v_and_b32 v161, 0xffff0000, v160
    v_sub_f32 v160, v160, v161
    v_and_b32 v162, 0xffff0000, v160
    v_sub_f32 v160, v160, v162
    v_lshrrev_b32 v161, 16, v161
    v_or_b32 v108, v161, v162
    v_lshrrev_b32 v109, 16, v160
    v_max3_f32 v164, v164, v165, v166
    v_max_f32 v164, v164, v167
    v_sub_f32 v164, 0, v164
    v_and_b32 v165, 0xffff0000, v164
    v_sub_f32 v164, v164, v165
    v_and_b32 v166, 0xffff0000, v164
    v_sub_f32 v164, v164, v166
    v_lshrrev_b32 v165, 16, v165
    v_or_b32 v114, v165, v166
    v_lshrrev_b32 v115, 16, v164
    v_max3_f32 v168, v168, v169, v170
    v_max_f32 v168, v168, v171
    v_sub_f32 v168, 0, v168
    v_and_b32 v169, 0xffff0000, v168
    v_sub_f32 v168, v168, v169
    v_and_b32 v170, 0xffff0000, v168
    v_sub_f32 v168, v168, v170
    v_lshrrev_b32 v169, 16, v169
    v_or_b32 v120, v169, v170
    v_lshrrev_b32 v121, 16, v168
    v_max3_f32 v172, v172, v173, v174
    v_max_f32 v172, v172, v175
    v_sub_f32 v172, 0, v172
    v_and_b32 v173, 0xffff0000, v172
    v_sub_f32 v172, v172, v173
    v_and_b32 v174, 0xffff0000, v172
    v_sub_f32 v172, v172, v174
    v_lshrrev_b32 v173, 16, v173
    v_or_b32 v126, v173, v174
    v_lshrrev_b32 v127, 16, v172
    s_mov_b64 exec, -1
    v_mfma_f32_32x32x16_bf16 v[128:143], v[40:43], v[40:43], 0
    v_mfma_f32_32x32x16_bf16 v[144:159], v[40:43], v[40:43], 0
    v_mfma_f32_32x32x16_bf16 v[160:175], v[40:43], v[40:43], 0
    v_mfma_f32_32x32x16_bf16 v[176:191], v[40:43], v[40:43], 0
    v_mfma_f32_32x32x16_bf16 v[192:207], v[40:43], v[40:43], 0
    v_mfma_f32_32x32x16_bf16 v[208:223], v[40:43], v[40:43], 0
    v_mfma_f32_32x32x16_bf16 v[224:239], v[40:43], v[40:43], 0
    v_mfma_f32_32x32x16_bf16 v[240:255], v[40:43], v[40:43], 0
    v_add_u32 v8, s46, v5
    v_add_u32 v9, s46, v6
    v_add_u32 v10, s46, v7
    v_xor_b32 v0, 32, v10
    s_branch parallel_sum__mha_block__mixer_token_mlp__prompt_kernel_M
parallel_sum__mha_block__mixer_token_mlp__prompt_kernel_G:
    s_setprio 3
    s_and_b32 s10, s2, 7
    s_lshr_b32 s11, s2, 3
    v_and_b32 v2, 31, v1
    v_lshrrev_b32 v3, 5, v1
    v_mov_b32 v4, 159744
    s_mul_i32 s28, s11, 52
    s_lshr_b32 s28, s28, 8
    s_mul_i32 s29, s28, 5
    s_sub_u32 s29, s11, s29
    s_and_b32 s30, s10, 1
    s_mul_i32 s31, s30, 5
    s_add_u32 s32, s29, s31
    s_lshl_b32 s30, s30, 2
    s_lshr_b32 s31, s11, 3
    s_add_u32 s43, s30, s31
    s_lshr_b32 s30, s10, 1
    s_mul_i32 s31, s30, 6
    s_add_u32 s33, s28, s31
    s_lshl_b32 s30, s30, 3
    s_and_b32 s31, s11, 7
    s_add_u32 s42, s30, s31
    s_mov_b32 s27, s11
    s_and_b32 s40, s3, 1
    s_lshr_b32 s41, s3, 1
    s_lshl_b32 s28, s32, 1
    s_add_u32 s28, s28, s40
    s_lshl_b32 s34, s28, 17
    s_lshl_b32 s31, s3, 14
    s_add_u32 s34, s34, s31
    s_add_u32 s34, s34, 9306112
    s_mul_i32 s35, s28, 98304
    s_lshl_b32 s29, s33, 1
    s_add_u32 s29, s29, s41
    s_lshl_b32 s30, s29, 10
    s_add_u32 s35, s35, s30
    s_add_u32 s35, s35, 12582912
    s_lshl_b32 s48, s29, 6
    s_mul_i32 s47, s32, 24
    s_add_u32 s47, s47, s33
    s_lshl_b32 s47, s47, 7
    s_add_u32 s47, s47, 18972672
    s_mul_i32 s36, s3, 1572864
    s_lshl_b32 s28, s33, 7
    s_add_u32 s36, s36, s28
    s_mul_i32 s38, s3, 21504
    s_add_u32 s38, s38, 73728
    s_mul_i32 s44, s43, 245760
    s_mul_i32 s28, s3, 12288
    s_add_u32 s44, s44, s28
    s_add_u32 s44, s44, 12582912
    s_mul_i32 s45, s3, 1572864
    s_lshl_b32 s28, s42, 7
    s_add_u32 s45, s45, s28
    s_mul_i32 s28, s43, 5
    s_lshr_b32 s28, s28, 2
    s_mul_i32 s28, s28, 24
    s_mul_i32 s29, s3, 6
    s_add_u32 s28, s28, s29
    s_lshl_b32 s28, s28, 7
    s_add_u32 s46, s28, 18972672
    s_mul_i32 s29, s43, 160
    s_mul_i32 s24, s3, 204800
    s_add_u32 s24, s24, s29
    s_mul_i32 s25, s42, 81920
    s_add_u32 s25, s25, s29
    v_lshlrev_b32 v7, 4, v1
    s_lshl_b32 s28, s40, 18
    s_sub_u32 s28, 262144, s28
    v_add_u32 v51, s28, v7
    v_add_u32 v8, 131072, v7
    v_lshrrev_b32 v10, 3, v1
    v_and_b32 v12, 7, v1
    v_bfe_u32 v11, v1, 4, 2
    v_lshlrev_b32 v13, 1, v11
    v_xor_b32 v13, v13, v12
    v_lshlrev_b32 v13, 4, v13
    v_lshl_add_u32 v48, v10, 12, v13
    v_add_u32 v49, 32768, v48
    v_and_b32 v11, 1, v11
    v_lshlrev_b32 v11, 1, v11
    v_xor_b32 v11, v11, v12
    v_mul_u32_u24 v10, 3072, v10
    v_lshl_add_u32 v5, v11, 4, v10
    v_xor_b32 v11, 4, v11
    v_lshl_add_u32 v6, v11, 4, v10
    v_add_u32 v6, 24576, v6
    v_and_b32 v12, 3, v1
    v_lshlrev_b32 v12, 3, v12
    v_add_u32 v12, s38, v12
    v_bfe_u32 v10, v1, 2, 2
    v_lshrrev_b32 v11, 4, v1
    v_bfe_u32 v13, v1, 3, 2
    v_lshl_add_u32 v9, v11, 2, v10
    v_lshl_add_u32 v9, v9, 7, v12
    v_xor_b32 v44, 0, v13
    v_lshl_add_u32 v44, v44, 5, v9
    v_xor_b32 v45, 1, v13
    v_lshl_add_u32 v45, v45, 5, v9
    v_xor_b32 v46, 2, v13
    v_lshl_add_u32 v46, v46, 5, v9
    v_xor_b32 v47, 3, v13
    v_lshl_add_u32 v47, v47, 5, v9
    v_lshl_add_u32 v9, v11, 3, v10
    v_lshl_add_u32 v9, v9, 7, v12
    s_lshl_b32 s28, s41, 1
    v_xor_b32 v13, s28, v13
    v_xor_b32 v40, 0, v13
    v_lshl_add_u32 v40, v40, 5, v9
    v_xor_b32 v41, 1, v13
    v_lshl_add_u32 v41, v41, 5, v9
    v_xor_b32 v42, 2, v13
    v_lshl_add_u32 v42, v42, 5, v9
    v_xor_b32 v43, 3, v13
    v_lshl_add_u32 v43, v43, 5, v9
    v_mul_u32_u24 v9, 20, v3
    v_and_b32 v11, 1, v11
    v_lshl_add_u32 v9, v11, 2, v9
    v_add_u32 v9, v9, v10
    v_mul_u32_u24 v9, 160, v9
    v_add_u32 v62, v9, v12
    v_add_u32 v9, 16, v10
    v_mul_u32_u24 v9, 160, v9
    v_add_u32 v9, v9, v12
    v_lshrrev_b32 v11, 4, v1
    v_cmp_eq_u32 vcc, 3, v11
    v_mul_u32_u24 v11, 7168, v11
    s_nop 0
    v_cndmask_b32 v11, v11, 0, vcc
    v_add_u32 v63, v9, v11
    v_cmp_le_u32 vcc, 6, v1
    v_lshlrev_b32 v50, 7, v1
    v_add_u32 v10, 2304, v50
    v_cndmask_b32 v50, v50, v10, vcc
    v_add_u32 v10, 0, v1
    v_mul_u32_u24 v11, 6554, v10
    v_lshrrev_b32 v11, 16, v11
    v_mul_u32_u24 v12, 1120, v11
    v_lshl_add_u32 v52, v10, 4, v12
    v_add_u32 v10, 64, v1
    v_mul_u32_u24 v11, 6554, v10
    v_lshrrev_b32 v11, 16, v11
    v_mul_u32_u24 v12, 1120, v11
    v_lshl_add_u32 v53, v10, 4, v12
    v_add_u32 v10, 128, v1
    v_mul_u32_u24 v11, 6554, v10
    v_lshrrev_b32 v11, 16, v11
    v_mul_u32_u24 v12, 1120, v11
    v_lshl_add_u32 v54, v10, 4, v12
    v_add_u32 v10, 192, v1
    v_mul_u32_u24 v11, 6554, v10
    v_lshrrev_b32 v11, 16, v11
    v_mul_u32_u24 v12, 1120, v11
    v_lshl_add_u32 v55, v10, 4, v12
    v_add_u32 v10, 256, v1
    v_mul_u32_u24 v11, 6554, v10
    v_lshrrev_b32 v11, 16, v11
    v_mul_u32_u24 v12, 1120, v11
    v_lshl_add_u32 v56, v10, 4, v12
    v_and_b32 v13, 0xff, v0
    v_add_u32 v10, 0, v13
    v_mul_u32_u24 v11, 3277, v10
    v_lshrrev_b32 v11, 16, v11
    v_mul_u32_u24 v12, 1120, v11
    v_lshl_add_u32 v14, v10, 3, v12
    v_lshlrev_b32 v12, 4, v11
    v_lshl_add_u32 v12, v10, 4, v12
    v_add_u32 v19, 73728, v12
    v_lshlrev_b32 v57, 1, v11
    v_add_u32 v10, 256, v13
    v_mul_u32_u24 v11, 3277, v10
    v_lshrrev_b32 v11, 16, v11
    v_mul_u32_u24 v12, 1120, v11
    v_lshl_add_u32 v15, v10, 3, v12
    v_lshlrev_b32 v12, 4, v11
    v_lshl_add_u32 v12, v10, 4, v12
    v_add_u32 v20, 73728, v12
    v_lshlrev_b32 v58, 1, v11
    v_add_u32 v10, 512, v13
    v_mul_u32_u24 v11, 3277, v10
    v_lshrrev_b32 v11, 16, v11
    v_mul_u32_u24 v12, 1120, v11
    v_lshl_add_u32 v16, v10, 3, v12
    v_lshlrev_b32 v12, 4, v11
    v_lshl_add_u32 v12, v10, 4, v12
    v_add_u32 v21, 73728, v12
    v_lshlrev_b32 v59, 1, v11
    v_add_u32 v10, 768, v13
    v_mul_u32_u24 v11, 3277, v10
    v_lshrrev_b32 v11, 16, v11
    v_mul_u32_u24 v12, 1120, v11
    v_lshl_add_u32 v17, v10, 3, v12
    v_lshlrev_b32 v12, 4, v11
    v_lshl_add_u32 v12, v10, 4, v12
    v_add_u32 v22, 73728, v12
    v_lshlrev_b32 v60, 1, v11
    v_add_u32 v10, 1024, v13
    v_mul_u32_u24 v11, 3277, v10
    v_lshrrev_b32 v11, 16, v11
    v_mul_u32_u24 v12, 1120, v11
    v_lshl_add_u32 v18, v10, 3, v12
    v_lshlrev_b32 v12, 4, v11
    v_lshl_add_u32 v12, v10, 4, v12
    v_add_u32 v23, 73728, v12
    v_lshlrev_b32 v61, 1, v11
    v_lshrrev_b32 v13, 4, v1
    v_lshlrev_b32 v13, 3, v13
    v_mov_b32 v36, 0
    v_mov_b32 v37, 0
    v_mov_b32 v38, 0
    v_mov_b32 v39, 0
    s_mov_b32 s12, s72
    s_and_b32 s13, s73, 0xffff
    s_mov_b32 s14, 6291456
    s_mov_b32 s15, 0x20000
    s_mov_b32 s16, s74
    s_and_b32 s17, s75, 0xffff
    s_mov_b32 s18, 3072
    s_mov_b32 s19, 0x20000
    s_mov_b32 s60, s76
    s_and_b32 s61, s77, 0xffff
    s_mov_b32 s62, 6291456
    s_mov_b32 s63, 0x20000
    s_mov_b32 s64, s78
    s_and_b32 s65, s79, 0xffff
    s_mov_b32 s66, 4096
    s_mov_b32 s67, 0x20000
    s_mov_b32 s68, s4
    s_and_b32 s69, s5, 0xffff
    s_mov_b32 s70, 2621440
    s_mov_b32 s71, 0x20000
    s_mov_b32 s52, s8
    s_and_b32 s53, s9, 0xffff
    s_mov_b32 s54, 819200
    s_mov_b32 s55, 0x20000
    s_mov_b32 s56, s50
    s_and_b32 s57, s51, 0xffff
    s_mov_b32 s58, 2621440
    s_mov_b32 s59, 0x20000
    s_waitcnt vmcnt(1)
    s_mov_b32 s39, 0x40000
    s_mov_b32 exec_lo, 15
    s_mov_b32 exec_hi, 0
    s_branch parallel_sum__mha_block__mixer_token_mlp__prompt_kernel_PHC
parallel_sum__mha_block__mixer_token_mlp__prompt_kernel_PHL:
    buffer_load_dwordx2 v[212:213], v194, s[20:23], s49 offen sc1
    s_waitcnt vmcnt(0)
parallel_sum__mha_block__mixer_token_mlp__prompt_kernel_PHC:
    v_cmp_ne_u64 vcc, s[100:101], v[212:213]
    s_sub_u32 s39, s39, 1
    s_cbranch_scc1 parallel_sum__mha_block__mixer_token_mlp__prompt_kernel_PHX
    s_nop 2
    s_cbranch_vccz parallel_sum__mha_block__mixer_token_mlp__prompt_kernel_PHX
    s_sleep 2
    s_branch parallel_sum__mha_block__mixer_token_mlp__prompt_kernel_PHL
parallel_sum__mha_block__mixer_token_mlp__prompt_kernel_PHX:
    s_mov_b64 exec, -1
    s_cmp_ge_u32 s27, 30
    s_cbranch_scc1 parallel_sum__mha_block__mixer_token_mlp__prompt_kernel_G2
    buffer_load_dwordx2 v[240:241], v13, s[16:19], s48 offen offset:0
    buffer_load_dwordx2 v[242:243], v13, s[16:19], s48 offen offset:32
    s_setprio 0
    s_add_u32 m0, s38, 0
    s_add_u32 s28, s34, 65536
    buffer_load_dwordx4 v5, s[12:15], s36 offen lds
    s_add_u32 m0, s38, 1024
    buffer_load_dwordx4 v[96:99], v8, s[20:23], s34 offen sc1
    buffer_load_dwordx4 v6, s[12:15], s36 offen lds
    s_add_u32 s36, s36, 49152
    s_add_u32 m0, s38, 2048
    buffer_load_dwordx4 v[100:103], v8, s[20:23], s28 offen sc1
    buffer_load_dwordx4 v5, s[12:15], s36 offen lds
    s_add_u32 m0, s38, 3072
    buffer_load_dwordx4 v[104:107], v51, s[20:23], s34 offen sc1
    buffer_load_dwordx4 v6, s[12:15], s36 offen lds
    buffer_load_dwordx4 v[108:111], v51, s[20:23], s28 offen sc1
    s_add_u32 s36, s36, 49152
    s_add_u32 s34, s34, 1024
    v_mfma_f32_32x32x16_bf16 v[176:191], v[36:39], v[36:39], 0
    v_mfma_f32_32x32x16_bf16 v[192:207], v[36:39], v[36:39], 0
    v_mfma_f32_32x32x16_bf16 v[208:223], v[36:39], v[36:39], 0
    v_mfma_f32_32x32x16_bf16 v[224:239], v[36:39], v[36:39], 0
    s_waitcnt vmcnt(0)
    ds_read_b64_tr_b16 v[64:65], v40 offset:0
    ds_read_b64_tr_b16 v[66:67], v40 offset:512
    ds_read_b64_tr_b16 v[68:69], v41 offset:0
    ds_read_b64_tr_b16 v[70:71], v41 offset:512
    ds_read_b64_tr_b16 v[72:73], v42 offset:0
    ds_read_b64_tr_b16 v[74:75], v42 offset:512
    ds_read_b64_tr_b16 v[76:77], v43 offset:0
    ds_read_b64_tr_b16 v[78:79], v43 offset:512
    s_add_u32 m0, s38, 4096
    s_add_u32 s28, s34, 65536
    buffer_load_dwordx4 v5, s[12:15], s36 offen lds
    s_add_u32 m0, s38, 5120
    buffer_load_dwordx4 v[112:115], v8, s[20:23], s34 offen sc1
    buffer_load_dwordx4 v6, s[12:15], s36 offen lds
    s_add_u32 s36, s36, 49152
    s_add_u32 m0, s38, 6144
    buffer_load_dwordx4 v[116:119], v8, s[20:23], s28 offen sc1
    buffer_load_dwordx4 v5, s[12:15], s36 offen lds
    s_add_u32 m0, s38, 7168
    buffer_load_dwordx4 v[120:123], v51, s[20:23], s34 offen sc1
    buffer_load_dwordx4 v6, s[12:15], s36 offen lds
    buffer_load_dwordx4 v[124:127], v51, s[20:23], s28 offen sc1
    s_add_u32 s36, s36, 49152
    s_add_u32 s34, s34, 1024
    s_waitcnt vmcnt(0)
    ds_read_b64_tr_b16 v[80:81], v40 offset:4096
    ds_read_b64_tr_b16 v[82:83], v40 offset:4608
    ds_read_b64_tr_b16 v[84:85], v41 offset:4096
    ds_read_b64_tr_b16 v[86:87], v41 offset:4608
    ds_read_b64_tr_b16 v[88:89], v42 offset:4096
    ds_read_b64_tr_b16 v[90:91], v42 offset:4608
    ds_read_b64_tr_b16 v[92:93], v43 offset:4096
    ds_read_b64_tr_b16 v[94:95], v43 offset:4608
    s_waitcnt lgkmcnt(8)
    v_mfma_f32_16x16x32_bf16 v[176:179], v[64:67], v[96:99], v[176:179]
    v_mfma_f32_16x16x32_bf16 v[184:187], v[64:67], v[100:103], v[184:187]
    v_mfma_f32_16x16x32_bf16 v[192:195], v[64:67], v[104:107], v[192:195]
    v_mfma_f32_16x16x32_bf16 v[200:203], v[64:67], v[108:111], v[200:203]
    v_mfma_f32_16x16x32_bf16 v[180:183], v[68:71], v[96:99], v[180:183]
    v_mfma_f32_16x16x32_bf16 v[188:191], v[68:71], v[100:103], v[188:191]
    v_mfma_f32_16x16x32_bf16 v[196:199], v[68:71], v[104:107], v[196:199]
    v_mfma_f32_16x16x32_bf16 v[204:207], v[68:71], v[108:111], v[204:207]
    v_mfma_f32_16x16x32_bf16 v[208:211], v[72:75], v[96:99], v[208:211]
    v_mfma_f32_16x16x32_bf16 v[216:219], v[72:75], v[100:103], v[216:219]
    v_mfma_f32_16x16x32_bf16 v[224:227], v[72:75], v[104:107], v[224:227]
    v_mfma_f32_16x16x32_bf16 v[232:235], v[72:75], v[108:111], v[232:235]
    v_mfma_f32_16x16x32_bf16 v[212:215], v[76:79], v[96:99], v[212:215]
    v_mfma_f32_16x16x32_bf16 v[220:223], v[76:79], v[100:103], v[220:223]
    v_mfma_f32_16x16x32_bf16 v[228:231], v[76:79], v[104:107], v[228:231]
    v_mfma_f32_16x16x32_bf16 v[236:239], v[76:79], v[108:111], v[236:239]
    s_add_u32 m0, s38, 8192
    s_add_u32 s28, s34, 65536
    buffer_load_dwordx4 v5, s[12:15], s36 offen lds
    s_add_u32 m0, s38, 9216
    buffer_load_dwordx4 v[128:131], v8, s[20:23], s34 offen sc1
    buffer_load_dwordx4 v6, s[12:15], s36 offen lds
    s_add_u32 s36, s36, 49152
    s_add_u32 m0, s38, 10240
    buffer_load_dwordx4 v[132:135], v8, s[20:23], s28 offen sc1
    buffer_load_dwordx4 v5, s[12:15], s36 offen lds
    s_add_u32 m0, s38, 11264
    buffer_load_dwordx4 v[136:139], v51, s[20:23], s34 offen sc1
    buffer_load_dwordx4 v6, s[12:15], s36 offen lds
    buffer_load_dwordx4 v[140:143], v51, s[20:23], s28 offen sc1
    s_add_u32 s36, s36, 49152
    s_add_u32 s34, s34, 1024
    s_waitcnt vmcnt(0)
    ds_read_b64_tr_b16 v[64:65], v40 offset:8192
    ds_read_b64_tr_b16 v[66:67], v40 offset:8704
    ds_read_b64_tr_b16 v[68:69], v41 offset:8192
    ds_read_b64_tr_b16 v[70:71], v41 offset:8704
    ds_read_b64_tr_b16 v[72:73], v42 offset:8192
    ds_read_b64_tr_b16 v[74:75], v42 offset:8704
    ds_read_b64_tr_b16 v[76:77], v43 offset:8192
    ds_read_b64_tr_b16 v[78:79], v43 offset:8704
    s_waitcnt lgkmcnt(8)
    v_mfma_f32_16x16x32_bf16 v[176:179], v[80:83], v[112:115], v[176:179]
    v_mfma_f32_16x16x32_bf16 v[184:187], v[80:83], v[116:119], v[184:187]
    v_mfma_f32_16x16x32_bf16 v[192:195], v[80:83], v[120:123], v[192:195]
    v_mfma_f32_16x16x32_bf16 v[200:203], v[80:83], v[124:127], v[200:203]
    v_mfma_f32_16x16x32_bf16 v[180:183], v[84:87], v[112:115], v[180:183]
    v_mfma_f32_16x16x32_bf16 v[188:191], v[84:87], v[116:119], v[188:191]
    v_mfma_f32_16x16x32_bf16 v[196:199], v[84:87], v[120:123], v[196:199]
    v_mfma_f32_16x16x32_bf16 v[204:207], v[84:87], v[124:127], v[204:207]
    v_mfma_f32_16x16x32_bf16 v[208:211], v[88:91], v[112:115], v[208:211]
    v_mfma_f32_16x16x32_bf16 v[216:219], v[88:91], v[116:119], v[216:219]
    v_mfma_f32_16x16x32_bf16 v[224:227], v[88:91], v[120:123], v[224:227]
    v_mfma_f32_16x16x32_bf16 v[232:235], v[88:91], v[124:127], v[232:235]
    v_mfma_f32_16x16x32_bf16 v[212:215], v[92:95], v[112:115], v[212:215]
    v_mfma_f32_16x16x32_bf16 v[220:223], v[92:95], v[116:119], v[220:223]
    v_mfma_f32_16x16x32_bf16 v[228:231], v[92:95], v[120:123], v[228:231]
    v_mfma_f32_16x16x32_bf16 v[236:239], v[92:95], v[124:127], v[236:239]
    s_add_u32 m0, s38, 0
    s_add_u32 s28, s34, 65536
    buffer_load_dwordx4 v5, s[12:15], s36 offen lds
    s_add_u32 m0, s38, 1024
    buffer_load_dwordx4 v[96:99], v8, s[20:23], s34 offen sc1
    buffer_load_dwordx4 v6, s[12:15], s36 offen lds
    s_add_u32 s36, s36, 49152
    s_add_u32 m0, s38, 2048
    buffer_load_dwordx4 v[100:103], v8, s[20:23], s28 offen sc1
    buffer_load_dwordx4 v5, s[12:15], s36 offen lds
    s_add_u32 m0, s38, 3072
    buffer_load_dwordx4 v[104:107], v51, s[20:23], s34 offen sc1
    buffer_load_dwordx4 v6, s[12:15], s36 offen lds
    buffer_load_dwordx4 v[108:111], v51, s[20:23], s28 offen sc1
    s_add_u32 s36, s36, 49152
    s_add_u32 s34, s34, 1024
    s_waitcnt vmcnt(0)
    ds_read_b64_tr_b16 v[80:81], v40 offset:0
    ds_read_b64_tr_b16 v[82:83], v40 offset:512
    ds_read_b64_tr_b16 v[84:85], v41 offset:0
    ds_read_b64_tr_b16 v[86:87], v41 offset:512
    ds_read_b64_tr_b16 v[88:89], v42 offset:0
    ds_read_b64_tr_b16 v[90:91], v42 offset:512
    ds_read_b64_tr_b16 v[92:93], v43 offset:0
    ds_read_b64_tr_b16 v[94:95], v43 offset:512
    s_waitcnt lgkmcnt(8)
    v_mfma_f32_16x16x32_bf16 v[176:179], v[64:67], v[128:131], v[176:179]
    v_mfma_f32_16x16x32_bf16 v[184:187], v[64:67], v[132:135], v[184:187]
    v_mfma_f32_16x16x32_bf16 v[192:195], v[64:67], v[136:139], v[192:195]
    v_mfma_f32_16x16x32_bf16 v[200:203], v[64:67], v[140:143], v[200:203]
    v_mfma_f32_16x16x32_bf16 v[180:183], v[68:71], v[128:131], v[180:183]
    v_mfma_f32_16x16x32_bf16 v[188:191], v[68:71], v[132:135], v[188:191]
    v_mfma_f32_16x16x32_bf16 v[196:199], v[68:71], v[136:139], v[196:199]
    v_mfma_f32_16x16x32_bf16 v[204:207], v[68:71], v[140:143], v[204:207]
    v_mfma_f32_16x16x32_bf16 v[208:211], v[72:75], v[128:131], v[208:211]
    v_mfma_f32_16x16x32_bf16 v[216:219], v[72:75], v[132:135], v[216:219]
    v_mfma_f32_16x16x32_bf16 v[224:227], v[72:75], v[136:139], v[224:227]
    v_mfma_f32_16x16x32_bf16 v[232:235], v[72:75], v[140:143], v[232:235]
    v_mfma_f32_16x16x32_bf16 v[212:215], v[76:79], v[128:131], v[212:215]
    v_mfma_f32_16x16x32_bf16 v[220:223], v[76:79], v[132:135], v[220:223]
    v_mfma_f32_16x16x32_bf16 v[228:231], v[76:79], v[136:139], v[228:231]
    v_mfma_f32_16x16x32_bf16 v[236:239], v[76:79], v[140:143], v[236:239]
    s_add_u32 m0, s38, 4096
    s_add_u32 s28, s34, 65536
    buffer_load_dwordx4 v5, s[12:15], s36 offen lds
    s_add_u32 m0, s38, 5120
    buffer_load_dwordx4 v[112:115], v8, s[20:23], s34 offen sc1
    buffer_load_dwordx4 v6, s[12:15], s36 offen lds
    s_add_u32 s36, s36, 49152
    s_add_u32 m0, s38, 6144
    buffer_load_dwordx4 v[116:119], v8, s[20:23], s28 offen sc1
    buffer_load_dwordx4 v5, s[12:15], s36 offen lds
    s_add_u32 m0, s38, 7168
    buffer_load_dwordx4 v[120:123], v51, s[20:23], s34 offen sc1
    buffer_load_dwordx4 v6, s[12:15], s36 offen lds
    buffer_load_dwordx4 v[124:127], v51, s[20:23], s28 offen sc1
    s_add_u32 s36, s36, 49152
    s_add_u32 s34, s34, 1024
    s_waitcnt vmcnt(0)
    ds_read_b64_tr_b16 v[64:65], v40 offset:4096
    ds_read_b64_tr_b16 v[66:67], v40 offset:4608
    ds_read_b64_tr_b16 v[68:69], v41 offset:4096
    ds_read_b64_tr_b16 v[70:71], v41 offset:4608
    ds_read_b64_tr_b16 v[72:73], v42 offset:4096
    ds_read_b64_tr_b16 v[74:75], v42 offset:4608
    ds_read_b64_tr_b16 v[76:77], v43 offset:4096
    ds_read_b64_tr_b16 v[78:79], v43 offset:4608
    s_waitcnt lgkmcnt(8)
    v_mfma_f32_16x16x32_bf16 v[176:179], v[80:83], v[96:99], v[176:179]
    v_mfma_f32_16x16x32_bf16 v[184:187], v[80:83], v[100:103], v[184:187]
    v_mfma_f32_16x16x32_bf16 v[192:195], v[80:83], v[104:107], v[192:195]
    v_mfma_f32_16x16x32_bf16 v[200:203], v[80:83], v[108:111], v[200:203]
    v_mfma_f32_16x16x32_bf16 v[180:183], v[84:87], v[96:99], v[180:183]
    v_mfma_f32_16x16x32_bf16 v[188:191], v[84:87], v[100:103], v[188:191]
    v_mfma_f32_16x16x32_bf16 v[196:199], v[84:87], v[104:107], v[196:199]
    v_mfma_f32_16x16x32_bf16 v[204:207], v[84:87], v[108:111], v[204:207]
    v_mfma_f32_16x16x32_bf16 v[208:211], v[88:91], v[96:99], v[208:211]
    v_mfma_f32_16x16x32_bf16 v[216:219], v[88:91], v[100:103], v[216:219]
    v_mfma_f32_16x16x32_bf16 v[224:227], v[88:91], v[104:107], v[224:227]
    v_mfma_f32_16x16x32_bf16 v[232:235], v[88:91], v[108:111], v[232:235]
    v_mfma_f32_16x16x32_bf16 v[212:215], v[92:95], v[96:99], v[212:215]
    v_mfma_f32_16x16x32_bf16 v[220:223], v[92:95], v[100:103], v[220:223]
    v_mfma_f32_16x16x32_bf16 v[228:231], v[92:95], v[104:107], v[228:231]
    v_mfma_f32_16x16x32_bf16 v[236:239], v[92:95], v[108:111], v[236:239]
    s_add_u32 m0, s38, 8192
    s_add_u32 s28, s34, 65536
    buffer_load_dwordx4 v5, s[12:15], s36 offen lds
    s_add_u32 m0, s38, 9216
    buffer_load_dwordx4 v[128:131], v8, s[20:23], s34 offen sc1
    buffer_load_dwordx4 v6, s[12:15], s36 offen lds
    s_add_u32 s36, s36, 49152
    s_add_u32 m0, s38, 10240
    buffer_load_dwordx4 v[132:135], v8, s[20:23], s28 offen sc1
    buffer_load_dwordx4 v5, s[12:15], s36 offen lds
    s_add_u32 m0, s38, 11264
    buffer_load_dwordx4 v[136:139], v51, s[20:23], s34 offen sc1
    buffer_load_dwordx4 v6, s[12:15], s36 offen lds
    buffer_load_dwordx4 v[140:143], v51, s[20:23], s28 offen sc1
    s_add_u32 s36, s36, 49152
    s_add_u32 s34, s34, 1024
    s_waitcnt vmcnt(0)
    ds_read_b64_tr_b16 v[80:81], v40 offset:8192
    ds_read_b64_tr_b16 v[82:83], v40 offset:8704
    ds_read_b64_tr_b16 v[84:85], v41 offset:8192
    ds_read_b64_tr_b16 v[86:87], v41 offset:8704
    ds_read_b64_tr_b16 v[88:89], v42 offset:8192
    ds_read_b64_tr_b16 v[90:91], v42 offset:8704
    ds_read_b64_tr_b16 v[92:93], v43 offset:8192
    ds_read_b64_tr_b16 v[94:95], v43 offset:8704
    s_waitcnt lgkmcnt(8)
    v_mfma_f32_16x16x32_bf16 v[176:179], v[64:67], v[112:115], v[176:179]
    v_mfma_f32_16x16x32_bf16 v[184:187], v[64:67], v[116:119], v[184:187]
    v_mfma_f32_16x16x32_bf16 v[192:195], v[64:67], v[120:123], v[192:195]
    v_mfma_f32_16x16x32_bf16 v[200:203], v[64:67], v[124:127], v[200:203]
    v_mfma_f32_16x16x32_bf16 v[180:183], v[68:71], v[112:115], v[180:183]
    v_mfma_f32_16x16x32_bf16 v[188:191], v[68:71], v[116:119], v[188:191]
    v_mfma_f32_16x16x32_bf16 v[196:199], v[68:71], v[120:123], v[196:199]
    v_mfma_f32_16x16x32_bf16 v[204:207], v[68:71], v[124:127], v[204:207]
    v_mfma_f32_16x16x32_bf16 v[208:211], v[72:75], v[112:115], v[208:211]
    v_mfma_f32_16x16x32_bf16 v[216:219], v[72:75], v[116:119], v[216:219]
    v_mfma_f32_16x16x32_bf16 v[224:227], v[72:75], v[120:123], v[224:227]
    v_mfma_f32_16x16x32_bf16 v[232:235], v[72:75], v[124:127], v[232:235]
    v_mfma_f32_16x16x32_bf16 v[212:215], v[76:79], v[112:115], v[212:215]
    v_mfma_f32_16x16x32_bf16 v[220:223], v[76:79], v[116:119], v[220:223]
    v_mfma_f32_16x16x32_bf16 v[228:231], v[76:79], v[120:123], v[228:231]
    v_mfma_f32_16x16x32_bf16 v[236:239], v[76:79], v[124:127], v[236:239]
    s_add_u32 m0, s38, 0
    s_add_u32 s28, s34, 65536
    buffer_load_dwordx4 v5, s[12:15], s36 offen lds
    s_add_u32 m0, s38, 1024
    buffer_load_dwordx4 v[96:99], v8, s[20:23], s34 offen sc1
    buffer_load_dwordx4 v6, s[12:15], s36 offen lds
    s_add_u32 s36, s36, 49152
    s_add_u32 m0, s38, 2048
    buffer_load_dwordx4 v[100:103], v8, s[20:23], s28 offen sc1
    buffer_load_dwordx4 v5, s[12:15], s36 offen lds
    s_add_u32 m0, s38, 3072
    buffer_load_dwordx4 v[104:107], v51, s[20:23], s34 offen sc1
    buffer_load_dwordx4 v6, s[12:15], s36 offen lds
    buffer_load_dwordx4 v[108:111], v51, s[20:23], s28 offen sc1
    s_add_u32 s36, s36, 49152
    s_add_u32 s34, s34, 1024
    s_waitcnt vmcnt(0)
    ds_read_b64_tr_b16 v[64:65], v40 offset:0
    ds_read_b64_tr_b16 v[66:67], v40 offset:512
    ds_read_b64_tr_b16 v[68:69], v41 offset:0
    ds_read_b64_tr_b16 v[70:71], v41 offset:512
    ds_read_b64_tr_b16 v[72:73], v42 offset:0
    ds_read_b64_tr_b16 v[74:75], v42 offset:512
    ds_read_b64_tr_b16 v[76:77], v43 offset:0
    ds_read_b64_tr_b16 v[78:79], v43 offset:512
    s_waitcnt lgkmcnt(8)
    v_mfma_f32_16x16x32_bf16 v[176:179], v[80:83], v[128:131], v[176:179]
    v_mfma_f32_16x16x32_bf16 v[184:187], v[80:83], v[132:135], v[184:187]
    v_mfma_f32_16x16x32_bf16 v[192:195], v[80:83], v[136:139], v[192:195]
    v_mfma_f32_16x16x32_bf16 v[200:203], v[80:83], v[140:143], v[200:203]
    v_mfma_f32_16x16x32_bf16 v[180:183], v[84:87], v[128:131], v[180:183]
    v_mfma_f32_16x16x32_bf16 v[188:191], v[84:87], v[132:135], v[188:191]
    v_mfma_f32_16x16x32_bf16 v[196:199], v[84:87], v[136:139], v[196:199]
    v_mfma_f32_16x16x32_bf16 v[204:207], v[84:87], v[140:143], v[204:207]
    v_mfma_f32_16x16x32_bf16 v[208:211], v[88:91], v[128:131], v[208:211]
    v_mfma_f32_16x16x32_bf16 v[216:219], v[88:91], v[132:135], v[216:219]
    v_mfma_f32_16x16x32_bf16 v[224:227], v[88:91], v[136:139], v[224:227]
    v_mfma_f32_16x16x32_bf16 v[232:235], v[88:91], v[140:143], v[232:235]
    v_mfma_f32_16x16x32_bf16 v[212:215], v[92:95], v[128:131], v[212:215]
    v_mfma_f32_16x16x32_bf16 v[220:223], v[92:95], v[132:135], v[220:223]
    v_mfma_f32_16x16x32_bf16 v[228:231], v[92:95], v[136:139], v[228:231]
    v_mfma_f32_16x16x32_bf16 v[236:239], v[92:95], v[140:143], v[236:239]
    s_add_u32 m0, s38, 4096
    s_add_u32 s28, s34, 65536
    buffer_load_dwordx4 v5, s[12:15], s36 offen lds
    s_add_u32 m0, s38, 5120
    buffer_load_dwordx4 v[112:115], v8, s[20:23], s34 offen sc1
    buffer_load_dwordx4 v6, s[12:15], s36 offen lds
    s_add_u32 s36, s36, 49152
    s_add_u32 m0, s38, 6144
    buffer_load_dwordx4 v[116:119], v8, s[20:23], s28 offen sc1
    buffer_load_dwordx4 v5, s[12:15], s36 offen lds
    s_add_u32 m0, s38, 7168
    buffer_load_dwordx4 v[120:123], v51, s[20:23], s34 offen sc1
    buffer_load_dwordx4 v6, s[12:15], s36 offen lds
    buffer_load_dwordx4 v[124:127], v51, s[20:23], s28 offen sc1
    s_add_u32 s36, s36, 49152
    s_add_u32 s34, s34, 1024
    s_add_u32 m0, s38, 8192
    s_add_u32 s28, s34, 65536
    buffer_load_dwordx4 v5, s[12:15], s36 offen lds
    s_add_u32 m0, s38, 9216
    buffer_load_dwordx4 v[128:131], v8, s[20:23], s34 offen sc1
    buffer_load_dwordx4 v6, s[12:15], s36 offen lds
    s_add_u32 s36, s36, 49152
    s_add_u32 m0, s38, 10240
    buffer_load_dwordx4 v[132:135], v8, s[20:23], s28 offen sc1
    buffer_load_dwordx4 v5, s[12:15], s36 offen lds
    s_add_u32 m0, s38, 11264
    buffer_load_dwordx4 v[136:139], v51, s[20:23], s34 offen sc1
    buffer_load_dwordx4 v6, s[12:15], s36 offen lds
    buffer_load_dwordx4 v[140:143], v51, s[20:23], s28 offen sc1
    s_add_u32 s36, s36, 49152
    s_add_u32 s34, s34, 1024
    s_waitcnt vmcnt(8)
    ds_read_b64_tr_b16 v[80:81], v40 offset:4096
    ds_read_b64_tr_b16 v[82:83], v40 offset:4608
    ds_read_b64_tr_b16 v[84:85], v41 offset:4096
    ds_read_b64_tr_b16 v[86:87], v41 offset:4608
    ds_read_b64_tr_b16 v[88:89], v42 offset:4096
    ds_read_b64_tr_b16 v[90:91], v42 offset:4608
    ds_read_b64_tr_b16 v[92:93], v43 offset:4096
    ds_read_b64_tr_b16 v[94:95], v43 offset:4608
    s_waitcnt lgkmcnt(8)
    v_mfma_f32_16x16x32_bf16 v[176:179], v[64:67], v[96:99], v[176:179]
    v_mfma_f32_16x16x32_bf16 v[184:187], v[64:67], v[100:103], v[184:187]
    v_mfma_f32_16x16x32_bf16 v[192:195], v[64:67], v[104:107], v[192:195]
    v_mfma_f32_16x16x32_bf16 v[200:203], v[64:67], v[108:111], v[200:203]
    v_mfma_f32_16x16x32_bf16 v[180:183], v[68:71], v[96:99], v[180:183]
    v_mfma_f32_16x16x32_bf16 v[188:191], v[68:71], v[100:103], v[188:191]
    v_mfma_f32_16x16x32_bf16 v[196:199], v[68:71], v[104:107], v[196:199]
    v_mfma_f32_16x16x32_bf16 v[204:207], v[68:71], v[108:111], v[204:207]
    v_mfma_f32_16x16x32_bf16 v[208:211], v[72:75], v[96:99], v[208:211]
    v_mfma_f32_16x16x32_bf16 v[216:219], v[72:75], v[100:103], v[216:219]
    v_mfma_f32_16x16x32_bf16 v[224:227], v[72:75], v[104:107], v[224:227]
    v_mfma_f32_16x16x32_bf16 v[232:235], v[72:75], v[108:111], v[232:235]
    v_mfma_f32_16x16x32_bf16 v[212:215], v[76:79], v[96:99], v[212:215]
    v_mfma_f32_16x16x32_bf16 v[220:223], v[76:79], v[100:103], v[220:223]
    v_mfma_f32_16x16x32_bf16 v[228:231], v[76:79], v[104:107], v[228:231]
    v_mfma_f32_16x16x32_bf16 v[236:239], v[76:79], v[108:111], v[236:239]
    s_add_u32 m0, s38, 0
    s_add_u32 s28, s34, 65536
    buffer_load_dwordx4 v5, s[12:15], s36 offen lds
    s_add_u32 m0, s38, 1024
    buffer_load_dwordx4 v[96:99], v8, s[20:23], s34 offen sc1
    buffer_load_dwordx4 v6, s[12:15], s36 offen lds
    s_add_u32 s36, s36, 49152
    s_add_u32 m0, s38, 2048
    buffer_load_dwordx4 v[100:103], v8, s[20:23], s28 offen sc1
    buffer_load_dwordx4 v5, s[12:15], s36 offen lds
    s_add_u32 m0, s38, 3072
    buffer_load_dwordx4 v[104:107], v51, s[20:23], s34 offen sc1
    buffer_load_dwordx4 v6, s[12:15], s36 offen lds
    buffer_load_dwordx4 v[108:111], v51, s[20:23], s28 offen sc1
    s_add_u32 s36, s36, 49152
    s_add_u32 s34, s34, 1024
    s_waitcnt vmcnt(8)
    ds_read_b64_tr_b16 v[64:65], v40 offset:8192
    ds_read_b64_tr_b16 v[66:67], v40 offset:8704
    ds_read_b64_tr_b16 v[68:69], v41 offset:8192
    ds_read_b64_tr_b16 v[70:71], v41 offset:8704
    ds_read_b64_tr_b16 v[72:73], v42 offset:8192
    ds_read_b64_tr_b16 v[74:75], v42 offset:8704
    ds_read_b64_tr_b16 v[76:77], v43 offset:8192
    ds_read_b64_tr_b16 v[78:79], v43 offset:8704
    s_waitcnt lgkmcnt(8)
    v_mfma_f32_16x16x32_bf16 v[176:179], v[80:83], v[112:115], v[176:179]
    v_mfma_f32_16x16x32_bf16 v[184:187], v[80:83], v[116:119], v[184:187]
    v_mfma_f32_16x16x32_bf16 v[192:195], v[80:83], v[120:123], v[192:195]
    v_mfma_f32_16x16x32_bf16 v[200:203], v[80:83], v[124:127], v[200:203]
    v_mfma_f32_16x16x32_bf16 v[180:183], v[84:87], v[112:115], v[180:183]
    v_mfma_f32_16x16x32_bf16 v[188:191], v[84:87], v[116:119], v[188:191]
    v_mfma_f32_16x16x32_bf16 v[196:199], v[84:87], v[120:123], v[196:199]
    v_mfma_f32_16x16x32_bf16 v[204:207], v[84:87], v[124:127], v[204:207]
    v_mfma_f32_16x16x32_bf16 v[208:211], v[88:91], v[112:115], v[208:211]
    v_mfma_f32_16x16x32_bf16 v[216:219], v[88:91], v[116:119], v[216:219]
    v_mfma_f32_16x16x32_bf16 v[224:227], v[88:91], v[120:123], v[224:227]
    v_mfma_f32_16x16x32_bf16 v[232:235], v[88:91], v[124:127], v[232:235]
    v_mfma_f32_16x16x32_bf16 v[212:215], v[92:95], v[112:115], v[212:215]
    v_mfma_f32_16x16x32_bf16 v[220:223], v[92:95], v[116:119], v[220:223]
    v_mfma_f32_16x16x32_bf16 v[228:231], v[92:95], v[120:123], v[228:231]
    v_mfma_f32_16x16x32_bf16 v[236:239], v[92:95], v[124:127], v[236:239]
    s_add_u32 m0, s38, 4096
    s_add_u32 s28, s34, 65536
    buffer_load_dwordx4 v5, s[12:15], s36 offen lds
    s_add_u32 m0, s38, 5120
    buffer_load_dwordx4 v[112:115], v8, s[20:23], s34 offen sc1
    buffer_load_dwordx4 v6, s[12:15], s36 offen lds
    s_add_u32 s36, s36, 49152
    s_add_u32 m0, s38, 6144
    buffer_load_dwordx4 v[116:119], v8, s[20:23], s28 offen sc1
    buffer_load_dwordx4 v5, s[12:15], s36 offen lds
    s_add_u32 m0, s38, 7168
    buffer_load_dwordx4 v[120:123], v51, s[20:23], s34 offen sc1
    buffer_load_dwordx4 v6, s[12:15], s36 offen lds
    buffer_load_dwordx4 v[124:127], v51, s[20:23], s28 offen sc1
    s_add_u32 s36, s36, 49152
    s_add_u32 s34, s34, 1024
    s_waitcnt vmcnt(8)
    ds_read_b64_tr_b16 v[80:81], v40 offset:0
    ds_read_b64_tr_b16 v[82:83], v40 offset:512
    ds_read_b64_tr_b16 v[84:85], v41 offset:0
    ds_read_b64_tr_b16 v[86:87], v41 offset:512
    ds_read_b64_tr_b16 v[88:89], v42 offset:0
    ds_read_b64_tr_b16 v[90:91], v42 offset:512
    ds_read_b64_tr_b16 v[92:93], v43 offset:0
    ds_read_b64_tr_b16 v[94:95], v43 offset:512
    s_waitcnt lgkmcnt(8)
    v_mfma_f32_16x16x32_bf16 v[176:179], v[64:67], v[128:131], v[176:179]
    v_mfma_f32_16x16x32_bf16 v[184:187], v[64:67], v[132:135], v[184:187]
    v_mfma_f32_16x16x32_bf16 v[192:195], v[64:67], v[136:139], v[192:195]
    v_mfma_f32_16x16x32_bf16 v[200:203], v[64:67], v[140:143], v[200:203]
    v_mfma_f32_16x16x32_bf16 v[180:183], v[68:71], v[128:131], v[180:183]
    v_mfma_f32_16x16x32_bf16 v[188:191], v[68:71], v[132:135], v[188:191]
    v_mfma_f32_16x16x32_bf16 v[196:199], v[68:71], v[136:139], v[196:199]
    v_mfma_f32_16x16x32_bf16 v[204:207], v[68:71], v[140:143], v[204:207]
    v_mfma_f32_16x16x32_bf16 v[208:211], v[72:75], v[128:131], v[208:211]
    v_mfma_f32_16x16x32_bf16 v[216:219], v[72:75], v[132:135], v[216:219]
    v_mfma_f32_16x16x32_bf16 v[224:227], v[72:75], v[136:139], v[224:227]
    v_mfma_f32_16x16x32_bf16 v[232:235], v[72:75], v[140:143], v[232:235]
    v_mfma_f32_16x16x32_bf16 v[212:215], v[76:79], v[128:131], v[212:215]
    v_mfma_f32_16x16x32_bf16 v[220:223], v[76:79], v[132:135], v[220:223]
    v_mfma_f32_16x16x32_bf16 v[228:231], v[76:79], v[136:139], v[228:231]
    v_mfma_f32_16x16x32_bf16 v[236:239], v[76:79], v[140:143], v[236:239]
    s_add_u32 m0, s38, 8192
    s_add_u32 s28, s34, 65536
    buffer_load_dwordx4 v5, s[12:15], s36 offen lds
    s_add_u32 m0, s38, 9216
    buffer_load_dwordx4 v[128:131], v8, s[20:23], s34 offen sc1
    buffer_load_dwordx4 v6, s[12:15], s36 offen lds
    s_add_u32 s36, s36, 49152
    s_add_u32 m0, s38, 10240
    buffer_load_dwordx4 v[132:135], v8, s[20:23], s28 offen sc1
    buffer_load_dwordx4 v5, s[12:15], s36 offen lds
    s_add_u32 m0, s38, 11264
    buffer_load_dwordx4 v[136:139], v51, s[20:23], s34 offen sc1
    buffer_load_dwordx4 v6, s[12:15], s36 offen lds
    buffer_load_dwordx4 v[140:143], v51, s[20:23], s28 offen sc1
    s_add_u32 s36, s36, 49152
    s_add_u32 s34, s34, 1024
    s_waitcnt vmcnt(8)
    ds_read_b64_tr_b16 v[64:65], v40 offset:4096
    ds_read_b64_tr_b16 v[66:67], v40 offset:4608
    ds_read_b64_tr_b16 v[68:69], v41 offset:4096
    ds_read_b64_tr_b16 v[70:71], v41 offset:4608
    ds_read_b64_tr_b16 v[72:73], v42 offset:4096
    ds_read_b64_tr_b16 v[74:75], v42 offset:4608
    ds_read_b64_tr_b16 v[76:77], v43 offset:4096
    ds_read_b64_tr_b16 v[78:79], v43 offset:4608
    s_waitcnt lgkmcnt(8)
    v_mfma_f32_16x16x32_bf16 v[176:179], v[80:83], v[96:99], v[176:179]
    v_mfma_f32_16x16x32_bf16 v[184:187], v[80:83], v[100:103], v[184:187]
    v_mfma_f32_16x16x32_bf16 v[192:195], v[80:83], v[104:107], v[192:195]
    v_mfma_f32_16x16x32_bf16 v[200:203], v[80:83], v[108:111], v[200:203]
    v_mfma_f32_16x16x32_bf16 v[180:183], v[84:87], v[96:99], v[180:183]
    v_mfma_f32_16x16x32_bf16 v[188:191], v[84:87], v[100:103], v[188:191]
    v_mfma_f32_16x16x32_bf16 v[196:199], v[84:87], v[104:107], v[196:199]
    v_mfma_f32_16x16x32_bf16 v[204:207], v[84:87], v[108:111], v[204:207]
    v_mfma_f32_16x16x32_bf16 v[208:211], v[88:91], v[96:99], v[208:211]
    v_mfma_f32_16x16x32_bf16 v[216:219], v[88:91], v[100:103], v[216:219]
    v_mfma_f32_16x16x32_bf16 v[224:227], v[88:91], v[104:107], v[224:227]
    v_mfma_f32_16x16x32_bf16 v[232:235], v[88:91], v[108:111], v[232:235]
    v_mfma_f32_16x16x32_bf16 v[212:215], v[92:95], v[96:99], v[212:215]
    v_mfma_f32_16x16x32_bf16 v[220:223], v[92:95], v[100:103], v[220:223]
    v_mfma_f32_16x16x32_bf16 v[228:231], v[92:95], v[104:107], v[228:231]
    v_mfma_f32_16x16x32_bf16 v[236:239], v[92:95], v[108:111], v[236:239]
    s_add_u32 m0, s38, 0
    s_add_u32 s28, s34, 65536
    buffer_load_dwordx4 v5, s[12:15], s36 offen lds
    s_add_u32 m0, s38, 1024
    buffer_load_dwordx4 v[96:99], v8, s[20:23], s34 offen sc1
    buffer_load_dwordx4 v6, s[12:15], s36 offen lds
    s_add_u32 s36, s36, 49152
    s_add_u32 m0, s38, 2048
    buffer_load_dwordx4 v[100:103], v8, s[20:23], s28 offen sc1
    buffer_load_dwordx4 v5, s[12:15], s36 offen lds
    s_add_u32 m0, s38, 3072
    buffer_load_dwordx4 v[104:107], v51, s[20:23], s34 offen sc1
    buffer_load_dwordx4 v6, s[12:15], s36 offen lds
    buffer_load_dwordx4 v[108:111], v51, s[20:23], s28 offen sc1
    s_add_u32 s36, s36, 49152
    s_add_u32 s34, s34, 1024
    s_waitcnt vmcnt(8)
    ds_read_b64_tr_b16 v[80:81], v40 offset:8192
    ds_read_b64_tr_b16 v[82:83], v40 offset:8704
    ds_read_b64_tr_b16 v[84:85], v41 offset:8192
    ds_read_b64_tr_b16 v[86:87], v41 offset:8704
    ds_read_b64_tr_b16 v[88:89], v42 offset:8192
    ds_read_b64_tr_b16 v[90:91], v42 offset:8704
    ds_read_b64_tr_b16 v[92:93], v43 offset:8192
    ds_read_b64_tr_b16 v[94:95], v43 offset:8704
    s_waitcnt lgkmcnt(8)
    v_mfma_f32_16x16x32_bf16 v[176:179], v[64:67], v[112:115], v[176:179]
    v_mfma_f32_16x16x32_bf16 v[184:187], v[64:67], v[116:119], v[184:187]
    v_mfma_f32_16x16x32_bf16 v[192:195], v[64:67], v[120:123], v[192:195]
    v_mfma_f32_16x16x32_bf16 v[200:203], v[64:67], v[124:127], v[200:203]
    v_mfma_f32_16x16x32_bf16 v[180:183], v[68:71], v[112:115], v[180:183]
    v_mfma_f32_16x16x32_bf16 v[188:191], v[68:71], v[116:119], v[188:191]
    v_mfma_f32_16x16x32_bf16 v[196:199], v[68:71], v[120:123], v[196:199]
    v_mfma_f32_16x16x32_bf16 v[204:207], v[68:71], v[124:127], v[204:207]
    v_mfma_f32_16x16x32_bf16 v[208:211], v[72:75], v[112:115], v[208:211]
    v_mfma_f32_16x16x32_bf16 v[216:219], v[72:75], v[116:119], v[216:219]
    v_mfma_f32_16x16x32_bf16 v[224:227], v[72:75], v[120:123], v[224:227]
    v_mfma_f32_16x16x32_bf16 v[232:235], v[72:75], v[124:127], v[232:235]
    v_mfma_f32_16x16x32_bf16 v[212:215], v[76:79], v[112:115], v[212:215]
    v_mfma_f32_16x16x32_bf16 v[220:223], v[76:79], v[116:119], v[220:223]
    v_mfma_f32_16x16x32_bf16 v[228:231], v[76:79], v[120:123], v[228:231]
    v_mfma_f32_16x16x32_bf16 v[236:239], v[76:79], v[124:127], v[236:239]
    s_add_u32 m0, s38, 4096
    s_add_u32 s28, s34, 65536
    buffer_load_dwordx4 v5, s[12:15], s36 offen lds
    s_add_u32 m0, s38, 5120
    buffer_load_dwordx4 v[112:115], v8, s[20:23], s34 offen sc1
    buffer_load_dwordx4 v6, s[12:15], s36 offen lds
    s_add_u32 s36, s36, 49152
    s_add_u32 m0, s38, 6144
    buffer_load_dwordx4 v[116:119], v8, s[20:23], s28 offen sc1
    buffer_load_dwordx4 v5, s[12:15], s36 offen lds
    s_add_u32 m0, s38, 7168
    buffer_load_dwordx4 v[120:123], v51, s[20:23], s34 offen sc1
    buffer_load_dwordx4 v6, s[12:15], s36 offen lds
    buffer_load_dwordx4 v[124:127], v51, s[20:23], s28 offen sc1
    s_add_u32 s36, s36, 49152
    s_add_u32 s34, s34, 1024
    s_waitcnt vmcnt(8)
    ds_read_b64_tr_b16 v[64:65], v40 offset:0
    ds_read_b64_tr_b16 v[66:67], v40 offset:512
    ds_read_b64_tr_b16 v[68:69], v41 offset:0
    ds_read_b64_tr_b16 v[70:71], v41 offset:512
    ds_read_b64_tr_b16 v[72:73], v42 offset:0
    ds_read_b64_tr_b16 v[74:75], v42 offset:512
    ds_read_b64_tr_b16 v[76:77], v43 offset:0
    ds_read_b64_tr_b16 v[78:79], v43 offset:512
    s_waitcnt lgkmcnt(8)
    v_mfma_f32_16x16x32_bf16 v[176:179], v[80:83], v[128:131], v[176:179]
    v_mfma_f32_16x16x32_bf16 v[184:187], v[80:83], v[132:135], v[184:187]
    v_mfma_f32_16x16x32_bf16 v[192:195], v[80:83], v[136:139], v[192:195]
    v_mfma_f32_16x16x32_bf16 v[200:203], v[80:83], v[140:143], v[200:203]
    v_mfma_f32_16x16x32_bf16 v[180:183], v[84:87], v[128:131], v[180:183]
    v_mfma_f32_16x16x32_bf16 v[188:191], v[84:87], v[132:135], v[188:191]
    v_mfma_f32_16x16x32_bf16 v[196:199], v[84:87], v[136:139], v[196:199]
    v_mfma_f32_16x16x32_bf16 v[204:207], v[84:87], v[140:143], v[204:207]
    v_mfma_f32_16x16x32_bf16 v[208:211], v[88:91], v[128:131], v[208:211]
    v_mfma_f32_16x16x32_bf16 v[216:219], v[88:91], v[132:135], v[216:219]
    v_mfma_f32_16x16x32_bf16 v[224:227], v[88:91], v[136:139], v[224:227]
    v_mfma_f32_16x16x32_bf16 v[232:235], v[88:91], v[140:143], v[232:235]
    v_mfma_f32_16x16x32_bf16 v[212:215], v[92:95], v[128:131], v[212:215]
    v_mfma_f32_16x16x32_bf16 v[220:223], v[92:95], v[132:135], v[220:223]
    v_mfma_f32_16x16x32_bf16 v[228:231], v[92:95], v[136:139], v[228:231]
    v_mfma_f32_16x16x32_bf16 v[236:239], v[92:95], v[140:143], v[236:239]
    s_add_u32 m0, s38, 8192
    s_add_u32 s28, s34, 65536
    buffer_load_dwordx4 v5, s[12:15], s36 offen lds
    s_add_u32 m0, s38, 9216
    buffer_load_dwordx4 v[128:131], v8, s[20:23], s34 offen sc1
    buffer_load_dwordx4 v6, s[12:15], s36 offen lds
    s_add_u32 s36, s36, 49152
    s_add_u32 m0, s38, 10240
    buffer_load_dwordx4 v[132:135], v8, s[20:23], s28 offen sc1
    buffer_load_dwordx4 v5, s[12:15], s36 offen lds
    s_add_u32 m0, s38, 11264
    buffer_load_dwordx4 v[136:139], v51, s[20:23], s34 offen sc1
    buffer_load_dwordx4 v6, s[12:15], s36 offen lds
    buffer_load_dwordx4 v[140:143], v51, s[20:23], s28 offen sc1
    s_add_u32 s36, s36, 49152
    s_add_u32 s34, s34, 1024
    s_waitcnt vmcnt(8)
    ds_read_b64_tr_b16 v[80:81], v40 offset:4096
    ds_read_b64_tr_b16 v[82:83], v40 offset:4608
    ds_read_b64_tr_b16 v[84:85], v41 offset:4096
    ds_read_b64_tr_b16 v[86:87], v41 offset:4608
    ds_read_b64_tr_b16 v[88:89], v42 offset:4096
    ds_read_b64_tr_b16 v[90:91], v42 offset:4608
    ds_read_b64_tr_b16 v[92:93], v43 offset:4096
    ds_read_b64_tr_b16 v[94:95], v43 offset:4608
    s_waitcnt lgkmcnt(8)
    v_mfma_f32_16x16x32_bf16 v[176:179], v[64:67], v[96:99], v[176:179]
    v_mfma_f32_16x16x32_bf16 v[184:187], v[64:67], v[100:103], v[184:187]
    v_mfma_f32_16x16x32_bf16 v[192:195], v[64:67], v[104:107], v[192:195]
    v_mfma_f32_16x16x32_bf16 v[200:203], v[64:67], v[108:111], v[200:203]
    v_mfma_f32_16x16x32_bf16 v[180:183], v[68:71], v[96:99], v[180:183]
    v_mfma_f32_16x16x32_bf16 v[188:191], v[68:71], v[100:103], v[188:191]
    v_mfma_f32_16x16x32_bf16 v[196:199], v[68:71], v[104:107], v[196:199]
    v_mfma_f32_16x16x32_bf16 v[204:207], v[68:71], v[108:111], v[204:207]
    v_mfma_f32_16x16x32_bf16 v[208:211], v[72:75], v[96:99], v[208:211]
    v_mfma_f32_16x16x32_bf16 v[216:219], v[72:75], v[100:103], v[216:219]
    v_mfma_f32_16x16x32_bf16 v[224:227], v[72:75], v[104:107], v[224:227]
    v_mfma_f32_16x16x32_bf16 v[232:235], v[72:75], v[108:111], v[232:235]
    v_mfma_f32_16x16x32_bf16 v[212:215], v[76:79], v[96:99], v[212:215]
    v_mfma_f32_16x16x32_bf16 v[220:223], v[76:79], v[100:103], v[220:223]
    v_mfma_f32_16x16x32_bf16 v[228:231], v[76:79], v[104:107], v[228:231]
    v_mfma_f32_16x16x32_bf16 v[236:239], v[76:79], v[108:111], v[236:239]
    s_setprio 3
    s_getpc_b64 s[26:27]
parallel_sum__mha_block__mixer_token_mlp__prompt_kernel_pc20:
    s_sub_u32 s26, s26, parallel_sum__mha_block__mixer_token_mlp__prompt_kernel_pc20-parallel_sum__mha_block__mixer_token_mlp__prompt_kernel
    s_subb_u32 s27, s27, 0
    s_lshl_b32 s79, s11, 2
    s_add_u32 s79, s79, s3
    s_mul_i32 s79, s79, 384
    v_lshl_add_u32 v10, v1, 7, s79
    v_min_u32 v10, parallel_sum__mha_block__mixer_token_mlp__prompt_kernel_last-parallel_sum__mha_block__mixer_token_mlp__prompt_kernel, v10
    s_mov_b64 exec, 7
    global_load_dword v247, v10, s[26:27]
    s_mov_b64 exec, -1
    s_setprio 0
    s_add_u32 m0, s38, 0
    s_add_u32 s28, s34, 65536
    buffer_load_dwordx4 v5, s[12:15], s36 offen lds
    s_add_u32 m0, s38, 1024
    buffer_load_dwordx4 v[96:99], v8, s[20:23], s34 offen sc1
    buffer_load_dwordx4 v6, s[12:15], s36 offen lds
    s_add_u32 s36, s36, 49152
    s_add_u32 m0, s38, 2048
    buffer_load_dwordx4 v[100:103], v8, s[20:23], s28 offen sc1
    buffer_load_dwordx4 v5, s[12:15], s36 offen lds
    s_add_u32 m0, s38, 3072
    buffer_load_dwordx4 v[104:107], v51, s[20:23], s34 offen sc1
    buffer_load_dwordx4 v6, s[12:15], s36 offen lds
    buffer_load_dwordx4 v[108:111], v51, s[20:23], s28 offen sc1
    s_add_u32 s36, s36, 49152
    s_add_u32 s34, s34, 1024
    s_waitcnt vmcnt(9)
    ds_read_b64_tr_b16 v[64:65], v40 offset:8192
    ds_read_b64_tr_b16 v[66:67], v40 offset:8704
    ds_read_b64_tr_b16 v[68:69], v41 offset:8192
    ds_read_b64_tr_b16 v[70:71], v41 offset:8704
    ds_read_b64_tr_b16 v[72:73], v42 offset:8192
    ds_read_b64_tr_b16 v[74:75], v42 offset:8704
    ds_read_b64_tr_b16 v[76:77], v43 offset:8192
    ds_read_b64_tr_b16 v[78:79], v43 offset:8704
    s_waitcnt lgkmcnt(8)
    v_mfma_f32_16x16x32_bf16 v[176:179], v[80:83], v[112:115], v[176:179]
    v_mfma_f32_16x16x32_bf16 v[184:187], v[80:83], v[116:119], v[184:187]
    v_mfma_f32_16x16x32_bf16 v[192:195], v[80:83], v[120:123], v[192:195]
    v_mfma_f32_16x16x32_bf16 v[200:203], v[80:83], v[124:127], v[200:203]
    v_mfma_f32_16x16x32_bf16 v[180:183], v[84:87], v[112:115], v[180:183]
    v_mfma_f32_16x16x32_bf16 v[188:191], v[84:87], v[116:119], v[188:191]
    v_mfma_f32_16x16x32_bf16 v[196:199], v[84:87], v[120:123], v[196:199]
    v_mfma_f32_16x16x32_bf16 v[204:207], v[84:87], v[124:127], v[204:207]
    v_mfma_f32_16x16x32_bf16 v[208:211], v[88:91], v[112:115], v[208:211]
    v_mfma_f32_16x16x32_bf16 v[216:219], v[88:91], v[116:119], v[216:219]
    v_mfma_f32_16x16x32_bf16 v[224:227], v[88:91], v[120:123], v[224:227]
    v_mfma_f32_16x16x32_bf16 v[232:235], v[88:91], v[124:127], v[232:235]
    v_mfma_f32_16x16x32_bf16 v[212:215], v[92:95], v[112:115], v[212:215]
    v_mfma_f32_16x16x32_bf16 v[220:223], v[92:95], v[116:119], v[220:223]
    v_mfma_f32_16x16x32_bf16 v[228:231], v[92:95], v[120:123], v[228:231]
    v_mfma_f32_16x16x32_bf16 v[236:239], v[92:95], v[124:127], v[236:239]
    s_waitcnt vmcnt(0)
    ds_read_b64_tr_b16 v[80:81], v40 offset:0
    ds_read_b64_tr_b16 v[82:83], v40 offset:512
    ds_read_b64_tr_b16 v[84:85], v41 offset:0
    ds_read_b64_tr_b16 v[86:87], v41 offset:512
    ds_read_b64_tr_b16 v[88:89], v42 offset:0
    ds_read_b64_tr_b16 v[90:91], v42 offset:512
    ds_read_b64_tr_b16 v[92:93], v43 offset:0
    ds_read_b64_tr_b16 v[94:95], v43 offset:512
    s_waitcnt lgkmcnt(8)
    v_mfma_f32_16x16x32_bf16 v[176:179], v[64:67], v[128:131], v[176:179]
    v_mfma_f32_16x16x32_bf16 v[184:187], v[64:67], v[132:135], v[184:187]
    v_mfma_f32_16x16x32_bf16 v[192:195], v[64:67], v[136:139], v[192:195]
    v_mfma_f32_16x16x32_bf16 v[200:203], v[64:67], v[140:143], v[200:203]
    v_mfma_f32_16x16x32_bf16 v[180:183], v[68:71], v[128:131], v[180:183]
    v_mfma_f32_16x16x32_bf16 v[188:191], v[68:71], v[132:135], v[188:191]
    v_mfma_f32_16x16x32_bf16 v[196:199], v[68:71], v[136:139], v[196:199]
    v_mfma_f32_16x16x32_bf16 v[204:207], v[68:71], v[140:143], v[204:207]
    v_mfma_f32_16x16x32_bf16 v[208:211], v[72:75], v[128:131], v[208:211]
    v_mfma_f32_16x16x32_bf16 v[216:219], v[72:75], v[132:135], v[216:219]
    v_mfma_f32_16x16x32_bf16 v[224:227], v[72:75], v[136:139], v[224:227]
    v_mfma_f32_16x16x32_bf16 v[232:235], v[72:75], v[140:143], v[232:235]
    v_mfma_f32_16x16x32_bf16 v[212:215], v[76:79], v[128:131], v[212:215]
    v_mfma_f32_16x16x32_bf16 v[220:223], v[76:79], v[132:135], v[220:223]
    v_mfma_f32_16x16x32_bf16 v[228:231], v[76:79], v[136:139], v[228:231]
    v_mfma_f32_16x16x32_bf16 v[236:239], v[76:79], v[140:143], v[236:239]
    s_waitcnt lgkmcnt(0)
    v_mfma_f32_16x16x32_bf16 v[176:179], v[80:83], v[96:99], v[176:179]
    v_mfma_f32_16x16x32_bf16 v[184:187], v[80:83], v[100:103], v[184:187]
    v_mfma_f32_16x16x32_bf16 v[192:195], v[80:83], v[104:107], v[192:195]
    v_mfma_f32_16x16x32_bf16 v[200:203], v[80:83], v[108:111], v[200:203]
    v_mfma_f32_16x16x32_bf16 v[180:183], v[84:87], v[96:99], v[180:183]
    v_mfma_f32_16x16x32_bf16 v[188:191], v[84:87], v[100:103], v[188:191]
    v_mfma_f32_16x16x32_bf16 v[196:199], v[84:87], v[104:107], v[196:199]
    v_mfma_f32_16x16x32_bf16 v[204:207], v[84:87], v[108:111], v[204:207]
    v_mfma_f32_16x16x32_bf16 v[208:211], v[88:91], v[96:99], v[208:211]
    v_mfma_f32_16x16x32_bf16 v[216:219], v[88:91], v[100:103], v[216:219]
    v_mfma_f32_16x16x32_bf16 v[224:227], v[88:91], v[104:107], v[224:227]
    v_mfma_f32_16x16x32_bf16 v[232:235], v[88:91], v[108:111], v[232:235]
    v_mfma_f32_16x16x32_bf16 v[212:215], v[92:95], v[96:99], v[212:215]
    v_mfma_f32_16x16x32_bf16 v[220:223], v[92:95], v[100:103], v[220:223]
    v_mfma_f32_16x16x32_bf16 v[228:231], v[92:95], v[104:107], v[228:231]
    v_mfma_f32_16x16x32_bf16 v[236:239], v[92:95], v[108:111], v[236:239]
    s_setprio 3
    v_add_u32 v10, s38, v7
    s_xor_b32 s29, s3, 1
    s_mul_i32 s29, s29, 21504
    s_add_u32 s29, s29, 73728
    v_add_u32 v11, s29, v7
    s_xor_b32 s29, s3, 2
    s_mul_i32 s29, s29, 21504
    s_add_u32 s29, s29, 77824
    v_add_u32 v12, s29, v7
    s_xor_b32 s29, s3, 3
    s_mul_i32 s29, s29, 21504
    s_add_u32 s29, s29, 81920
    v_add_u32 v13, s29, v7
    ds_write_b128 v10, v[192:195] offset:0
    ds_write_b128 v10, v[196:199] offset:1024
    ds_write_b128 v10, v[200:203] offset:2048
    ds_write_b128 v10, v[204:207] offset:3072
    ds_write_b128 v10, v[208:211] offset:4096
    ds_write_b128 v10, v[212:215] offset:5120
    ds_write_b128 v10, v[216:219] offset:6144
    ds_write_b128 v10, v[220:223] offset:7168
    ds_write_b128 v10, v[224:227] offset:8192
    ds_write_b128 v10, v[228:231] offset:9216
    ds_write_b128 v10, v[232:235] offset:10240
    ds_write_b128 v10, v[236:239] offset:11264
    s_waitcnt lgkmcnt(0)
    s_mov_b64 exec, 1
    v_mov_b32 v10, 1
    ds_add_u32 v4, v10 offset:4
    s_mov_b64 exec, -1
    v_lshlrev_b32 v64, 16, v240
    v_and_b32 v65, 0xffff0000, v240
    v_lshlrev_b32 v66, 16, v241
    v_and_b32 v67, 0xffff0000, v241
    v_lshlrev_b32 v68, 16, v242
    v_and_b32 v69, 0xffff0000, v242
    v_lshlrev_b32 v70, 16, v243
    v_and_b32 v71, 0xffff0000, v243
    v_pk_add_f32 v[176:177], v[176:177], v[64:65]
    v_pk_add_f32 v[178:179], v[178:179], v[66:67]
    v_pk_add_f32 v[180:181], v[180:181], v[68:69]
    v_pk_add_f32 v[182:183], v[182:183], v[70:71]
    v_pk_add_f32 v[184:185], v[184:185], v[64:65]
    v_pk_add_f32 v[186:187], v[186:187], v[66:67]
    v_pk_add_f32 v[188:189], v[188:189], v[68:69]
    v_pk_add_f32 v[190:191], v[190:191], v[70:71]
    v_mov_b32 v64, 0xbdd2d3e8
    v_mov_b32 v65, 0xbdd2d3e8
    v_mov_b32 v66, 0xc0135761
    v_mov_b32 v67, 0xc0135761
parallel_sum__mha_block__mixer_token_mlp__prompt_kernel_s1:
    ds_read_b32 v10, v4 offset:4
    s_waitcnt lgkmcnt(0)
    v_readfirstlane_b32 s29, v10
    s_nop 0
    s_cmp_ge_u32 s29, 4
    s_cbranch_scc1 parallel_sum__mha_block__mixer_token_mlp__prompt_kernel_s1x
    s_sleep 1
    s_branch parallel_sum__mha_block__mixer_token_mlp__prompt_kernel_s1
parallel_sum__mha_block__mixer_token_mlp__prompt_kernel_s1x:
    ds_read_b128 v[96:99], v11 offset:0
    ds_read_b128 v[100:103], v11 offset:1024
    ds_read_b128 v[104:107], v11 offset:2048
    ds_read_b128 v[108:111], v11 offset:3072
    ds_read_b128 v[112:115], v12 offset:0
    ds_read_b128 v[116:119], v12 offset:1024
    ds_read_b128 v[120:123], v12 offset:2048
    ds_read_b128 v[124:127], v12 offset:3072
    ds_read_b128 v[128:131], v13 offset:0
    ds_read_b128 v[132:135], v13 offset:1024
    ds_read_b128 v[136:139], v13 offset:2048
    ds_read_b128 v[140:143], v13 offset:3072
    s_waitcnt lgkmcnt(8)
    v_pk_add_f32 v[176:177], v[176:177], v[96:97]
    v_pk_add_f32 v[178:179], v[178:179], v[98:99]
    v_pk_add_f32 v[180:181], v[180:181], v[100:101]
    v_pk_add_f32 v[182:183], v[182:183], v[102:103]
    v_pk_add_f32 v[184:185], v[184:185], v[104:105]
    v_pk_add_f32 v[186:187], v[186:187], v[106:107]
    v_pk_add_f32 v[188:189], v[188:189], v[108:109]
    v_pk_add_f32 v[190:191], v[190:191], v[110:111]
    s_waitcnt lgkmcnt(4)
    v_pk_add_f32 v[176:177], v[176:177], v[112:113]
    v_pk_add_f32 v[178:179], v[178:179], v[114:115]
    v_pk_add_f32 v[180:181], v[180:181], v[116:117]
    v_pk_add_f32 v[182:183], v[182:183], v[118:119]
    v_pk_add_f32 v[184:185], v[184:185], v[120:121]
    v_pk_add_f32 v[186:187], v[186:187], v[122:123]
    v_pk_add_f32 v[188:189], v[188:189], v[124:125]
    v_pk_add_f32 v[190:191], v[190:191], v[126:127]
    s_waitcnt lgkmcnt(0)
    v_pk_add_f32 v[176:177], v[176:177], v[128:129]
    v_pk_add_f32 v[178:179], v[178:179], v[130:131]
    v_pk_add_f32 v[180:181], v[180:181], v[132:133]
    v_pk_add_f32 v[182:183], v[182:183], v[134:135]
    v_pk_add_f32 v[184:185], v[184:185], v[136:137]
    v_pk_add_f32 v[186:187], v[186:187], v[138:139]
    v_pk_add_f32 v[188:189], v[188:189], v[140:141]
    v_pk_add_f32 v[190:191], v[190:191], v[142:143]
    s_waitcnt lgkmcnt(0)
    s_mov_b64 exec, 1
    v_mov_b32 v10, 1
    ds_add_u32 v4, v10 offset:12
    s_mov_b64 exec, -1
    v_pk_mul_f32 v[96:97], v[176:177], v[176:177]
    v_pk_mul_f32 v[98:99], v[178:179], v[178:179]
    v_pk_mul_f32 v[100:101], v[180:181], v[180:181]
    v_pk_mul_f32 v[102:103], v[182:183], v[182:183]
    v_pk_mul_f32 v[104:105], v[184:185], v[184:185]
    v_pk_mul_f32 v[106:107], v[186:187], v[186:187]
    v_pk_mul_f32 v[108:109], v[188:189], v[188:189]
    v_pk_mul_f32 v[110:111], v[190:191], v[190:191]
    v_pk_fma_f32 v[96:97], v[96:97], v[64:65], v[66:67]
    v_pk_fma_f32 v[98:99], v[98:99], v[64:65], v[66:67]
    v_pk_fma_f32 v[100:101], v[100:101], v[64:65], v[66:67]
    v_pk_fma_f32 v[102:103], v[102:103], v[64:65], v[66:67]
    v_pk_fma_f32 v[104:105], v[104:105], v[64:65], v[66:67]
    v_pk_fma_f32 v[106:107], v[106:107], v[64:65], v[66:67]
    v_pk_fma_f32 v[108:109], v[108:109], v[64:65], v[66:67]
    v_pk_fma_f32 v[110:111], v[110:111], v[64:65], v[66:67]
    v_pk_mul_f32 v[96:97], v[96:97], v[176:177]
    v_pk_mul_f32 v[98:99], v[98:99], v[178:179]
    v_pk_mul_f32 v[100:101], v[100:101], v[180:181]
    v_pk_mul_f32 v[102:103], v[102:103], v[182:183]
    v_pk_mul_f32 v[104:105], v[104:105], v[184:185]
    v_pk_mul_f32 v[106:107], v[106:107], v[186:187]
    v_pk_mul_f32 v[108:109], v[108:109], v[188:189]
    v_pk_mul_f32 v[110:111], v[110:111], v[190:191]
    v_exp_f32 v96, v96
    v_exp_f32 v97, v97
    v_exp_f32 v98, v98
    v_exp_f32 v99, v99
    v_exp_f32 v100, v100
    v_exp_f32 v101, v101
    v_exp_f32 v102, v102
    v_exp_f32 v103, v103
    v_exp_f32 v104, v104
    v_exp_f32 v105, v105
    v_exp_f32 v106, v106
    v_exp_f32 v107, v107
    v_exp_f32 v108, v108
    v_exp_f32 v109, v109
    v_exp_f32 v110, v110
    v_exp_f32 v111, v111
    v_pk_add_f32 v[96:97], v[96:97], 1.0 op_sel_hi:[1,0]
    v_pk_add_f32 v[98:99], v[98:99], 1.0 op_sel_hi:[1,0]
    v_pk_add_f32 v[100:101], v[100:101], 1.0 op_sel_hi:[1,0]
    v_pk_add_f32 v[102:103], v[102:103], 1.0 op_sel_hi:[1,0]
    v_pk_add_f32 v[104:105], v[104:105], 1.0 op_sel_hi:[1,0]
    v_pk_add_f32 v[106:107], v[106:107], 1.0 op_sel_hi:[1,0]
    v_pk_add_f32 v[108:109], v[108:109], 1.0 op_sel_hi:[1,0]
    v_pk_add_f32 v[110:111], v[110:111], 1.0 op_sel_hi:[1,0]
    v_rcp_f32 v96, v96
    v_rcp_f32 v97, v97
    v_rcp_f32 v98, v98
    v_rcp_f32 v99, v99
    v_rcp_f32 v100, v100
    v_rcp_f32 v101, v101
    v_rcp_f32 v102, v102
    v_rcp_f32 v103, v103
    v_rcp_f32 v104, v104
    v_rcp_f32 v105, v105
    v_rcp_f32 v106, v106
    v_rcp_f32 v107, v107
    v_rcp_f32 v108, v108
    v_rcp_f32 v109, v109
    v_rcp_f32 v110, v110
    v_rcp_f32 v111, v111
    v_pk_mul_f32 v[96:97], v[96:97], v[176:177]
    v_pk_mul_f32 v[98:99], v[98:99], v[178:179]
    v_pk_mul_f32 v[100:101], v[100:101], v[180:181]
    v_pk_mul_f32 v[102:103], v[102:103], v[182:183]
    v_pk_mul_f32 v[104:105], v[104:105], v[184:185]
    v_pk_mul_f32 v[106:107], v[106:107], v[186:187]
    v_pk_mul_f32 v[108:109], v[108:109], v[188:189]
    v_pk_mul_f32 v[110:111], v[110:111], v[190:191]
    v_cvt_pk_bf16_f32 v112, v96, v97
    v_cvt_pk_bf16_f32 v113, v98, v99
    v_cvt_pk_bf16_f32 v114, v100, v101
    v_cvt_pk_bf16_f32 v115, v102, v103
    v_cvt_pk_bf16_f32 v116, v104, v105
    v_cvt_pk_bf16_f32 v117, v106, v107
    v_cvt_pk_bf16_f32 v118, v108, v109
    v_cvt_pk_bf16_f32 v119, v110, v111
    s_add_u32 s28, s35, 49152
    buffer_store_dwordx4 v[112:115], v7, s[20:23], s35 offen sc1
    buffer_store_dwordx4 v[116:119], v7, s[20:23], s28 offen sc1
parallel_sum__mha_block__mixer_token_mlp__prompt_kernel_s3:
    ds_read_b32 v10, v4 offset:12
    s_waitcnt lgkmcnt(0)
    v_readfirstlane_b32 s29, v10
    s_nop 0
    s_cmp_ge_u32 s29, 4
    s_cbranch_scc1 parallel_sum__mha_block__mixer_token_mlp__prompt_kernel_s3x
    s_sleep 1
    s_branch parallel_sum__mha_block__mixer_token_mlp__prompt_kernel_s3
parallel_sum__mha_block__mixer_token_mlp__prompt_kernel_s3x:
    s_add_u32 m0, s38, 0
    s_nop 0
    buffer_load_dwordx4 v48, s[60:63], s45 offen lds
    s_add_u32 m0, s38, 1024
    s_nop 0
    buffer_load_dwordx4 v49, s[60:63], s45 offen lds
    s_add_u32 s45, s45, 65536
    s_add_u32 m0, s38, 2048
    s_nop 0
    buffer_load_dwordx4 v48, s[60:63], s45 offen lds
    s_add_u32 m0, s38, 3072
    s_nop 0
    buffer_load_dwordx4 v49, s[60:63], s45 offen lds
    s_add_u32 s45, s45, 65536
    s_add_u32 m0, s38, 4096
    s_nop 0
    buffer_load_dwordx4 v48, s[60:63], s45 offen lds
    s_add_u32 m0, s38, 5120
    s_nop 0
    buffer_load_dwordx4 v49, s[60:63], s45 offen lds
    s_add_u32 s45, s45, 65536
    s_add_u32 m0, s38, 6144
    s_nop 0
    buffer_load_dwordx4 v48, s[60:63], s45 offen lds
    s_add_u32 m0, s38, 7168
    s_nop 0
    buffer_load_dwordx4 v49, s[60:63], s45 offen lds
    s_add_u32 s45, s45, 65536
    s_add_u32 m0, s38, 8192
    s_nop 0
    buffer_load_dwordx4 v48, s[60:63], s45 offen lds
    s_add_u32 m0, s38, 9216
    s_nop 0
    buffer_load_dwordx4 v49, s[60:63], s45 offen lds
    s_add_u32 s45, s45, 65536
    s_add_u32 m0, s38, 10240
    s_nop 0
    buffer_load_dwordx4 v48, s[60:63], s45 offen lds
    s_add_u32 m0, s38, 11264
    s_nop 0
    buffer_load_dwordx4 v49, s[60:63], s45 offen lds
    s_add_u32 s45, s45, 65536
    s_waitcnt vmcnt(12)
    s_mov_b64 exec, 1
    v_mov_b32 v11, 1
    ds_add_rtn_u32 v11, v4, v11 offset:52
    s_mov_b64 exec, -1
    s_waitcnt lgkmcnt(0)
    v_readfirstlane_b32 s29, v11
    s_nop 0
    s_cmp_lg_u32 s29, 3
    s_cbranch_scc1 parallel_sum__mha_block__mixer_token_mlp__prompt_kernel_UR
    v_mov_b32 v12, s100
    v_mov_b32 v13, s101
    v_mov_b32 v11, 0
    s_mov_b64 exec, 1
    buffer_store_dwordx2 v[12:13], v11, s[20:23], s47 offen sc1
    s_mov_b64 exec, -1
parallel_sum__mha_block__mixer_token_mlp__prompt_kernel_UR:
    s_branch parallel_sum__mha_block__mixer_token_mlp__prompt_kernel_G3
parallel_sum__mha_block__mixer_token_mlp__prompt_kernel_G2:
    s_waitcnt vmcnt(0)
    s_add_u32 m0, s38, 0
    s_nop 0
    buffer_load_dwordx4 v48, s[60:63], s45 offen lds
    s_add_u32 m0, s38, 1024
    s_nop 0
    buffer_load_dwordx4 v49, s[60:63], s45 offen lds
    s_add_u32 s45, s45, 65536
    s_add_u32 m0, s38, 2048
    s_nop 0
    buffer_load_dwordx4 v48, s[60:63], s45 offen lds
    s_add_u32 m0, s38, 3072
    s_nop 0
    buffer_load_dwordx4 v49, s[60:63], s45 offen lds
    s_add_u32 s45, s45, 65536
    s_add_u32 m0, s38, 4096
    s_nop 0
    buffer_load_dwordx4 v48, s[60:63], s45 offen lds
    s_add_u32 m0, s38, 5120
    s_nop 0
    buffer_load_dwordx4 v49, s[60:63], s45 offen lds
    s_add_u32 s45, s45, 65536
    s_add_u32 m0, s38, 6144
    s_nop 0
    buffer_load_dwordx4 v48, s[60:63], s45 offen lds
    s_add_u32 m0, s38, 7168
    s_nop 0
    buffer_load_dwordx4 v49, s[60:63], s45 offen lds
    s_add_u32 s45, s45, 65536
    s_add_u32 m0, s38, 8192
    s_nop 0
    buffer_load_dwordx4 v48, s[60:63], s45 offen lds
    s_add_u32 m0, s38, 9216
    s_nop 0
    buffer_load_dwordx4 v49, s[60:63], s45 offen lds
    s_add_u32 s45, s45, 65536
    s_add_u32 m0, s38, 10240
    s_nop 0
    buffer_load_dwordx4 v48, s[60:63], s45 offen lds
    s_add_u32 m0, s38, 11264
    s_nop 0
    buffer_load_dwordx4 v49, s[60:63], s45 offen lds
    s_add_u32 s45, s45, 65536
parallel_sum__mha_block__mixer_token_mlp__prompt_kernel_G3:
    v_mfma_f32_32x32x16_bf16 v[176:191], v[36:39], v[36:39], 0
    v_mfma_f32_32x32x16_bf16 v[192:207], v[36:39], v[36:39], 0
    v_mfma_f32_32x32x16_bf16 v[208:223], v[36:39], v[36:39], 0
    v_mfma_f32_32x32x16_bf16 v[224:239], v[36:39], v[36:39], 0
    v_mfma_f32_32x32x16_bf16 v[240:255], v[36:39], v[36:39], 0
    s_lshl_b32 s31, s42, 7
    buffer_load_dwordx2 v[24:25], v14, s[68:71], s25 offen
    buffer_load_ushort v34, v57, s[64:67], s31 offen
    buffer_load_dwordx2 v[26:27], v15, s[68:71], s25 offen
    buffer_load_ushort v35, v58, s[64:67], s31 offen
    buffer_load_dwordx2 v[28:29], v16, s[68:71], s25 offen
    buffer_load_ushort v36, v59, s[64:67], s31 offen
    buffer_load_dwordx2 v[30:31], v17, s[68:71], s25 offen
    buffer_load_ushort v37, v60, s[64:67], s31 offen
    buffer_load_dwordx2 v[32:33], v18, s[68:71], s25 offen
    buffer_load_ushort v38, v61, s[64:67], s31 offen
    s_mov_b32 s39, 0x40000
parallel_sum__mha_block__mixer_token_mlp__prompt_kernel_PUL:
    s_mov_b64 exec, -1
    s_waitcnt lgkmcnt(0)
    s_mov_b64 exec, 0xfff
    buffer_load_dwordx2 v[8:9], v50, s[20:23], s46 offen sc1
    s_waitcnt vmcnt(0)
    v_cmp_ne_u64 s[26:27], s[100:101], v[8:9]
    s_sub_u32 s39, s39, 1
    s_cbranch_scc1 parallel_sum__mha_block__mixer_token_mlp__prompt_kernel_PUX
    s_and_b32 s28, s26, 0xc3
    s_cbranch_scc0 parallel_sum__mha_block__mixer_token_mlp__prompt_kernel_PUX
    s_sleep 4
    s_branch parallel_sum__mha_block__mixer_token_mlp__prompt_kernel_PUL
parallel_sum__mha_block__mixer_token_mlp__prompt_kernel_PUX:
    s_mov_b64 exec, -1
    s_setprio 0
    buffer_load_dwordx4 v[96:99], v7, s[20:23], s44 offen sc1
    s_add_u32 s28, s44, 49152
    buffer_load_dwordx4 v[100:103], v7, s[20:23], s28 offen sc1
    s_add_u32 s28, s44, 98304
    buffer_load_dwordx4 v[104:107], v7, s[20:23], s28 offen sc1
    s_add_u32 s28, s44, 147456
    buffer_load_dwordx4 v[108:111], v7, s[20:23], s28 offen sc1
    s_add_u32 s28, s44, 196608
    buffer_load_dwordx4 v[112:115], v7, s[20:23], s28 offen sc1
    s_add_u32 s44, s44, 1024
    buffer_load_dwordx4 v[116:119], v7, s[20:23], s44 offen sc1
    s_add_u32 s28, s44, 49152
    buffer_load_dwordx4 v[120:123], v7, s[20:23], s28 offen sc1
    s_add_u32 s28, s44, 98304
    buffer_load_dwordx4 v[124:127], v7, s[20:23], s28 offen sc1
    s_add_u32 s28, s44, 147456
    buffer_load_dwordx4 v[128:131], v7, s[20:23], s28 offen sc1
    s_add_u32 s28, s44, 196608
    buffer_load_dwordx4 v[132:135], v7, s[20:23], s28 offen sc1
    s_add_u32 s44, s44, 1024
    buffer_load_dwordx4 v[136:139], v7, s[20:23], s44 offen sc1
    s_add_u32 s28, s44, 49152
    buffer_load_dwordx4 v[140:143], v7, s[20:23], s28 offen sc1
    s_add_u32 s28, s44, 98304
    buffer_load_dwordx4 v[144:147], v7, s[20:23], s28 offen sc1
    s_add_u32 s28, s44, 147456
    buffer_load_dwordx4 v[148:151], v7, s[20:23], s28 offen sc1
    s_add_u32 s28, s44, 196608
    buffer_load_dwordx4 v[152:155], v7, s[20:23], s28 offen sc1
    s_add_u32 s44, s44, 1024
    ds_read_b64_tr_b16 v[64:65], v44 offset:0
    ds_read_b64_tr_b16 v[66:67], v44 offset:2048
    ds_read_b64_tr_b16 v[68:69], v45 offset:0
    ds_read_b64_tr_b16 v[70:71], v45 offset:2048
    ds_read_b64_tr_b16 v[72:73], v46 offset:0
    ds_read_b64_tr_b16 v[74:75], v46 offset:2048
    ds_read_b64_tr_b16 v[76:77], v47 offset:0
    ds_read_b64_tr_b16 v[78:79], v47 offset:2048
    s_add_u32 m0, s38, 12288
    s_nop 0
    buffer_load_dwordx4 v48, s[60:63], s45 offen lds
    s_add_u32 m0, s38, 13312
    s_nop 0
    buffer_load_dwordx4 v49, s[60:63], s45 offen lds
    s_add_u32 s45, s45, 65536
    s_add_u32 m0, s38, 14336
    s_nop 0
    buffer_load_dwordx4 v48, s[60:63], s45 offen lds
    s_add_u32 m0, s38, 15360
    s_nop 0
    buffer_load_dwordx4 v49, s[60:63], s45 offen lds
    s_add_u32 s45, s45, 65536
    buffer_load_dwordx4 v[156:159], v7, s[20:23], s44 offen sc1
    s_add_u32 s28, s44, 49152
    buffer_load_dwordx4 v[160:163], v7, s[20:23], s28 offen sc1
    s_add_u32 s28, s44, 98304
    buffer_load_dwordx4 v[164:167], v7, s[20:23], s28 offen sc1
    s_add_u32 s28, s44, 147456
    buffer_load_dwordx4 v[168:171], v7, s[20:23], s28 offen sc1
    s_add_u32 s28, s44, 196608
    buffer_load_dwordx4 v[172:175], v7, s[20:23], s28 offen sc1
    s_add_u32 s44, s44, 1024
    s_waitcnt vmcnt(19)
    s_waitcnt vmcnt(14)
    ds_read_b64_tr_b16 v[80:81], v44 offset:4096
    ds_read_b64_tr_b16 v[82:83], v44 offset:6144
    ds_read_b64_tr_b16 v[84:85], v45 offset:4096
    ds_read_b64_tr_b16 v[86:87], v45 offset:6144
    ds_read_b64_tr_b16 v[88:89], v46 offset:4096
    ds_read_b64_tr_b16 v[90:91], v46 offset:6144
    ds_read_b64_tr_b16 v[92:93], v47 offset:4096
    ds_read_b64_tr_b16 v[94:95], v47 offset:6144
    s_waitcnt lgkmcnt(8)
    v_mfma_f32_16x16x32_bf16 v[176:179], v[96:99], v[64:67], v[176:179]
    v_mfma_f32_16x16x32_bf16 v[180:183], v[96:99], v[68:71], v[180:183]
    v_mfma_f32_16x16x32_bf16 v[184:187], v[96:99], v[72:75], v[184:187]
    v_mfma_f32_16x16x32_bf16 v[188:191], v[96:99], v[76:79], v[188:191]
    v_mfma_f32_16x16x32_bf16 v[192:195], v[100:103], v[64:67], v[192:195]
    v_mfma_f32_16x16x32_bf16 v[196:199], v[100:103], v[68:71], v[196:199]
    v_mfma_f32_16x16x32_bf16 v[200:203], v[100:103], v[72:75], v[200:203]
    v_mfma_f32_16x16x32_bf16 v[204:207], v[100:103], v[76:79], v[204:207]
    v_mfma_f32_16x16x32_bf16 v[208:211], v[104:107], v[64:67], v[208:211]
    v_mfma_f32_16x16x32_bf16 v[212:215], v[104:107], v[68:71], v[212:215]
    v_mfma_f32_16x16x32_bf16 v[216:219], v[104:107], v[72:75], v[216:219]
    v_mfma_f32_16x16x32_bf16 v[220:223], v[104:107], v[76:79], v[220:223]
    v_mfma_f32_16x16x32_bf16 v[224:227], v[108:111], v[64:67], v[224:227]
    v_mfma_f32_16x16x32_bf16 v[228:231], v[108:111], v[68:71], v[228:231]
    v_mfma_f32_16x16x32_bf16 v[232:235], v[108:111], v[72:75], v[232:235]
    v_mfma_f32_16x16x32_bf16 v[236:239], v[108:111], v[76:79], v[236:239]
    v_mfma_f32_16x16x32_bf16 v[240:243], v[112:115], v[64:67], v[240:243]
    v_mfma_f32_16x16x32_bf16 v[244:247], v[112:115], v[68:71], v[244:247]
    v_mfma_f32_16x16x32_bf16 v[248:251], v[112:115], v[72:75], v[248:251]
    v_mfma_f32_16x16x32_bf16 v[252:255], v[112:115], v[76:79], v[252:255]
    s_add_u32 m0, s38, 0
    s_nop 0
    buffer_load_dwordx4 v48, s[60:63], s45 offen lds
    s_add_u32 m0, s38, 1024
    s_nop 0
    buffer_load_dwordx4 v49, s[60:63], s45 offen lds
    s_add_u32 s45, s45, 65536
    s_add_u32 m0, s38, 2048
    s_nop 0
    buffer_load_dwordx4 v48, s[60:63], s45 offen lds
    s_add_u32 m0, s38, 3072
    s_nop 0
    buffer_load_dwordx4 v49, s[60:63], s45 offen lds
    s_add_u32 s45, s45, 65536
    s_and_b32 s28, s26, 260
    s_cbranch_scc1 parallel_sum__mha_block__mixer_token_mlp__prompt_kernel_PW2
parallel_sum__mha_block__mixer_token_mlp__prompt_kernel_PR2:
    buffer_load_dwordx4 v[96:99], v7, s[20:23], s44 offen sc1
    s_add_u32 s28, s44, 49152
    buffer_load_dwordx4 v[100:103], v7, s[20:23], s28 offen sc1
    s_add_u32 s28, s44, 98304
    buffer_load_dwordx4 v[104:107], v7, s[20:23], s28 offen sc1
    s_add_u32 s28, s44, 147456
    buffer_load_dwordx4 v[108:111], v7, s[20:23], s28 offen sc1
    s_add_u32 s28, s44, 196608
    buffer_load_dwordx4 v[112:115], v7, s[20:23], s28 offen sc1
    s_add_u32 s44, s44, 1024
    s_waitcnt vmcnt(18)
    ds_read_b64_tr_b16 v[64:65], v44 offset:8192
    ds_read_b64_tr_b16 v[66:67], v44 offset:10240
    ds_read_b64_tr_b16 v[68:69], v45 offset:8192
    ds_read_b64_tr_b16 v[70:71], v45 offset:10240
    ds_read_b64_tr_b16 v[72:73], v46 offset:8192
    ds_read_b64_tr_b16 v[74:75], v46 offset:10240
    ds_read_b64_tr_b16 v[76:77], v47 offset:8192
    ds_read_b64_tr_b16 v[78:79], v47 offset:10240
    s_waitcnt lgkmcnt(8)
    v_mfma_f32_16x16x32_bf16 v[176:179], v[116:119], v[80:83], v[176:179]
    v_mfma_f32_16x16x32_bf16 v[180:183], v[116:119], v[84:87], v[180:183]
    v_mfma_f32_16x16x32_bf16 v[184:187], v[116:119], v[88:91], v[184:187]
    v_mfma_f32_16x16x32_bf16 v[188:191], v[116:119], v[92:95], v[188:191]
    v_mfma_f32_16x16x32_bf16 v[192:195], v[120:123], v[80:83], v[192:195]
    v_mfma_f32_16x16x32_bf16 v[196:199], v[120:123], v[84:87], v[196:199]
    v_mfma_f32_16x16x32_bf16 v[200:203], v[120:123], v[88:91], v[200:203]
    v_mfma_f32_16x16x32_bf16 v[204:207], v[120:123], v[92:95], v[204:207]
    v_mfma_f32_16x16x32_bf16 v[208:211], v[124:127], v[80:83], v[208:211]
    v_mfma_f32_16x16x32_bf16 v[212:215], v[124:127], v[84:87], v[212:215]
    v_mfma_f32_16x16x32_bf16 v[216:219], v[124:127], v[88:91], v[216:219]
    v_mfma_f32_16x16x32_bf16 v[220:223], v[124:127], v[92:95], v[220:223]
    v_mfma_f32_16x16x32_bf16 v[224:227], v[128:131], v[80:83], v[224:227]
    v_mfma_f32_16x16x32_bf16 v[228:231], v[128:131], v[84:87], v[228:231]
    v_mfma_f32_16x16x32_bf16 v[232:235], v[128:131], v[88:91], v[232:235]
    v_mfma_f32_16x16x32_bf16 v[236:239], v[128:131], v[92:95], v[236:239]
    v_mfma_f32_16x16x32_bf16 v[240:243], v[132:135], v[80:83], v[240:243]
    v_mfma_f32_16x16x32_bf16 v[244:247], v[132:135], v[84:87], v[244:247]
    v_mfma_f32_16x16x32_bf16 v[248:251], v[132:135], v[88:91], v[248:251]
    v_mfma_f32_16x16x32_bf16 v[252:255], v[132:135], v[92:95], v[252:255]
    s_add_u32 m0, s38, 4096
    s_nop 0
    buffer_load_dwordx4 v48, s[60:63], s45 offen lds
    s_add_u32 m0, s38, 5120
    s_nop 0
    buffer_load_dwordx4 v49, s[60:63], s45 offen lds
    s_add_u32 s45, s45, 65536
    s_add_u32 m0, s38, 6144
    s_nop 0
    buffer_load_dwordx4 v48, s[60:63], s45 offen lds
    s_add_u32 m0, s38, 7168
    s_nop 0
    buffer_load_dwordx4 v49, s[60:63], s45 offen lds
    s_add_u32 s45, s45, 65536
    buffer_load_dwordx4 v[116:119], v7, s[20:23], s44 offen sc1
    s_add_u32 s28, s44, 49152
    buffer_load_dwordx4 v[120:123], v7, s[20:23], s28 offen sc1
    s_add_u32 s28, s44, 98304
    buffer_load_dwordx4 v[124:127], v7, s[20:23], s28 offen sc1
    s_add_u32 s28, s44, 147456
    buffer_load_dwordx4 v[128:131], v7, s[20:23], s28 offen sc1
    s_add_u32 s28, s44, 196608
    buffer_load_dwordx4 v[132:135], v7, s[20:23], s28 offen sc1
    s_add_u32 s44, s44, 1024
    s_waitcnt vmcnt(18)
    ds_read_b64_tr_b16 v[80:81], v44 offset:12288
    ds_read_b64_tr_b16 v[82:83], v44 offset:14336
    ds_read_b64_tr_b16 v[84:85], v45 offset:12288
    ds_read_b64_tr_b16 v[86:87], v45 offset:14336
    ds_read_b64_tr_b16 v[88:89], v46 offset:12288
    ds_read_b64_tr_b16 v[90:91], v46 offset:14336
    ds_read_b64_tr_b16 v[92:93], v47 offset:12288
    ds_read_b64_tr_b16 v[94:95], v47 offset:14336
    s_waitcnt lgkmcnt(8)
    v_mfma_f32_16x16x32_bf16 v[176:179], v[136:139], v[64:67], v[176:179]
    v_mfma_f32_16x16x32_bf16 v[180:183], v[136:139], v[68:71], v[180:183]
    v_mfma_f32_16x16x32_bf16 v[184:187], v[136:139], v[72:75], v[184:187]
    v_mfma_f32_16x16x32_bf16 v[188:191], v[136:139], v[76:79], v[188:191]
    v_mfma_f32_16x16x32_bf16 v[192:195], v[140:143], v[64:67], v[192:195]
    v_mfma_f32_16x16x32_bf16 v[196:199], v[140:143], v[68:71], v[196:199]
    v_mfma_f32_16x16x32_bf16 v[200:203], v[140:143], v[72:75], v[200:203]
    v_mfma_f32_16x16x32_bf16 v[204:207], v[140:143], v[76:79], v[204:207]
    v_mfma_f32_16x16x32_bf16 v[208:211], v[144:147], v[64:67], v[208:211]
    v_mfma_f32_16x16x32_bf16 v[212:215], v[144:147], v[68:71], v[212:215]
    v_mfma_f32_16x16x32_bf16 v[216:219], v[144:147], v[72:75], v[216:219]
    v_mfma_f32_16x16x32_bf16 v[220:223], v[144:147], v[76:79], v[220:223]
    v_mfma_f32_16x16x32_bf16 v[224:227], v[148:151], v[64:67], v[224:227]
    v_mfma_f32_16x16x32_bf16 v[228:231], v[148:151], v[68:71], v[228:231]
    v_mfma_f32_16x16x32_bf16 v[232:235], v[148:151], v[72:75], v[232:235]
    v_mfma_f32_16x16x32_bf16 v[236:239], v[148:151], v[76:79], v[236:239]
    v_mfma_f32_16x16x32_bf16 v[240:243], v[152:155], v[64:67], v[240:243]
    v_mfma_f32_16x16x32_bf16 v[244:247], v[152:155], v[68:71], v[244:247]
    v_mfma_f32_16x16x32_bf16 v[248:251], v[152:155], v[72:75], v[248:251]
    v_mfma_f32_16x16x32_bf16 v[252:255], v[152:155], v[76:79], v[252:255]
    s_add_u32 m0, s38, 8192
    s_nop 0
    buffer_load_dwordx4 v48, s[60:63], s45 offen lds
    s_add_u32 m0, s38, 9216
    s_nop 0
    buffer_load_dwordx4 v49, s[60:63], s45 offen lds
    s_add_u32 s45, s45, 65536
    s_add_u32 m0, s38, 10240
    s_nop 0
    buffer_load_dwordx4 v48, s[60:63], s45 offen lds
    s_add_u32 m0, s38, 11264
    s_nop 0
    buffer_load_dwordx4 v49, s[60:63], s45 offen lds
    s_add_u32 s45, s45, 65536
    s_and_b32 s28, s26, 520
    s_cbranch_scc1 parallel_sum__mha_block__mixer_token_mlp__prompt_kernel_PW3
parallel_sum__mha_block__mixer_token_mlp__prompt_kernel_PR3:
    buffer_load_dwordx4 v[136:139], v7, s[20:23], s44 offen sc1
    s_add_u32 s28, s44, 49152
    buffer_load_dwordx4 v[140:143], v7, s[20:23], s28 offen sc1
    s_add_u32 s28, s44, 98304
    buffer_load_dwordx4 v[144:147], v7, s[20:23], s28 offen sc1
    s_add_u32 s28, s44, 147456
    buffer_load_dwordx4 v[148:151], v7, s[20:23], s28 offen sc1
    s_add_u32 s28, s44, 196608
    buffer_load_dwordx4 v[152:155], v7, s[20:23], s28 offen sc1
    s_add_u32 s44, s44, 1024
    s_waitcnt vmcnt(18)
    ds_read_b64_tr_b16 v[64:65], v44 offset:0
    ds_read_b64_tr_b16 v[66:67], v44 offset:2048
    ds_read_b64_tr_b16 v[68:69], v45 offset:0
    ds_read_b64_tr_b16 v[70:71], v45 offset:2048
    ds_read_b64_tr_b16 v[72:73], v46 offset:0
    ds_read_b64_tr_b16 v[74:75], v46 offset:2048
    ds_read_b64_tr_b16 v[76:77], v47 offset:0
    ds_read_b64_tr_b16 v[78:79], v47 offset:2048
    s_waitcnt lgkmcnt(8)
    v_mfma_f32_16x16x32_bf16 v[176:179], v[156:159], v[80:83], v[176:179]
    v_mfma_f32_16x16x32_bf16 v[180:183], v[156:159], v[84:87], v[180:183]
    v_mfma_f32_16x16x32_bf16 v[184:187], v[156:159], v[88:91], v[184:187]
    v_mfma_f32_16x16x32_bf16 v[188:191], v[156:159], v[92:95], v[188:191]
    v_mfma_f32_16x16x32_bf16 v[192:195], v[160:163], v[80:83], v[192:195]
    v_mfma_f32_16x16x32_bf16 v[196:199], v[160:163], v[84:87], v[196:199]
    v_mfma_f32_16x16x32_bf16 v[200:203], v[160:163], v[88:91], v[200:203]
    v_mfma_f32_16x16x32_bf16 v[204:207], v[160:163], v[92:95], v[204:207]
    v_mfma_f32_16x16x32_bf16 v[208:211], v[164:167], v[80:83], v[208:211]
    v_mfma_f32_16x16x32_bf16 v[212:215], v[164:167], v[84:87], v[212:215]
    v_mfma_f32_16x16x32_bf16 v[216:219], v[164:167], v[88:91], v[216:219]
    v_mfma_f32_16x16x32_bf16 v[220:223], v[164:167], v[92:95], v[220:223]
    v_mfma_f32_16x16x32_bf16 v[224:227], v[168:171], v[80:83], v[224:227]
    v_mfma_f32_16x16x32_bf16 v[228:231], v[168:171], v[84:87], v[228:231]
    v_mfma_f32_16x16x32_bf16 v[232:235], v[168:171], v[88:91], v[232:235]
    v_mfma_f32_16x16x32_bf16 v[236:239], v[168:171], v[92:95], v[236:239]
    v_mfma_f32_16x16x32_bf16 v[240:243], v[172:175], v[80:83], v[240:243]
    v_mfma_f32_16x16x32_bf16 v[244:247], v[172:175], v[84:87], v[244:247]
    v_mfma_f32_16x16x32_bf16 v[248:251], v[172:175], v[88:91], v[248:251]
    v_mfma_f32_16x16x32_bf16 v[252:255], v[172:175], v[92:95], v[252:255]
    s_add_u32 m0, s38, 12288
    s_nop 0
    buffer_load_dwordx4 v48, s[60:63], s45 offen lds
    s_add_u32 m0, s38, 13312
    s_nop 0
    buffer_load_dwordx4 v49, s[60:63], s45 offen lds
    s_add_u32 s45, s45, 65536
    s_add_u32 m0, s38, 14336
    s_nop 0
    buffer_load_dwordx4 v48, s[60:63], s45 offen lds
    s_add_u32 m0, s38, 15360
    s_nop 0
    buffer_load_dwordx4 v49, s[60:63], s45 offen lds
    s_add_u32 s45, s45, 65536
    buffer_load_dwordx4 v[156:159], v7, s[20:23], s44 offen sc1
    s_add_u32 s28, s44, 49152
    buffer_load_dwordx4 v[160:163], v7, s[20:23], s28 offen sc1
    s_add_u32 s28, s44, 98304
    buffer_load_dwordx4 v[164:167], v7, s[20:23], s28 offen sc1
    s_add_u32 s28, s44, 147456
    buffer_load_dwordx4 v[168:171], v7, s[20:23], s28 offen sc1
    s_add_u32 s28, s44, 196608
    buffer_load_dwordx4 v[172:175], v7, s[20:23], s28 offen sc1
    s_add_u32 s44, s44, 1024
    s_waitcnt vmcnt(18)
    ds_read_b64_tr_b16 v[80:81], v44 offset:4096
    ds_read_b64_tr_b16 v[82:83], v44 offset:6144
    ds_read_b64_tr_b16 v[84:85], v45 offset:4096
    ds_read_b64_tr_b16 v[86:87], v45 offset:6144
    ds_read_b64_tr_b16 v[88:89], v46 offset:4096
    ds_read_b64_tr_b16 v[90:91], v46 offset:6144
    ds_read_b64_tr_b16 v[92:93], v47 offset:4096
    ds_read_b64_tr_b16 v[94:95], v47 offset:6144
    s_waitcnt lgkmcnt(8)
    v_mfma_f32_16x16x32_bf16 v[176:179], v[96:99], v[64:67], v[176:179]
    v_mfma_f32_16x16x32_bf16 v[180:183], v[96:99], v[68:71], v[180:183]
    v_mfma_f32_16x16x32_bf16 v[184:187], v[96:99], v[72:75], v[184:187]
    v_mfma_f32_16x16x32_bf16 v[188:191], v[96:99], v[76:79], v[188:191]
    v_mfma_f32_16x16x32_bf16 v[192:195], v[100:103], v[64:67], v[192:195]
    v_mfma_f32_16x16x32_bf16 v[196:199], v[100:103], v[68:71], v[196:199]
    v_mfma_f32_16x16x32_bf16 v[200:203], v[100:103], v[72:75], v[200:203]
    v_mfma_f32_16x16x32_bf16 v[204:207], v[100:103], v[76:79], v[204:207]
    v_mfma_f32_16x16x32_bf16 v[208:211], v[104:107], v[64:67], v[208:211]
    v_mfma_f32_16x16x32_bf16 v[212:215], v[104:107], v[68:71], v[212:215]
    v_mfma_f32_16x16x32_bf16 v[216:219], v[104:107], v[72:75], v[216:219]
    v_mfma_f32_16x16x32_bf16 v[220:223], v[104:107], v[76:79], v[220:223]
    v_mfma_f32_16x16x32_bf16 v[224:227], v[108:111], v[64:67], v[224:227]
    v_mfma_f32_16x16x32_bf16 v[228:231], v[108:111], v[68:71], v[228:231]
    v_mfma_f32_16x16x32_bf16 v[232:235], v[108:111], v[72:75], v[232:235]
    v_mfma_f32_16x16x32_bf16 v[236:239], v[108:111], v[76:79], v[236:239]
    v_mfma_f32_16x16x32_bf16 v[240:243], v[112:115], v[64:67], v[240:243]
    v_mfma_f32_16x16x32_bf16 v[244:247], v[112:115], v[68:71], v[244:247]
    v_mfma_f32_16x16x32_bf16 v[248:251], v[112:115], v[72:75], v[248:251]
    v_mfma_f32_16x16x32_bf16 v[252:255], v[112:115], v[76:79], v[252:255]
    s_add_u32 m0, s38, 0
    s_nop 0
    buffer_load_dwordx4 v48, s[60:63], s45 offen lds
    s_add_u32 m0, s38, 1024
    s_nop 0
    buffer_load_dwordx4 v49, s[60:63], s45 offen lds
    s_add_u32 s45, s45, 65536
    s_add_u32 m0, s38, 2048
    s_nop 0
    buffer_load_dwordx4 v48, s[60:63], s45 offen lds
    s_add_u32 m0, s38, 3072
    s_nop 0
    buffer_load_dwordx4 v49, s[60:63], s45 offen lds
    s_add_u32 s45, s45, 65536
    s_and_b32 s28, s26, 1040
    s_cbranch_scc1 parallel_sum__mha_block__mixer_token_mlp__prompt_kernel_PW4
parallel_sum__mha_block__mixer_token_mlp__prompt_kernel_PR4:
    buffer_load_dwordx4 v[96:99], v7, s[20:23], s44 offen sc1
    s_add_u32 s28, s44, 49152
    buffer_load_dwordx4 v[100:103], v7, s[20:23], s28 offen sc1
    s_add_u32 s28, s44, 98304
    buffer_load_dwordx4 v[104:107], v7, s[20:23], s28 offen sc1
    s_add_u32 s28, s44, 147456
    buffer_load_dwordx4 v[108:111], v7, s[20:23], s28 offen sc1
    s_add_u32 s28, s44, 196608
    buffer_load_dwordx4 v[112:115], v7, s[20:23], s28 offen sc1
    s_add_u32 s44, s44, 1024
    s_waitcnt vmcnt(18)
    ds_read_b64_tr_b16 v[64:65], v44 offset:8192
    ds_read_b64_tr_b16 v[66:67], v44 offset:10240
    ds_read_b64_tr_b16 v[68:69], v45 offset:8192
    ds_read_b64_tr_b16 v[70:71], v45 offset:10240
    ds_read_b64_tr_b16 v[72:73], v46 offset:8192
    ds_read_b64_tr_b16 v[74:75], v46 offset:10240
    ds_read_b64_tr_b16 v[76:77], v47 offset:8192
    ds_read_b64_tr_b16 v[78:79], v47 offset:10240
    s_waitcnt lgkmcnt(8)
    v_mfma_f32_16x16x32_bf16 v[176:179], v[116:119], v[80:83], v[176:179]
    v_mfma_f32_16x16x32_bf16 v[180:183], v[116:119], v[84:87], v[180:183]
    v_mfma_f32_16x16x32_bf16 v[184:187], v[116:119], v[88:91], v[184:187]
    v_mfma_f32_16x16x32_bf16 v[188:191], v[116:119], v[92:95], v[188:191]
    v_mfma_f32_16x16x32_bf16 v[192:195], v[120:123], v[80:83], v[192:195]
    v_mfma_f32_16x16x32_bf16 v[196:199], v[120:123], v[84:87], v[196:199]
    v_mfma_f32_16x16x32_bf16 v[200:203], v[120:123], v[88:91], v[200:203]
    v_mfma_f32_16x16x32_bf16 v[204:207], v[120:123], v[92:95], v[204:207]
    v_mfma_f32_16x16x32_bf16 v[208:211], v[124:127], v[80:83], v[208:211]
    v_mfma_f32_16x16x32_bf16 v[212:215], v[124:127], v[84:87], v[212:215]
    v_mfma_f32_16x16x32_bf16 v[216:219], v[124:127], v[88:91], v[216:219]
    v_mfma_f32_16x16x32_bf16 v[220:223], v[124:127], v[92:95], v[220:223]
    v_mfma_f32_16x16x32_bf16 v[224:227], v[128:131], v[80:83], v[224:227]
    v_mfma_f32_16x16x32_bf16 v[228:231], v[128:131], v[84:87], v[228:231]
    v_mfma_f32_16x16x32_bf16 v[232:235], v[128:131], v[88:91], v[232:235]
    v_mfma_f32_16x16x32_bf16 v[236:239], v[128:131], v[92:95], v[236:239]
    v_mfma_f32_16x16x32_bf16 v[240:243], v[132:135], v[80:83], v[240:243]
    v_mfma_f32_16x16x32_bf16 v[244:247], v[132:135], v[84:87], v[244:247]
    v_mfma_f32_16x16x32_bf16 v[248:251], v[132:135], v[88:91], v[248:251]
    v_mfma_f32_16x16x32_bf16 v[252:255], v[132:135], v[92:95], v[252:255]
    s_add_u32 m0, s38, 4096
    s_nop 0
    buffer_load_dwordx4 v48, s[60:63], s45 offen lds
    s_add_u32 m0, s38, 5120
    s_nop 0
    buffer_load_dwordx4 v49, s[60:63], s45 offen lds
    s_add_u32 s45, s45, 65536
    s_add_u32 m0, s38, 6144
    s_nop 0
    buffer_load_dwordx4 v48, s[60:63], s45 offen lds
    s_add_u32 m0, s38, 7168
    s_nop 0
    buffer_load_dwordx4 v49, s[60:63], s45 offen lds
    s_add_u32 s45, s45, 65536
    buffer_load_dwordx4 v[116:119], v7, s[20:23], s44 offen sc1
    s_add_u32 s28, s44, 49152
    buffer_load_dwordx4 v[120:123], v7, s[20:23], s28 offen sc1
    s_add_u32 s28, s44, 98304
    buffer_load_dwordx4 v[124:127], v7, s[20:23], s28 offen sc1
    s_add_u32 s28, s44, 147456
    buffer_load_dwordx4 v[128:131], v7, s[20:23], s28 offen sc1
    s_add_u32 s28, s44, 196608
    buffer_load_dwordx4 v[132:135], v7, s[20:23], s28 offen sc1
    s_add_u32 s44, s44, 1024
    s_waitcnt vmcnt(18)
    ds_read_b64_tr_b16 v[80:81], v44 offset:12288
    ds_read_b64_tr_b16 v[82:83], v44 offset:14336
    ds_read_b64_tr_b16 v[84:85], v45 offset:12288
    ds_read_b64_tr_b16 v[86:87], v45 offset:14336
    ds_read_b64_tr_b16 v[88:89], v46 offset:12288
    ds_read_b64_tr_b16 v[90:91], v46 offset:14336
    ds_read_b64_tr_b16 v[92:93], v47 offset:12288
    ds_read_b64_tr_b16 v[94:95], v47 offset:14336
    s_waitcnt lgkmcnt(8)
    v_mfma_f32_16x16x32_bf16 v[176:179], v[136:139], v[64:67], v[176:179]
    v_mfma_f32_16x16x32_bf16 v[180:183], v[136:139], v[68:71], v[180:183]
    v_mfma_f32_16x16x32_bf16 v[184:187], v[136:139], v[72:75], v[184:187]
    v_mfma_f32_16x16x32_bf16 v[188:191], v[136:139], v[76:79], v[188:191]
    v_mfma_f32_16x16x32_bf16 v[192:195], v[140:143], v[64:67], v[192:195]
    v_mfma_f32_16x16x32_bf16 v[196:199], v[140:143], v[68:71], v[196:199]
    v_mfma_f32_16x16x32_bf16 v[200:203], v[140:143], v[72:75], v[200:203]
    v_mfma_f32_16x16x32_bf16 v[204:207], v[140:143], v[76:79], v[204:207]
    v_mfma_f32_16x16x32_bf16 v[208:211], v[144:147], v[64:67], v[208:211]
    v_mfma_f32_16x16x32_bf16 v[212:215], v[144:147], v[68:71], v[212:215]
    v_mfma_f32_16x16x32_bf16 v[216:219], v[144:147], v[72:75], v[216:219]
    v_mfma_f32_16x16x32_bf16 v[220:223], v[144:147], v[76:79], v[220:223]
    v_mfma_f32_16x16x32_bf16 v[224:227], v[148:151], v[64:67], v[224:227]
    v_mfma_f32_16x16x32_bf16 v[228:231], v[148:151], v[68:71], v[228:231]
    v_mfma_f32_16x16x32_bf16 v[232:235], v[148:151], v[72:75], v[232:235]
    v_mfma_f32_16x16x32_bf16 v[236:239], v[148:151], v[76:79], v[236:239]
    v_mfma_f32_16x16x32_bf16 v[240:243], v[152:155], v[64:67], v[240:243]
    v_mfma_f32_16x16x32_bf16 v[244:247], v[152:155], v[68:71], v[244:247]
    v_mfma_f32_16x16x32_bf16 v[248:251], v[152:155], v[72:75], v[248:251]
    v_mfma_f32_16x16x32_bf16 v[252:255], v[152:155], v[76:79], v[252:255]
    s_add_u32 m0, s38, 8192
    s_nop 0
    buffer_load_dwordx4 v48, s[60:63], s45 offen lds
    s_add_u32 m0, s38, 9216
    s_nop 0
    buffer_load_dwordx4 v49, s[60:63], s45 offen lds
    s_add_u32 s45, s45, 65536
    s_add_u32 m0, s38, 10240
    s_nop 0
    buffer_load_dwordx4 v48, s[60:63], s45 offen lds
    s_add_u32 m0, s38, 11264
    s_nop 0
    buffer_load_dwordx4 v49, s[60:63], s45 offen lds
    s_add_u32 s45, s45, 65536
    s_and_b32 s28, s26, 2080
    s_cbranch_scc1 parallel_sum__mha_block__mixer_token_mlp__prompt_kernel_PW5
parallel_sum__mha_block__mixer_token_mlp__prompt_kernel_PR5:
    buffer_load_dwordx4 v[136:139], v7, s[20:23], s44 offen sc1
    s_add_u32 s28, s44, 49152
    buffer_load_dwordx4 v[140:143], v7, s[20:23], s28 offen sc1
    s_add_u32 s28, s44, 98304
    buffer_load_dwordx4 v[144:147], v7, s[20:23], s28 offen sc1
    s_add_u32 s28, s44, 147456
    buffer_load_dwordx4 v[148:151], v7, s[20:23], s28 offen sc1
    s_add_u32 s28, s44, 196608
    buffer_load_dwordx4 v[152:155], v7, s[20:23], s28 offen sc1
    s_add_u32 s44, s44, 1024
    s_waitcnt vmcnt(18)
    ds_read_b64_tr_b16 v[64:65], v44 offset:0
    ds_read_b64_tr_b16 v[66:67], v44 offset:2048
    ds_read_b64_tr_b16 v[68:69], v45 offset:0
    ds_read_b64_tr_b16 v[70:71], v45 offset:2048
    ds_read_b64_tr_b16 v[72:73], v46 offset:0
    ds_read_b64_tr_b16 v[74:75], v46 offset:2048
    ds_read_b64_tr_b16 v[76:77], v47 offset:0
    ds_read_b64_tr_b16 v[78:79], v47 offset:2048
    s_waitcnt lgkmcnt(8)
    v_mfma_f32_16x16x32_bf16 v[176:179], v[156:159], v[80:83], v[176:179]
    v_mfma_f32_16x16x32_bf16 v[180:183], v[156:159], v[84:87], v[180:183]
    v_mfma_f32_16x16x32_bf16 v[184:187], v[156:159], v[88:91], v[184:187]
    v_mfma_f32_16x16x32_bf16 v[188:191], v[156:159], v[92:95], v[188:191]
    v_mfma_f32_16x16x32_bf16 v[192:195], v[160:163], v[80:83], v[192:195]
    v_mfma_f32_16x16x32_bf16 v[196:199], v[160:163], v[84:87], v[196:199]
    v_mfma_f32_16x16x32_bf16 v[200:203], v[160:163], v[88:91], v[200:203]
    v_mfma_f32_16x16x32_bf16 v[204:207], v[160:163], v[92:95], v[204:207]
    v_mfma_f32_16x16x32_bf16 v[208:211], v[164:167], v[80:83], v[208:211]
    v_mfma_f32_16x16x32_bf16 v[212:215], v[164:167], v[84:87], v[212:215]
    v_mfma_f32_16x16x32_bf16 v[216:219], v[164:167], v[88:91], v[216:219]
    v_mfma_f32_16x16x32_bf16 v[220:223], v[164:167], v[92:95], v[220:223]
    v_mfma_f32_16x16x32_bf16 v[224:227], v[168:171], v[80:83], v[224:227]
    v_mfma_f32_16x16x32_bf16 v[228:231], v[168:171], v[84:87], v[228:231]
    v_mfma_f32_16x16x32_bf16 v[232:235], v[168:171], v[88:91], v[232:235]
    v_mfma_f32_16x16x32_bf16 v[236:239], v[168:171], v[92:95], v[236:239]
    v_mfma_f32_16x16x32_bf16 v[240:243], v[172:175], v[80:83], v[240:243]
    v_mfma_f32_16x16x32_bf16 v[244:247], v[172:175], v[84:87], v[244:247]
    v_mfma_f32_16x16x32_bf16 v[248:251], v[172:175], v[88:91], v[248:251]
    v_mfma_f32_16x16x32_bf16 v[252:255], v[172:175], v[92:95], v[252:255]
    s_add_u32 m0, s38, 12288
    s_nop 0
    buffer_load_dwordx4 v48, s[60:63], s45 offen lds
    s_add_u32 m0, s38, 13312
    s_nop 0
    buffer_load_dwordx4 v49, s[60:63], s45 offen lds
    s_add_u32 s45, s45, 65536
    s_add_u32 m0, s38, 14336
    s_nop 0
    buffer_load_dwordx4 v48, s[60:63], s45 offen lds
    s_add_u32 m0, s38, 15360
    s_nop 0
    buffer_load_dwordx4 v49, s[60:63], s45 offen lds
    s_add_u32 s45, s45, 65536
    buffer_load_dwordx4 v[156:159], v7, s[20:23], s44 offen sc1
    s_add_u32 s28, s44, 49152
    buffer_load_dwordx4 v[160:163], v7, s[20:23], s28 offen sc1
    s_add_u32 s28, s44, 98304
    buffer_load_dwordx4 v[164:167], v7, s[20:23], s28 offen sc1
    s_add_u32 s28, s44, 147456
    buffer_load_dwordx4 v[168:171], v7, s[20:23], s28 offen sc1
    s_add_u32 s28, s44, 196608
    buffer_load_dwordx4 v[172:175], v7, s[20:23], s28 offen sc1
    s_add_u32 s44, s44, 1024
    s_waitcnt vmcnt(18)
    ds_read_b64_tr_b16 v[80:81], v44 offset:4096
    ds_read_b64_tr_b16 v[82:83], v44 offset:6144
    ds_read_b64_tr_b16 v[84:85], v45 offset:4096
    ds_read_b64_tr_b16 v[86:87], v45 offset:6144
    ds_read_b64_tr_b16 v[88:89], v46 offset:4096
    ds_read_b64_tr_b16 v[90:91], v46 offset:6144
    ds_read_b64_tr_b16 v[92:93], v47 offset:4096
    ds_read_b64_tr_b16 v[94:95], v47 offset:6144
    s_waitcnt lgkmcnt(8)
    v_mfma_f32_16x16x32_bf16 v[176:179], v[96:99], v[64:67], v[176:179]
    v_mfma_f32_16x16x32_bf16 v[180:183], v[96:99], v[68:71], v[180:183]
    v_mfma_f32_16x16x32_bf16 v[184:187], v[96:99], v[72:75], v[184:187]
    v_mfma_f32_16x16x32_bf16 v[188:191], v[96:99], v[76:79], v[188:191]
    v_mfma_f32_16x16x32_bf16 v[192:195], v[100:103], v[64:67], v[192:195]
    v_mfma_f32_16x16x32_bf16 v[196:199], v[100:103], v[68:71], v[196:199]
    v_mfma_f32_16x16x32_bf16 v[200:203], v[100:103], v[72:75], v[200:203]
    v_mfma_f32_16x16x32_bf16 v[204:207], v[100:103], v[76:79], v[204:207]
    v_mfma_f32_16x16x32_bf16 v[208:211], v[104:107], v[64:67], v[208:211]
    v_mfma_f32_16x16x32_bf16 v[212:215], v[104:107], v[68:71], v[212:215]
    v_mfma_f32_16x16x32_bf16 v[216:219], v[104:107], v[72:75], v[216:219]
    v_mfma_f32_16x16x32_bf16 v[220:223], v[104:107], v[76:79], v[220:223]
    v_mfma_f32_16x16x32_bf16 v[224:227], v[108:111], v[64:67], v[224:227]
    v_mfma_f32_16x16x32_bf16 v[228:231], v[108:111], v[68:71], v[228:231]
    v_mfma_f32_16x16x32_bf16 v[232:235], v[108:111], v[72:75], v[232:235]
    v_mfma_f32_16x16x32_bf16 v[236:239], v[108:111], v[76:79], v[236:239]
    v_mfma_f32_16x16x32_bf16 v[240:243], v[112:115], v[64:67], v[240:243]
    v_mfma_f32_16x16x32_bf16 v[244:247], v[112:115], v[68:71], v[244:247]
    v_mfma_f32_16x16x32_bf16 v[248:251], v[112:115], v[72:75], v[248:251]
    v_mfma_f32_16x16x32_bf16 v[252:255], v[112:115], v[76:79], v[252:255]
    s_waitcnt vmcnt(9)
    ds_read_b64_tr_b16 v[64:65], v44 offset:8192
    ds_read_b64_tr_b16 v[66:67], v44 offset:10240
    ds_read_b64_tr_b16 v[68:69], v45 offset:8192
    ds_read_b64_tr_b16 v[70:71], v45 offset:10240
    ds_read_b64_tr_b16 v[72:73], v46 offset:8192
    ds_read_b64_tr_b16 v[74:75], v46 offset:10240
    ds_read_b64_tr_b16 v[76:77], v47 offset:8192
    ds_read_b64_tr_b16 v[78:79], v47 offset:10240
    s_waitcnt lgkmcnt(8)
    s_add_u32 m0, s38, 0
    s_nop 0
    buffer_load_dwordx4 v52, s[52:55], s24 offen lds
    s_add_u32 m0, s38, 1024
    s_nop 0
    buffer_load_dwordx4 v53, s[52:55], s24 offen lds
    s_add_u32 m0, s38, 2048
    s_nop 0
    buffer_load_dwordx4 v54, s[52:55], s24 offen lds
    s_add_u32 m0, s38, 3072
    s_nop 0
    buffer_load_dwordx4 v55, s[52:55], s24 offen lds
    s_add_u32 m0, s38, 4096
    s_nop 0
    buffer_load_dwordx4 v56, s[52:55], s24 offen lds
    s_add_u32 m0, s38, 5120
    s_add_u32 s24, s24, 40960
    buffer_load_dwordx4 v52, s[52:55], s24 offen lds
    s_add_u32 m0, s38, 6144
    s_nop 0
    buffer_load_dwordx4 v53, s[52:55], s24 offen lds
    s_add_u32 s24, s24, 10240
    v_mfma_f32_16x16x32_bf16 v[176:179], v[116:119], v[80:83], v[176:179]
    v_mfma_f32_16x16x32_bf16 v[180:183], v[116:119], v[84:87], v[180:183]
    v_mfma_f32_16x16x32_bf16 v[184:187], v[116:119], v[88:91], v[184:187]
    v_mfma_f32_16x16x32_bf16 v[188:191], v[116:119], v[92:95], v[188:191]
    v_mfma_f32_16x16x32_bf16 v[192:195], v[120:123], v[80:83], v[192:195]
    v_mfma_f32_16x16x32_bf16 v[196:199], v[120:123], v[84:87], v[196:199]
    v_mfma_f32_16x16x32_bf16 v[200:203], v[120:123], v[88:91], v[200:203]
    v_mfma_f32_16x16x32_bf16 v[204:207], v[120:123], v[92:95], v[204:207]
    v_mfma_f32_16x16x32_bf16 v[208:211], v[124:127], v[80:83], v[208:211]
    v_mfma_f32_16x16x32_bf16 v[212:215], v[124:127], v[84:87], v[212:215]
    v_mfma_f32_16x16x32_bf16 v[216:219], v[124:127], v[88:91], v[216:219]
    v_mfma_f32_16x16x32_bf16 v[220:223], v[124:127], v[92:95], v[220:223]
    v_mfma_f32_16x16x32_bf16 v[224:227], v[128:131], v[80:83], v[224:227]
    v_mfma_f32_16x16x32_bf16 v[228:231], v[128:131], v[84:87], v[228:231]
    v_mfma_f32_16x16x32_bf16 v[232:235], v[128:131], v[88:91], v[232:235]
    v_mfma_f32_16x16x32_bf16 v[236:239], v[128:131], v[92:95], v[236:239]
    v_mfma_f32_16x16x32_bf16 v[240:243], v[132:135], v[80:83], v[240:243]
    v_mfma_f32_16x16x32_bf16 v[244:247], v[132:135], v[84:87], v[244:247]
    v_mfma_f32_16x16x32_bf16 v[248:251], v[132:135], v[88:91], v[248:251]
    v_mfma_f32_16x16x32_bf16 v[252:255], v[132:135], v[92:95], v[252:255]
    s_waitcnt vmcnt(7)
    ds_read_b64_tr_b16 v[80:81], v44 offset:12288
    ds_read_b64_tr_b16 v[82:83], v44 offset:14336
    ds_read_b64_tr_b16 v[84:85], v45 offset:12288
    ds_read_b64_tr_b16 v[86:87], v45 offset:14336
    ds_read_b64_tr_b16 v[88:89], v46 offset:12288
    ds_read_b64_tr_b16 v[90:91], v46 offset:14336
    ds_read_b64_tr_b16 v[92:93], v47 offset:12288
    ds_read_b64_tr_b16 v[94:95], v47 offset:14336
    s_waitcnt lgkmcnt(8)
    v_mfma_f32_16x16x32_bf16 v[176:179], v[136:139], v[64:67], v[176:179]
    v_mfma_f32_16x16x32_bf16 v[180:183], v[136:139], v[68:71], v[180:183]
    v_mfma_f32_16x16x32_bf16 v[184:187], v[136:139], v[72:75], v[184:187]
    v_mfma_f32_16x16x32_bf16 v[188:191], v[136:139], v[76:79], v[188:191]
    v_mfma_f32_16x16x32_bf16 v[192:195], v[140:143], v[64:67], v[192:195]
    v_mfma_f32_16x16x32_bf16 v[196:199], v[140:143], v[68:71], v[196:199]
    v_mfma_f32_16x16x32_bf16 v[200:203], v[140:143], v[72:75], v[200:203]
    v_mfma_f32_16x16x32_bf16 v[204:207], v[140:143], v[76:79], v[204:207]
    v_mfma_f32_16x16x32_bf16 v[208:211], v[144:147], v[64:67], v[208:211]
    v_mfma_f32_16x16x32_bf16 v[212:215], v[144:147], v[68:71], v[212:215]
    v_mfma_f32_16x16x32_bf16 v[216:219], v[144:147], v[72:75], v[216:219]
    v_mfma_f32_16x16x32_bf16 v[220:223], v[144:147], v[76:79], v[220:223]
    v_mfma_f32_16x16x32_bf16 v[224:227], v[148:151], v[64:67], v[224:227]
    v_mfma_f32_16x16x32_bf16 v[228:231], v[148:151], v[68:71], v[228:231]
    v_mfma_f32_16x16x32_bf16 v[232:235], v[148:151], v[72:75], v[232:235]
    v_mfma_f32_16x16x32_bf16 v[236:239], v[148:151], v[76:79], v[236:239]
    v_mfma_f32_16x16x32_bf16 v[240:243], v[152:155], v[64:67], v[240:243]
    v_mfma_f32_16x16x32_bf16 v[244:247], v[152:155], v[68:71], v[244:247]
    v_mfma_f32_16x16x32_bf16 v[248:251], v[152:155], v[72:75], v[248:251]
    v_mfma_f32_16x16x32_bf16 v[252:255], v[152:155], v[76:79], v[252:255]
    s_waitcnt lgkmcnt(0)
    s_add_u32 m0, s38, 7168
    s_nop 0
    buffer_load_dwordx4 v52, s[52:55], s24 offen lds
    s_add_u32 m0, s38, 8192
    s_nop 0
    buffer_load_dwordx4 v53, s[52:55], s24 offen lds
    s_add_u32 m0, s38, 9216
    s_nop 0
    buffer_load_dwordx4 v54, s[52:55], s24 offen lds
    s_add_u32 m0, s38, 10240
    s_nop 0
    buffer_load_dwordx4 v55, s[52:55], s24 offen lds
    s_add_u32 m0, s38, 11264
    s_nop 0
    buffer_load_dwordx4 v56, s[52:55], s24 offen lds
    s_add_u32 m0, s38, 12288
    s_add_u32 s24, s24, 40960
    buffer_load_dwordx4 v52, s[52:55], s24 offen lds
    s_add_u32 m0, s38, 13312
    s_nop 0
    buffer_load_dwordx4 v53, s[52:55], s24 offen lds
    s_add_u32 s24, s24, 10240
    s_add_u32 m0, s38, 14336
    s_nop 0
    buffer_load_dwordx4 v52, s[52:55], s24 offen lds
    s_add_u32 m0, s38, 15360
    s_nop 0
    buffer_load_dwordx4 v53, s[52:55], s24 offen lds
    s_add_u32 m0, s38, 16384
    s_nop 0
    buffer_load_dwordx4 v54, s[52:55], s24 offen lds
    s_add_u32 m0, s38, 17408
    s_nop 0
    buffer_load_dwordx4 v55, s[52:55], s24 offen lds
    s_add_u32 m0, s38, 18432
    s_nop 0
    buffer_load_dwordx4 v56, s[52:55], s24 offen lds
    s_add_u32 m0, s38, 19456
    s_add_u32 s24, s24, 40960
    buffer_load_dwordx4 v52, s[52:55], s24 offen lds
    s_add_u32 m0, s38, 20480
    s_nop 0
    buffer_load_dwordx4 v53, s[52:55], s24 offen lds
    s_add_u32 s24, s24, 10240
    v_mfma_f32_16x16x32_bf16 v[176:179], v[156:159], v[80:83], v[176:179]
    v_mfma_f32_16x16x32_bf16 v[180:183], v[156:159], v[84:87], v[180:183]
    v_mfma_f32_16x16x32_bf16 v[184:187], v[156:159], v[88:91], v[184:187]
    v_mfma_f32_16x16x32_bf16 v[188:191], v[156:159], v[92:95], v[188:191]
    v_mfma_f32_16x16x32_bf16 v[192:195], v[160:163], v[80:83], v[192:195]
    v_mfma_f32_16x16x32_bf16 v[196:199], v[160:163], v[84:87], v[196:199]
    v_mfma_f32_16x16x32_bf16 v[200:203], v[160:163], v[88:91], v[200:203]
    v_mfma_f32_16x16x32_bf16 v[204:207], v[160:163], v[92:95], v[204:207]
    v_mfma_f32_16x16x32_bf16 v[208:211], v[164:167], v[80:83], v[208:211]
    v_mfma_f32_16x16x32_bf16 v[212:215], v[164:167], v[84:87], v[212:215]
    v_mfma_f32_16x16x32_bf16 v[216:219], v[164:167], v[88:91], v[216:219]
    v_mfma_f32_16x16x32_bf16 v[220:223], v[164:167], v[92:95], v[220:223]
    v_mfma_f32_16x16x32_bf16 v[224:227], v[168:171], v[80:83], v[224:227]
    v_mfma_f32_16x16x32_bf16 v[228:231], v[168:171], v[84:87], v[228:231]
    v_mfma_f32_16x16x32_bf16 v[232:235], v[168:171], v[88:91], v[232:235]
    v_mfma_f32_16x16x32_bf16 v[236:239], v[168:171], v[92:95], v[236:239]
    v_mfma_f32_16x16x32_bf16 v[240:243], v[172:175], v[80:83], v[240:243]
    v_mfma_f32_16x16x32_bf16 v[244:247], v[172:175], v[84:87], v[244:247]
    v_mfma_f32_16x16x32_bf16 v[248:251], v[172:175], v[88:91], v[248:251]
    v_mfma_f32_16x16x32_bf16 v[252:255], v[172:175], v[92:95], v[252:255]
    s_setprio 2
    v_lshlrev_b32 v5, 16, v34
    v_lshlrev_b32 v6, 16, v35
    v_lshlrev_b32 v8, 16, v36
    v_lshlrev_b32 v9, 16, v37
    v_lshlrev_b32 v34, 16, v38
    v_mov_b32 v10, v62
    v_mov_b32 v11, v63
    v_and_b32 v12, 15, v1
    v_lshlrev_b32 v12, 3, v12
    v_lshrrev_b32 v13, 4, v1
    v_lshl_add_u32 v12, v13, 8, v12
    v_lshlrev_b32 v13, 7, v1
    s_lshl_b32 s28, s42, 7
    s_lshl_b32 s29, s3, 3
    s_add_u32 s28, s28, s29
    s_lshl_b32 s35, s28, 7
    s_add_u32 s35, s35, 16777216
    s_lshl_b32 s34, s28, 9
    s_add_u32 s34, s34, 14680064
    s_lshl_b32 s30, s42, 5
    s_add_u32 s29, s29, s30
    s_lshl_b32 s29, s29, 7
    s_add_u32 s44, s29, 19005440
    s_waitcnt vmcnt(0)
    ds_read_b64_tr_b16 v[116:117], v10 offset:0
    ds_read_b64_tr_b16 v[118:119], v10 offset:1280
    ds_read_b64_tr_b16 v[120:121], v10 offset:32
    ds_read_b64_tr_b16 v[122:123], v10 offset:1312
    ds_read_b64_tr_b16 v[124:125], v10 offset:64
    ds_read_b64_tr_b16 v[126:127], v10 offset:1344
    ds_read_b64_tr_b16 v[128:129], v10 offset:96
    ds_read_b64_tr_b16 v[130:131], v10 offset:1376
    ds_read_b64_tr_b16 v[132:133], v10 offset:128
    ds_read_b64_tr_b16 v[134:135], v10 offset:1408
    ds_read_b64_tr_b16 v[156:157], v11 offset:0
    ds_read_b64_tr_b16 v[158:159], v11 offset:3200
    ds_read_b64_tr_b16 v[160:161], v11 offset:32
    ds_read_b64_tr_b16 v[162:163], v11 offset:3232
    ds_read_b64_tr_b16 v[164:165], v11 offset:64
    ds_read_b64_tr_b16 v[166:167], v11 offset:3264
    ds_read_b64_tr_b16 v[168:169], v11 offset:96
    ds_read_b64_tr_b16 v[170:171], v11 offset:3296
    ds_read_b64_tr_b16 v[172:173], v11 offset:128
    ds_read_b64_tr_b16 v[174:175], v11 offset:3328
    s_waitcnt lgkmcnt(0)
    s_add_u32 m0, s38, 0
    s_nop 0
    buffer_load_dwordx4 v52, s[52:55], s24 offen lds
    s_add_u32 m0, s38, 1024
    s_nop 0
    buffer_load_dwordx4 v53, s[52:55], s24 offen lds
    s_add_u32 m0, s38, 2048
    s_nop 0
    buffer_load_dwordx4 v54, s[52:55], s24 offen lds
    s_add_u32 m0, s38, 3072
    s_nop 0
    buffer_load_dwordx4 v55, s[52:55], s24 offen lds
    s_add_u32 m0, s38, 4096
    s_nop 0
    buffer_load_dwordx4 v56, s[52:55], s24 offen lds
    s_add_u32 m0, s38, 5120
    s_add_u32 s24, s24, 40960
    buffer_load_dwordx4 v52, s[52:55], s24 offen lds
    s_add_u32 m0, s38, 6144
    s_nop 0
    buffer_load_dwordx4 v53, s[52:55], s24 offen lds
    s_add_u32 s24, s24, 10240
    ds_read_b64_tr_b16 v[136:137], v10 offset:7168
    ds_read_b64_tr_b16 v[138:139], v10 offset:8448
    ds_read_b64_tr_b16 v[140:141], v10 offset:7200
    ds_read_b64_tr_b16 v[142:143], v10 offset:8480
    ds_read_b64_tr_b16 v[144:145], v10 offset:7232
    ds_read_b64_tr_b16 v[146:147], v10 offset:8512
    ds_read_b64_tr_b16 v[148:149], v10 offset:7264
    ds_read_b64_tr_b16 v[150:151], v10 offset:8544
    ds_read_b64_tr_b16 v[152:153], v10 offset:7296
    ds_read_b64_tr_b16 v[154:155], v10 offset:8576
    s_waitcnt vmcnt(0)
    ds_read_b64_tr_b16 v[96:97], v11 offset:0
    ds_read_b64_tr_b16 v[98:99], v11 offset:3200
    ds_read_b64_tr_b16 v[100:101], v11 offset:32
    ds_read_b64_tr_b16 v[102:103], v11 offset:3232
    ds_read_b64_tr_b16 v[104:105], v11 offset:64
    ds_read_b64_tr_b16 v[106:107], v11 offset:3264
    ds_read_b64_tr_b16 v[108:109], v11 offset:96
    ds_read_b64_tr_b16 v[110:111], v11 offset:3296
    ds_read_b64_tr_b16 v[112:113], v11 offset:128
    ds_read_b64_tr_b16 v[114:115], v11 offset:3328
    s_waitcnt lgkmcnt(0)
    s_mov_b32 exec_lo, 0
    s_mov_b32 exec_hi, 0xffff0000
    v_mov_b32 v156, v96
    v_mov_b32 v157, v97
    v_mov_b32 v158, v98
    v_mov_b32 v159, v99
    v_mov_b32 v160, v100
    v_mov_b32 v161, v101
    v_mov_b32 v162, v102
    v_mov_b32 v163, v103
    v_mov_b32 v164, v104
    v_mov_b32 v165, v105
    v_mov_b32 v166, v106
    v_mov_b32 v167, v107
    v_mov_b32 v168, v108
    v_mov_b32 v169, v109
    v_mov_b32 v170, v110
    v_mov_b32 v171, v111
    v_mov_b32 v172, v112
    v_mov_b32 v173, v113
    v_mov_b32 v174, v114
    v_mov_b32 v175, v115
    s_mov_b64 exec, -1
    s_mov_b32 s39, 0x40000
    s_mov_b32 exec_lo, 15
    s_mov_b32 exec_hi, 0
parallel_sum__mha_block__mixer_token_mlp__prompt_kernel_POL:
    buffer_load_dwordx2 v[2:3], v13, s[20:23], s44 offen sc1
    s_waitcnt vmcnt(0)
    v_cmp_ne_u64 vcc, s[100:101], v[2:3]
    s_sub_u32 s39, s39, 1
    s_cbranch_scc1 parallel_sum__mha_block__mixer_token_mlp__prompt_kernel_POX
    s_nop 2
    s_cbranch_vccz parallel_sum__mha_block__mixer_token_mlp__prompt_kernel_POX
    s_sleep 1
    s_branch parallel_sum__mha_block__mixer_token_mlp__prompt_kernel_POL
parallel_sum__mha_block__mixer_token_mlp__prompt_kernel_POX:
    s_mov_b64 exec, -1
    s_mov_b64 exec, 0xf0
    buffer_load_dwordx2 v[2:3], v13, s[20:23], s44 offen sc1
    s_mov_b64 exec, -1
    s_add_u32 s28, s34, 0
    buffer_load_dwordx4 v[36:39], v7, s[20:23], s28 offen sc1
    s_add_u32 s28, s34, 16384
    buffer_load_dwordx4 v[40:43], v7, s[20:23], s28 offen sc1
    s_add_u32 s28, s34, 32768
    buffer_load_dwordx4 v[44:47], v7, s[20:23], s28 offen sc1
    s_add_u32 s28, s34, 49152
    buffer_load_dwordx4 v[48:51], v7, s[20:23], s28 offen sc1
    s_add_u32 s28, s34, 1024
    buffer_load_dwordx4 v[52:55], v7, s[20:23], s28 offen sc1
    s_add_u32 s28, s34, 17408
    buffer_load_dwordx4 v[56:59], v7, s[20:23], s28 offen sc1
    s_add_u32 s28, s34, 33792
    buffer_load_dwordx4 v[60:63], v7, s[20:23], s28 offen sc1
    s_add_u32 s28, s34, 50176
    buffer_load_dwordx4 v[64:67], v7, s[20:23], s28 offen sc1
    s_waitcnt vmcnt(8)
    s_mov_b64 exec, 0xf0
    v_cmp_ne_u64 vcc, s[100:101], v[2:3]
    s_mov_b64 exec, -1
    s_nop 3
    s_cbranch_vccnz parallel_sum__mha_block__mixer_token_mlp__prompt_kernel_TB
    s_add_u32 s28, s34, 2048
    buffer_load_dwordx4 v[68:71], v7, s[20:23], s28 offen sc1
    s_add_u32 s28, s34, 18432
    buffer_load_dwordx4 v[72:75], v7, s[20:23], s28 offen sc1
    s_add_u32 s28, s34, 34816
    buffer_load_dwordx4 v[76:79], v7, s[20:23], s28 offen sc1
    s_add_u32 s28, s34, 51200
    buffer_load_dwordx4 v[80:83], v7, s[20:23], s28 offen sc1
    s_add_u32 s28, s34, 3072
    buffer_load_dwordx4 v[84:87], v7, s[20:23], s28 offen sc1
    s_add_u32 s28, s34, 19456
    buffer_load_dwordx4 v[88:91], v7, s[20:23], s28 offen sc1
    s_add_u32 s28, s34, 35840
    buffer_load_dwordx4 v[92:95], v7, s[20:23], s28 offen sc1
    s_add_u32 s28, s34, 52224
    buffer_load_dwordx4 v[96:99], v7, s[20:23], s28 offen sc1
    s_add_u32 s28, s35, 0
    buffer_load_dwordx2 v[100:101], v12, s[20:23], s28 offen sc1
    buffer_load_dwordx2 v[102:103], v12, s[20:23], s28 offen offset:128 sc1
    s_add_u32 s28, s35, 4096
    buffer_load_dwordx2 v[104:105], v12, s[20:23], s28 offen sc1
    buffer_load_dwordx2 v[106:107], v12, s[20:23], s28 offen offset:128 sc1
    s_add_u32 s28, s35, 8192
    buffer_load_dwordx2 v[108:109], v12, s[20:23], s28 offen sc1
    buffer_load_dwordx2 v[110:111], v12, s[20:23], s28 offen offset:128 sc1
    s_add_u32 s28, s35, 12288
    buffer_load_dwordx2 v[112:113], v12, s[20:23], s28 offen sc1
    buffer_load_dwordx2 v[114:115], v12, s[20:23], s28 offen offset:128 sc1
    s_waitcnt vmcnt(20)
    v_mfma_f32_16x16x32_bf16 v[176:179], v[116:119], v[36:39], v[176:179]
    v_mfma_f32_16x16x32_bf16 v[180:183], v[116:119], v[40:43], v[180:183]
    v_mfma_f32_16x16x32_bf16 v[184:187], v[116:119], v[44:47], v[184:187]
    v_mfma_f32_16x16x32_bf16 v[188:191], v[116:119], v[48:51], v[188:191]
    v_mfma_f32_16x16x32_bf16 v[192:195], v[120:123], v[36:39], v[192:195]
    v_mfma_f32_16x16x32_bf16 v[196:199], v[120:123], v[40:43], v[196:199]
    v_mfma_f32_16x16x32_bf16 v[200:203], v[120:123], v[44:47], v[200:203]
    v_mfma_f32_16x16x32_bf16 v[204:207], v[120:123], v[48:51], v[204:207]
    v_mfma_f32_16x16x32_bf16 v[208:211], v[124:127], v[36:39], v[208:211]
    v_mfma_f32_16x16x32_bf16 v[212:215], v[124:127], v[40:43], v[212:215]
    v_mfma_f32_16x16x32_bf16 v[216:219], v[124:127], v[44:47], v[216:219]
    v_mfma_f32_16x16x32_bf16 v[220:223], v[124:127], v[48:51], v[220:223]
    v_mfma_f32_16x16x32_bf16 v[224:227], v[128:131], v[36:39], v[224:227]
    v_mfma_f32_16x16x32_bf16 v[228:231], v[128:131], v[40:43], v[228:231]
    v_mfma_f32_16x16x32_bf16 v[232:235], v[128:131], v[44:47], v[232:235]
    v_mfma_f32_16x16x32_bf16 v[236:239], v[128:131], v[48:51], v[236:239]
    v_mfma_f32_16x16x32_bf16 v[240:243], v[132:135], v[36:39], v[240:243]
    v_mfma_f32_16x16x32_bf16 v[244:247], v[132:135], v[40:43], v[244:247]
    v_mfma_f32_16x16x32_bf16 v[248:251], v[132:135], v[44:47], v[248:251]
    v_mfma_f32_16x16x32_bf16 v[252:255], v[132:135], v[48:51], v[252:255]
    ds_read_b64_tr_b16 v[116:117], v10 offset:14336
    ds_read_b64_tr_b16 v[118:119], v10 offset:15616
    ds_read_b64_tr_b16 v[120:121], v10 offset:14368
    ds_read_b64_tr_b16 v[122:123], v10 offset:15648
    ds_read_b64_tr_b16 v[124:125], v10 offset:14400
    ds_read_b64_tr_b16 v[126:127], v10 offset:15680
    ds_read_b64_tr_b16 v[128:129], v10 offset:14432
    ds_read_b64_tr_b16 v[130:131], v10 offset:15712
    ds_read_b64_tr_b16 v[132:133], v10 offset:14464
    ds_read_b64_tr_b16 v[134:135], v10 offset:15744
    s_waitcnt vmcnt(16)
    v_mfma_f32_16x16x32_bf16 v[176:179], v[136:139], v[52:55], v[176:179]
    v_mfma_f32_16x16x32_bf16 v[180:183], v[136:139], v[56:59], v[180:183]
    v_mfma_f32_16x16x32_bf16 v[184:187], v[136:139], v[60:63], v[184:187]
    v_mfma_f32_16x16x32_bf16 v[188:191], v[136:139], v[64:67], v[188:191]
    v_mfma_f32_16x16x32_bf16 v[192:195], v[140:143], v[52:55], v[192:195]
    v_mfma_f32_16x16x32_bf16 v[196:199], v[140:143], v[56:59], v[196:199]
    v_mfma_f32_16x16x32_bf16 v[200:203], v[140:143], v[60:63], v[200:203]
    v_mfma_f32_16x16x32_bf16 v[204:207], v[140:143], v[64:67], v[204:207]
    v_mfma_f32_16x16x32_bf16 v[208:211], v[144:147], v[52:55], v[208:211]
    v_mfma_f32_16x16x32_bf16 v[212:215], v[144:147], v[56:59], v[212:215]
    v_mfma_f32_16x16x32_bf16 v[216:219], v[144:147], v[60:63], v[216:219]
    v_mfma_f32_16x16x32_bf16 v[220:223], v[144:147], v[64:67], v[220:223]
    v_mfma_f32_16x16x32_bf16 v[224:227], v[148:151], v[52:55], v[224:227]
    v_mfma_f32_16x16x32_bf16 v[228:231], v[148:151], v[56:59], v[228:231]
    v_mfma_f32_16x16x32_bf16 v[232:235], v[148:151], v[60:63], v[232:235]
    v_mfma_f32_16x16x32_bf16 v[236:239], v[148:151], v[64:67], v[236:239]
    v_mfma_f32_16x16x32_bf16 v[240:243], v[152:155], v[52:55], v[240:243]
    v_mfma_f32_16x16x32_bf16 v[244:247], v[152:155], v[56:59], v[244:247]
    v_mfma_f32_16x16x32_bf16 v[248:251], v[152:155], v[60:63], v[248:251]
    v_mfma_f32_16x16x32_bf16 v[252:255], v[152:155], v[64:67], v[252:255]
    ds_read_b64_tr_b16 v[136:137], v10 offset:0
    ds_read_b64_tr_b16 v[138:139], v10 offset:1280
    ds_read_b64_tr_b16 v[140:141], v10 offset:32
    ds_read_b64_tr_b16 v[142:143], v10 offset:1312
    ds_read_b64_tr_b16 v[144:145], v10 offset:64
    ds_read_b64_tr_b16 v[146:147], v10 offset:1344
    ds_read_b64_tr_b16 v[148:149], v10 offset:96
    ds_read_b64_tr_b16 v[150:151], v10 offset:1376
    ds_read_b64_tr_b16 v[152:153], v10 offset:128
    ds_read_b64_tr_b16 v[154:155], v10 offset:1408
    s_waitcnt vmcnt(12)
    s_waitcnt lgkmcnt(10)
    v_mfma_f32_16x16x32_bf16 v[176:179], v[116:119], v[68:71], v[176:179]
    v_mfma_f32_16x16x32_bf16 v[180:183], v[116:119], v[72:75], v[180:183]
    v_mfma_f32_16x16x32_bf16 v[184:187], v[116:119], v[76:79], v[184:187]
    v_mfma_f32_16x16x32_bf16 v[188:191], v[116:119], v[80:83], v[188:191]
    v_mfma_f32_16x16x32_bf16 v[192:195], v[120:123], v[68:71], v[192:195]
    v_mfma_f32_16x16x32_bf16 v[196:199], v[120:123], v[72:75], v[196:199]
    v_mfma_f32_16x16x32_bf16 v[200:203], v[120:123], v[76:79], v[200:203]
    v_mfma_f32_16x16x32_bf16 v[204:207], v[120:123], v[80:83], v[204:207]
    v_mfma_f32_16x16x32_bf16 v[208:211], v[124:127], v[68:71], v[208:211]
    v_mfma_f32_16x16x32_bf16 v[212:215], v[124:127], v[72:75], v[212:215]
    v_mfma_f32_16x16x32_bf16 v[216:219], v[124:127], v[76:79], v[216:219]
    v_mfma_f32_16x16x32_bf16 v[220:223], v[124:127], v[80:83], v[220:223]
    v_mfma_f32_16x16x32_bf16 v[224:227], v[128:131], v[68:71], v[224:227]
    v_mfma_f32_16x16x32_bf16 v[228:231], v[128:131], v[72:75], v[228:231]
    v_mfma_f32_16x16x32_bf16 v[232:235], v[128:131], v[76:79], v[232:235]
    v_mfma_f32_16x16x32_bf16 v[236:239], v[128:131], v[80:83], v[236:239]
    v_mfma_f32_16x16x32_bf16 v[240:243], v[132:135], v[68:71], v[240:243]
    v_mfma_f32_16x16x32_bf16 v[244:247], v[132:135], v[72:75], v[244:247]
    v_mfma_f32_16x16x32_bf16 v[248:251], v[132:135], v[76:79], v[248:251]
    v_mfma_f32_16x16x32_bf16 v[252:255], v[132:135], v[80:83], v[252:255]
    s_waitcnt vmcnt(8)
    s_waitcnt lgkmcnt(0)
    v_mfma_f32_16x16x32_bf16 v[176:179], v[136:139], v[84:87], v[176:179]
    v_mfma_f32_16x16x32_bf16 v[180:183], v[136:139], v[88:91], v[180:183]
    v_mfma_f32_16x16x32_bf16 v[184:187], v[136:139], v[92:95], v[184:187]
    v_mfma_f32_16x16x32_bf16 v[188:191], v[136:139], v[96:99], v[188:191]
    v_mfma_f32_16x16x32_bf16 v[192:195], v[140:143], v[84:87], v[192:195]
    v_mfma_f32_16x16x32_bf16 v[196:199], v[140:143], v[88:91], v[196:199]
    v_mfma_f32_16x16x32_bf16 v[200:203], v[140:143], v[92:95], v[200:203]
    v_mfma_f32_16x16x32_bf16 v[204:207], v[140:143], v[96:99], v[204:207]
    v_mfma_f32_16x16x32_bf16 v[208:211], v[144:147], v[84:87], v[208:211]
    v_mfma_f32_16x16x32_bf16 v[212:215], v[144:147], v[88:91], v[212:215]
    v_mfma_f32_16x16x32_bf16 v[216:219], v[144:147], v[92:95], v[216:219]
    v_mfma_f32_16x16x32_bf16 v[220:223], v[144:147], v[96:99], v[220:223]
    v_mfma_f32_16x16x32_bf16 v[224:227], v[148:151], v[84:87], v[224:227]
    v_mfma_f32_16x16x32_bf16 v[228:231], v[148:151], v[88:91], v[228:231]
    v_mfma_f32_16x16x32_bf16 v[232:235], v[148:151], v[92:95], v[232:235]
    v_mfma_f32_16x16x32_bf16 v[236:239], v[148:151], v[96:99], v[236:239]
    v_mfma_f32_16x16x32_bf16 v[240:243], v[152:155], v[84:87], v[240:243]
    v_mfma_f32_16x16x32_bf16 v[244:247], v[152:155], v[88:91], v[244:247]
    v_mfma_f32_16x16x32_bf16 v[248:251], v[152:155], v[92:95], v[248:251]
    v_mfma_f32_16x16x32_bf16 v[252:255], v[152:155], v[96:99], v[252:255]
    s_waitcnt vmcnt(0)
    v_mfma_f32_16x16x32_bf16 v[176:179], v[156:159], v[100:103], v[176:179]
    v_mfma_f32_16x16x32_bf16 v[180:183], v[156:159], v[104:107], v[180:183]
    v_mfma_f32_16x16x32_bf16 v[184:187], v[156:159], v[108:111], v[184:187]
    v_mfma_f32_16x16x32_bf16 v[188:191], v[156:159], v[112:115], v[188:191]
    v_mfma_f32_16x16x32_bf16 v[192:195], v[160:163], v[100:103], v[192:195]
    v_mfma_f32_16x16x32_bf16 v[196:199], v[160:163], v[104:107], v[196:199]
    v_mfma_f32_16x16x32_bf16 v[200:203], v[160:163], v[108:111], v[200:203]
    v_mfma_f32_16x16x32_bf16 v[204:207], v[160:163], v[112:115], v[204:207]
    v_mfma_f32_16x16x32_bf16 v[208:211], v[164:167], v[100:103], v[208:211]
    v_mfma_f32_16x16x32_bf16 v[212:215], v[164:167], v[104:107], v[212:215]
    v_mfma_f32_16x16x32_bf16 v[216:219], v[164:167], v[108:111], v[216:219]
    v_mfma_f32_16x16x32_bf16 v[220:223], v[164:167], v[112:115], v[220:223]
    v_mfma_f32_16x16x32_bf16 v[224:227], v[168:171], v[100:103], v[224:227]
    v_mfma_f32_16x16x32_bf16 v[228:231], v[168:171], v[104:107], v[228:231]
    v_mfma_f32_16x16x32_bf16 v[232:235], v[168:171], v[108:111], v[232:235]
    v_mfma_f32_16x16x32_bf16 v[236:239], v[168:171], v[112:115], v[236:239]
    v_mfma_f32_16x16x32_bf16 v[240:243], v[172:175], v[100:103], v[240:243]
    v_mfma_f32_16x16x32_bf16 v[244:247], v[172:175], v[104:107], v[244:247]
    v_mfma_f32_16x16x32_bf16 v[248:251], v[172:175], v[108:111], v[248:251]
    v_mfma_f32_16x16x32_bf16 v[252:255], v[172:175], v[112:115], v[252:255]
    s_branch parallel_sum__mha_block__mixer_token_mlp__prompt_kernel_TE
parallel_sum__mha_block__mixer_token_mlp__prompt_kernel_TB:
    s_waitcnt vmcnt(4)
    v_mfma_f32_16x16x32_bf16 v[176:179], v[116:119], v[36:39], v[176:179]
    v_mfma_f32_16x16x32_bf16 v[180:183], v[116:119], v[40:43], v[180:183]
    v_mfma_f32_16x16x32_bf16 v[184:187], v[116:119], v[44:47], v[184:187]
    v_mfma_f32_16x16x32_bf16 v[188:191], v[116:119], v[48:51], v[188:191]
    v_mfma_f32_16x16x32_bf16 v[192:195], v[120:123], v[36:39], v[192:195]
    v_mfma_f32_16x16x32_bf16 v[196:199], v[120:123], v[40:43], v[196:199]
    v_mfma_f32_16x16x32_bf16 v[200:203], v[120:123], v[44:47], v[200:203]
    v_mfma_f32_16x16x32_bf16 v[204:207], v[120:123], v[48:51], v[204:207]
    v_mfma_f32_16x16x32_bf16 v[208:211], v[124:127], v[36:39], v[208:211]
    v_mfma_f32_16x16x32_bf16 v[212:215], v[124:127], v[40:43], v[212:215]
    v_mfma_f32_16x16x32_bf16 v[216:219], v[124:127], v[44:47], v[216:219]
    v_mfma_f32_16x16x32_bf16 v[220:223], v[124:127], v[48:51], v[220:223]
    v_mfma_f32_16x16x32_bf16 v[224:227], v[128:131], v[36:39], v[224:227]
    v_mfma_f32_16x16x32_bf16 v[228:231], v[128:131], v[40:43], v[228:231]
    v_mfma_f32_16x16x32_bf16 v[232:235], v[128:131], v[44:47], v[232:235]
    v_mfma_f32_16x16x32_bf16 v[236:239], v[128:131], v[48:51], v[236:239]
    v_mfma_f32_16x16x32_bf16 v[240:243], v[132:135], v[36:39], v[240:243]
    v_mfma_f32_16x16x32_bf16 v[244:247], v[132:135], v[40:43], v[244:247]
    v_mfma_f32_16x16x32_bf16 v[248:251], v[132:135], v[44:47], v[248:251]
    v_mfma_f32_16x16x32_bf16 v[252:255], v[132:135], v[48:51], v[252:255]
    ds_read_b64_tr_b16 v[116:117], v10 offset:14336
    ds_read_b64_tr_b16 v[118:119], v10 offset:15616
    ds_read_b64_tr_b16 v[120:121], v10 offset:14368
    ds_read_b64_tr_b16 v[122:123], v10 offset:15648
    ds_read_b64_tr_b16 v[124:125], v10 offset:14400
    ds_read_b64_tr_b16 v[126:127], v10 offset:15680
    ds_read_b64_tr_b16 v[128:129], v10 offset:14432
    ds_read_b64_tr_b16 v[130:131], v10 offset:15712
    ds_read_b64_tr_b16 v[132:133], v10 offset:14464
    ds_read_b64_tr_b16 v[134:135], v10 offset:15744
    s_waitcnt vmcnt(0)
    v_mfma_f32_16x16x32_bf16 v[176:179], v[136:139], v[52:55], v[176:179]
    v_mfma_f32_16x16x32_bf16 v[180:183], v[136:139], v[56:59], v[180:183]
    v_mfma_f32_16x16x32_bf16 v[184:187], v[136:139], v[60:63], v[184:187]
    v_mfma_f32_16x16x32_bf16 v[188:191], v[136:139], v[64:67], v[188:191]
    v_mfma_f32_16x16x32_bf16 v[192:195], v[140:143], v[52:55], v[192:195]
    v_mfma_f32_16x16x32_bf16 v[196:199], v[140:143], v[56:59], v[196:199]
    v_mfma_f32_16x16x32_bf16 v[200:203], v[140:143], v[60:63], v[200:203]
    v_mfma_f32_16x16x32_bf16 v[204:207], v[140:143], v[64:67], v[204:207]
    v_mfma_f32_16x16x32_bf16 v[208:211], v[144:147], v[52:55], v[208:211]
    v_mfma_f32_16x16x32_bf16 v[212:215], v[144:147], v[56:59], v[212:215]
    v_mfma_f32_16x16x32_bf16 v[216:219], v[144:147], v[60:63], v[216:219]
    v_mfma_f32_16x16x32_bf16 v[220:223], v[144:147], v[64:67], v[220:223]
    v_mfma_f32_16x16x32_bf16 v[224:227], v[148:151], v[52:55], v[224:227]
    v_mfma_f32_16x16x32_bf16 v[228:231], v[148:151], v[56:59], v[228:231]
    v_mfma_f32_16x16x32_bf16 v[232:235], v[148:151], v[60:63], v[232:235]
    v_mfma_f32_16x16x32_bf16 v[236:239], v[148:151], v[64:67], v[236:239]
    v_mfma_f32_16x16x32_bf16 v[240:243], v[152:155], v[52:55], v[240:243]
    v_mfma_f32_16x16x32_bf16 v[244:247], v[152:155], v[56:59], v[244:247]
    v_mfma_f32_16x16x32_bf16 v[248:251], v[152:155], v[60:63], v[248:251]
    v_mfma_f32_16x16x32_bf16 v[252:255], v[152:155], v[64:67], v[252:255]
    ds_read_b64_tr_b16 v[136:137], v10 offset:0
    ds_read_b64_tr_b16 v[138:139], v10 offset:1280
    ds_read_b64_tr_b16 v[140:141], v10 offset:32
    ds_read_b64_tr_b16 v[142:143], v10 offset:1312
    ds_read_b64_tr_b16 v[144:145], v10 offset:64
    ds_read_b64_tr_b16 v[146:147], v10 offset:1344
    ds_read_b64_tr_b16 v[148:149], v10 offset:96
    ds_read_b64_tr_b16 v[150:151], v10 offset:1376
    ds_read_b64_tr_b16 v[152:153], v10 offset:128
    ds_read_b64_tr_b16 v[154:155], v10 offset:1408
    s_mov_b32 s39, 0x40000
    s_mov_b32 exec_lo, 240
    s_mov_b32 exec_hi, 0
parallel_sum__mha_block__mixer_token_mlp__prompt_kernel_PO2OL:
    buffer_load_dwordx2 v[2:3], v13, s[20:23], s44 offen sc1
    s_waitcnt vmcnt(0)
    v_cmp_ne_u64 vcc, s[100:101], v[2:3]
    s_sub_u32 s39, s39, 1
    s_cbranch_scc1 parallel_sum__mha_block__mixer_token_mlp__prompt_kernel_PO2OX
    s_nop 2
    s_cbranch_vccz parallel_sum__mha_block__mixer_token_mlp__prompt_kernel_PO2OX
    s_sleep 1
    s_branch parallel_sum__mha_block__mixer_token_mlp__prompt_kernel_PO2OL
parallel_sum__mha_block__mixer_token_mlp__prompt_kernel_PO2OX:
    s_mov_b64 exec, -1
    s_add_u32 s28, s34, 2048
    buffer_load_dwordx4 v[68:71], v7, s[20:23], s28 offen sc1
    s_add_u32 s28, s34, 18432
    buffer_load_dwordx4 v[72:75], v7, s[20:23], s28 offen sc1
    s_add_u32 s28, s34, 34816
    buffer_load_dwordx4 v[76:79], v7, s[20:23], s28 offen sc1
    s_add_u32 s28, s34, 51200
    buffer_load_dwordx4 v[80:83], v7, s[20:23], s28 offen sc1
    s_add_u32 s28, s34, 3072
    buffer_load_dwordx4 v[84:87], v7, s[20:23], s28 offen sc1
    s_add_u32 s28, s34, 19456
    buffer_load_dwordx4 v[88:91], v7, s[20:23], s28 offen sc1
    s_add_u32 s28, s34, 35840
    buffer_load_dwordx4 v[92:95], v7, s[20:23], s28 offen sc1
    s_add_u32 s28, s34, 52224
    buffer_load_dwordx4 v[96:99], v7, s[20:23], s28 offen sc1
    s_add_u32 s28, s35, 0
    buffer_load_dwordx2 v[100:101], v12, s[20:23], s28 offen sc1
    buffer_load_dwordx2 v[102:103], v12, s[20:23], s28 offen offset:128 sc1
    s_add_u32 s28, s35, 4096
    buffer_load_dwordx2 v[104:105], v12, s[20:23], s28 offen sc1
    buffer_load_dwordx2 v[106:107], v12, s[20:23], s28 offen offset:128 sc1
    s_add_u32 s28, s35, 8192
    buffer_load_dwordx2 v[108:109], v12, s[20:23], s28 offen sc1
    buffer_load_dwordx2 v[110:111], v12, s[20:23], s28 offen offset:128 sc1
    s_add_u32 s28, s35, 12288
    buffer_load_dwordx2 v[112:113], v12, s[20:23], s28 offen sc1
    buffer_load_dwordx2 v[114:115], v12, s[20:23], s28 offen offset:128 sc1
    s_waitcnt vmcnt(12)
    s_waitcnt lgkmcnt(10)
    v_mfma_f32_16x16x32_bf16 v[176:179], v[116:119], v[68:71], v[176:179]
    v_mfma_f32_16x16x32_bf16 v[180:183], v[116:119], v[72:75], v[180:183]
    v_mfma_f32_16x16x32_bf16 v[184:187], v[116:119], v[76:79], v[184:187]
    v_mfma_f32_16x16x32_bf16 v[188:191], v[116:119], v[80:83], v[188:191]
    v_mfma_f32_16x16x32_bf16 v[192:195], v[120:123], v[68:71], v[192:195]
    v_mfma_f32_16x16x32_bf16 v[196:199], v[120:123], v[72:75], v[196:199]
    v_mfma_f32_16x16x32_bf16 v[200:203], v[120:123], v[76:79], v[200:203]
    v_mfma_f32_16x16x32_bf16 v[204:207], v[120:123], v[80:83], v[204:207]
    v_mfma_f32_16x16x32_bf16 v[208:211], v[124:127], v[68:71], v[208:211]
    v_mfma_f32_16x16x32_bf16 v[212:215], v[124:127], v[72:75], v[212:215]
    v_mfma_f32_16x16x32_bf16 v[216:219], v[124:127], v[76:79], v[216:219]
    v_mfma_f32_16x16x32_bf16 v[220:223], v[124:127], v[80:83], v[220:223]
    v_mfma_f32_16x16x32_bf16 v[224:227], v[128:131], v[68:71], v[224:227]
    v_mfma_f32_16x16x32_bf16 v[228:231], v[128:131], v[72:75], v[228:231]
    v_mfma_f32_16x16x32_bf16 v[232:235], v[128:131], v[76:79], v[232:235]
    v_mfma_f32_16x16x32_bf16 v[236:239], v[128:131], v[80:83], v[236:239]
    v_mfma_f32_16x16x32_bf16 v[240:243], v[132:135], v[68:71], v[240:243]
    v_mfma_f32_16x16x32_bf16 v[244:247], v[132:135], v[72:75], v[244:247]
    v_mfma_f32_16x16x32_bf16 v[248:251], v[132:135], v[76:79], v[248:251]
    v_mfma_f32_16x16x32_bf16 v[252:255], v[132:135], v[80:83], v[252:255]
    s_waitcnt vmcnt(8)
    s_waitcnt lgkmcnt(0)
    v_mfma_f32_16x16x32_bf16 v[176:179], v[136:139], v[84:87], v[176:179]
    v_mfma_f32_16x16x32_bf16 v[180:183], v[136:139], v[88:91], v[180:183]
    v_mfma_f32_16x16x32_bf16 v[184:187], v[136:139], v[92:95], v[184:187]
    v_mfma_f32_16x16x32_bf16 v[188:191], v[136:139], v[96:99], v[188:191]
    v_mfma_f32_16x16x32_bf16 v[192:195], v[140:143], v[84:87], v[192:195]
    v_mfma_f32_16x16x32_bf16 v[196:199], v[140:143], v[88:91], v[196:199]
    v_mfma_f32_16x16x32_bf16 v[200:203], v[140:143], v[92:95], v[200:203]
    v_mfma_f32_16x16x32_bf16 v[204:207], v[140:143], v[96:99], v[204:207]
    v_mfma_f32_16x16x32_bf16 v[208:211], v[144:147], v[84:87], v[208:211]
    v_mfma_f32_16x16x32_bf16 v[212:215], v[144:147], v[88:91], v[212:215]
    v_mfma_f32_16x16x32_bf16 v[216:219], v[144:147], v[92:95], v[216:219]
    v_mfma_f32_16x16x32_bf16 v[220:223], v[144:147], v[96:99], v[220:223]
    v_mfma_f32_16x16x32_bf16 v[224:227], v[148:151], v[84:87], v[224:227]
    v_mfma_f32_16x16x32_bf16 v[228:231], v[148:151], v[88:91], v[228:231]
    v_mfma_f32_16x16x32_bf16 v[232:235], v[148:151], v[92:95], v[232:235]
    v_mfma_f32_16x16x32_bf16 v[236:239], v[148:151], v[96:99], v[236:239]
    v_mfma_f32_16x16x32_bf16 v[240:243], v[152:155], v[84:87], v[240:243]
    v_mfma_f32_16x16x32_bf16 v[244:247], v[152:155], v[88:91], v[244:247]
    v_mfma_f32_16x16x32_bf16 v[248:251], v[152:155], v[92:95], v[248:251]
    v_mfma_f32_16x16x32_bf16 v[252:255], v[152:155], v[96:99], v[252:255]
    s_waitcnt vmcnt(0)
    v_mfma_f32_16x16x32_bf16 v[176:179], v[156:159], v[100:103], v[176:179]
    v_mfma_f32_16x16x32_bf16 v[180:183], v[156:159], v[104:107], v[180:183]
    v_mfma_f32_16x16x32_bf16 v[184:187], v[156:159], v[108:111], v[184:187]
    v_mfma_f32_16x16x32_bf16 v[188:191], v[156:159], v[112:115], v[188:191]
    v_mfma_f32_16x16x32_bf16 v[192:195], v[160:163], v[100:103], v[192:195]
    v_mfma_f32_16x16x32_bf16 v[196:199], v[160:163], v[104:107], v[196:199]
    v_mfma_f32_16x16x32_bf16 v[200:203], v[160:163], v[108:111], v[200:203]
    v_mfma_f32_16x16x32_bf16 v[204:207], v[160:163], v[112:115], v[204:207]
    v_mfma_f32_16x16x32_bf16 v[208:211], v[164:167], v[100:103], v[208:211]
    v_mfma_f32_16x16x32_bf16 v[212:215], v[164:167], v[104:107], v[212:215]
    v_mfma_f32_16x16x32_bf16 v[216:219], v[164:167], v[108:111], v[216:219]
    v_mfma_f32_16x16x32_bf16 v[220:223], v[164:167], v[112:115], v[220:223]
    v_mfma_f32_16x16x32_bf16 v[224:227], v[168:171], v[100:103], v[224:227]
    v_mfma_f32_16x16x32_bf16 v[228:231], v[168:171], v[104:107], v[228:231]
    v_mfma_f32_16x16x32_bf16 v[232:235], v[168:171], v[108:111], v[232:235]
    v_mfma_f32_16x16x32_bf16 v[236:239], v[168:171], v[112:115], v[236:239]
    v_mfma_f32_16x16x32_bf16 v[240:243], v[172:175], v[100:103], v[240:243]
    v_mfma_f32_16x16x32_bf16 v[244:247], v[172:175], v[104:107], v[244:247]
    v_mfma_f32_16x16x32_bf16 v[248:251], v[172:175], v[108:111], v[248:251]
    v_mfma_f32_16x16x32_bf16 v[252:255], v[172:175], v[112:115], v[252:255]
parallel_sum__mha_block__mixer_token_mlp__prompt_kernel_TE:
    v_and_b32 v10, 15, v1
    v_mul_u32_u24 v10, 336, v10
    v_lshrrev_b32 v11, 4, v1
    v_lshl_add_u32 v10, v11, 4, v10
    v_add_u32 v10, s38, v10
    v_add_u32 v60, 43008, v19
    v_add_u32 v61, 43008, v20
    v_add_u32 v62, 43008, v21
    v_add_u32 v63, 43008, v22
    v_add_u32 v64, 43008, v23
    ds_write_b128 v10, v[176:179] offset:0
    ds_write_b128 v10, v[180:183] offset:5376
    ds_write_b128 v10, v[184:187] offset:10752
    ds_write_b128 v10, v[188:191] offset:16128
    ds_write_b128 v10, v[192:195] offset:64
    ds_write_b128 v10, v[196:199] offset:5440
    ds_write_b128 v10, v[200:203] offset:10816
    ds_write_b128 v10, v[204:207] offset:16192
    ds_write_b128 v10, v[208:211] offset:128
    ds_write_b128 v10, v[212:215] offset:5504
    ds_write_b128 v10, v[216:219] offset:10880
    ds_write_b128 v10, v[220:223] offset:16256
    ds_write_b128 v10, v[224:227] offset:192
    ds_write_b128 v10, v[228:231] offset:5568
    ds_write_b128 v10, v[232:235] offset:10944
    ds_write_b128 v10, v[236:239] offset:16320
    ds_write_b128 v10, v[240:243] offset:256
    ds_write_b128 v10, v[244:247] offset:5632
    ds_write_b128 v10, v[248:251] offset:11008
    ds_write_b128 v10, v[252:255] offset:16384
    s_waitcnt lgkmcnt(0)
    s_mov_b64 exec, 1
    v_mov_b32 v10, 1
    ds_add_u32 v4, v10 offset:16
    s_mov_b64 exec, -1
    v_lshlrev_b32 v40, 16, v24
    v_and_b32 v41, 0xffff0000, v24
    v_lshlrev_b32 v42, 16, v25
    v_and_b32 v43, 0xffff0000, v25
    v_add_f32 v40, v40, v5
    v_add_f32 v41, v41, v5
    v_add_f32 v42, v42, v5
    v_add_f32 v43, v43, v5
    v_lshlrev_b32 v44, 16, v26
    v_and_b32 v45, 0xffff0000, v26
    v_lshlrev_b32 v46, 16, v27
    v_and_b32 v47, 0xffff0000, v27
    v_add_f32 v44, v44, v6
    v_add_f32 v45, v45, v6
    v_add_f32 v46, v46, v6
    v_add_f32 v47, v47, v6
    v_lshlrev_b32 v48, 16, v28
    v_and_b32 v49, 0xffff0000, v28
    v_lshlrev_b32 v50, 16, v29
    v_and_b32 v51, 0xffff0000, v29
    v_add_f32 v48, v48, v8
    v_add_f32 v49, v49, v8
    v_add_f32 v50, v50, v8
    v_add_f32 v51, v51, v8
    v_lshlrev_b32 v52, 16, v30
    v_and_b32 v53, 0xffff0000, v30
    v_lshlrev_b32 v54, 16, v31
    v_and_b32 v55, 0xffff0000, v31
    v_add_f32 v52, v52, v9
    v_add_f32 v53, v53, v9
    v_add_f32 v54, v54, v9
    v_add_f32 v55, v55, v9
    v_lshlrev_b32 v56, 16, v32
    v_and_b32 v57, 0xffff0000, v32
    v_lshlrev_b32 v58, 16, v33
    v_and_b32 v59, 0xffff0000, v33
    v_add_f32 v56, v56, v34
    v_add_f32 v57, v57, v34
    v_add_f32 v58, v58, v34
    v_add_f32 v59, v59, v34
parallel_sum__mha_block__mixer_token_mlp__prompt_kernel_s4:
    ds_read_b32 v10, v4 offset:16
    s_waitcnt lgkmcnt(0)
    v_readfirstlane_b32 s29, v10
    s_nop 0
    s_cmp_ge_u32 s29, 4
    s_cbranch_scc1 parallel_sum__mha_block__mixer_token_mlp__prompt_kernel_s4x
    s_sleep 1
    s_branch parallel_sum__mha_block__mixer_token_mlp__prompt_kernel_s4
parallel_sum__mha_block__mixer_token_mlp__prompt_kernel_s4x:
    ds_read_b128 v[68:71], v19
    ds_read_b128 v[72:75], v19 offset:21504
    ds_read_b128 v[76:79], v60
    ds_read_b128 v[80:83], v60 offset:21504
    ds_read_b128 v[84:87], v20
    ds_read_b128 v[88:91], v20 offset:21504
    ds_read_b128 v[92:95], v61
    ds_read_b128 v[96:99], v61 offset:21504
    ds_read_b128 v[100:103], v21
    ds_read_b128 v[104:107], v21 offset:21504
    ds_read_b128 v[108:111], v62
    ds_read_b128 v[112:115], v62 offset:21504
    ds_read_b128 v[116:119], v22
    ds_read_b128 v[120:123], v22 offset:21504
    ds_read_b128 v[124:127], v63
    ds_read_b128 v[128:131], v63 offset:21504
    ds_read_b128 v[132:135], v23
    ds_read_b128 v[136:139], v23 offset:21504
    ds_read_b128 v[140:143], v64
    ds_read_b128 v[144:147], v64 offset:21504
    s_waitcnt lgkmcnt(15)
    v_pk_add_f32 v[68:69], v[68:69], v[72:73]
    v_pk_add_f32 v[76:77], v[76:77], v[80:81]
    v_pk_add_f32 v[40:41], v[40:41], v[68:69]
    v_pk_add_f32 v[40:41], v[40:41], v[76:77]
    v_pk_add_f32 v[70:71], v[70:71], v[74:75]
    v_pk_add_f32 v[78:79], v[78:79], v[82:83]
    v_pk_add_f32 v[42:43], v[42:43], v[70:71]
    v_pk_add_f32 v[42:43], v[42:43], v[78:79]
    v_cvt_pk_bf16_f32 v40, v40, v41
    v_cvt_pk_bf16_f32 v41, v42, v43
    buffer_store_dwordx2 v[40:41], v14, s[56:59], s25 offen sc1
    s_waitcnt lgkmcnt(12)
    v_pk_add_f32 v[84:85], v[84:85], v[88:89]
    v_pk_add_f32 v[92:93], v[92:93], v[96:97]
    v_pk_add_f32 v[44:45], v[44:45], v[84:85]
    v_pk_add_f32 v[44:45], v[44:45], v[92:93]
    v_pk_add_f32 v[86:87], v[86:87], v[90:91]
    v_pk_add_f32 v[94:95], v[94:95], v[98:99]
    v_pk_add_f32 v[46:47], v[46:47], v[86:87]
    v_pk_add_f32 v[46:47], v[46:47], v[94:95]
    v_cvt_pk_bf16_f32 v44, v44, v45
    v_cvt_pk_bf16_f32 v45, v46, v47
    buffer_store_dwordx2 v[44:45], v15, s[56:59], s25 offen sc1
    s_waitcnt lgkmcnt(8)
    v_pk_add_f32 v[100:101], v[100:101], v[104:105]
    v_pk_add_f32 v[108:109], v[108:109], v[112:113]
    v_pk_add_f32 v[48:49], v[48:49], v[100:101]
    v_pk_add_f32 v[48:49], v[48:49], v[108:109]
    v_pk_add_f32 v[102:103], v[102:103], v[106:107]
    v_pk_add_f32 v[110:111], v[110:111], v[114:115]
    v_pk_add_f32 v[50:51], v[50:51], v[102:103]
    v_pk_add_f32 v[50:51], v[50:51], v[110:111]
    v_cvt_pk_bf16_f32 v48, v48, v49
    v_cvt_pk_bf16_f32 v49, v50, v51
    buffer_store_dwordx2 v[48:49], v16, s[56:59], s25 offen sc1
    s_waitcnt lgkmcnt(4)
    v_pk_add_f32 v[116:117], v[116:117], v[120:121]
    v_pk_add_f32 v[124:125], v[124:125], v[128:129]
    v_pk_add_f32 v[52:53], v[52:53], v[116:117]
    v_pk_add_f32 v[52:53], v[52:53], v[124:125]
    v_pk_add_f32 v[118:119], v[118:119], v[122:123]
    v_pk_add_f32 v[126:127], v[126:127], v[130:131]
    v_pk_add_f32 v[54:55], v[54:55], v[118:119]
    v_pk_add_f32 v[54:55], v[54:55], v[126:127]
    v_cvt_pk_bf16_f32 v52, v52, v53
    v_cvt_pk_bf16_f32 v53, v54, v55
    buffer_store_dwordx2 v[52:53], v17, s[56:59], s25 offen sc1
    s_waitcnt lgkmcnt(0)
    v_pk_add_f32 v[132:133], v[132:133], v[136:137]
    v_pk_add_f32 v[140:141], v[140:141], v[144:145]
    v_pk_add_f32 v[56:57], v[56:57], v[132:133]
    v_pk_add_f32 v[56:57], v[56:57], v[140:141]
    v_pk_add_f32 v[134:135], v[134:135], v[138:139]
    v_pk_add_f32 v[142:143], v[142:143], v[146:147]
    v_pk_add_f32 v[58:59], v[58:59], v[134:135]
    v_pk_add_f32 v[58:59], v[58:59], v[142:143]
    v_cvt_pk_bf16_f32 v56, v56, v57
    v_cvt_pk_bf16_f32 v57, v58, v59
    buffer_store_dwordx2 v[56:57], v18, s[56:59], s25 offen sc1
parallel_sum__mha_block__mixer_token_mlp__prompt_kernel_end:
    s_endpgm
parallel_sum__mha_block__mixer_token_mlp__prompt_kernel_PW2:
    s_mov_b32 s39, 0x40000
    s_mov_b32 exec_lo, 260
    s_mov_b32 exec_hi, 0
parallel_sum__mha_block__mixer_token_mlp__prompt_kernel_PW2_L:
    buffer_load_dwordx2 v[8:9], v50, s[20:23], s46 offen sc1
    s_waitcnt vmcnt(0)
    v_cmp_ne_u64 vcc, s[100:101], v[8:9]
    s_sub_u32 s39, s39, 1
    s_cbranch_scc1 parallel_sum__mha_block__mixer_token_mlp__prompt_kernel_PW2_X
    s_nop 2
    s_cbranch_vccz parallel_sum__mha_block__mixer_token_mlp__prompt_kernel_PW2_X
    s_sleep 4
    s_branch parallel_sum__mha_block__mixer_token_mlp__prompt_kernel_PW2_L
parallel_sum__mha_block__mixer_token_mlp__prompt_kernel_PW2_X:
    s_mov_b64 exec, -1
    s_branch parallel_sum__mha_block__mixer_token_mlp__prompt_kernel_PR2
parallel_sum__mha_block__mixer_token_mlp__prompt_kernel_PW3:
    s_mov_b32 s39, 0x40000
    s_mov_b32 exec_lo, 520
    s_mov_b32 exec_hi, 0
parallel_sum__mha_block__mixer_token_mlp__prompt_kernel_PW3_L:
    buffer_load_dwordx2 v[8:9], v50, s[20:23], s46 offen sc1
    s_waitcnt vmcnt(0)
    v_cmp_ne_u64 vcc, s[100:101], v[8:9]
    s_sub_u32 s39, s39, 1
    s_cbranch_scc1 parallel_sum__mha_block__mixer_token_mlp__prompt_kernel_PW3_X
    s_nop 2
    s_cbranch_vccz parallel_sum__mha_block__mixer_token_mlp__prompt_kernel_PW3_X
    s_sleep 4
    s_branch parallel_sum__mha_block__mixer_token_mlp__prompt_kernel_PW3_L
parallel_sum__mha_block__mixer_token_mlp__prompt_kernel_PW3_X:
    s_mov_b64 exec, -1
    s_branch parallel_sum__mha_block__mixer_token_mlp__prompt_kernel_PR3
parallel_sum__mha_block__mixer_token_mlp__prompt_kernel_PW4:
    s_mov_b32 s39, 0x40000
    s_mov_b32 exec_lo, 1040
    s_mov_b32 exec_hi, 0
parallel_sum__mha_block__mixer_token_mlp__prompt_kernel_PW4_L:
    buffer_load_dwordx2 v[8:9], v50, s[20:23], s46 offen sc1
    s_waitcnt vmcnt(0)
    v_cmp_ne_u64 vcc, s[100:101], v[8:9]
    s_sub_u32 s39, s39, 1
    s_cbranch_scc1 parallel_sum__mha_block__mixer_token_mlp__prompt_kernel_PW4_X
    s_nop 2
    s_cbranch_vccz parallel_sum__mha_block__mixer_token_mlp__prompt_kernel_PW4_X
    s_sleep 4
    s_branch parallel_sum__mha_block__mixer_token_mlp__prompt_kernel_PW4_L
parallel_sum__mha_block__mixer_token_mlp__prompt_kernel_PW4_X:
    s_mov_b64 exec, -1
    s_branch parallel_sum__mha_block__mixer_token_mlp__prompt_kernel_PR4
parallel_sum__mha_block__mixer_token_mlp__prompt_kernel_PW5:
    s_mov_b32 s39, 0x40000
    s_mov_b32 exec_lo, 2080
    s_mov_b32 exec_hi, 0
parallel_sum__mha_block__mixer_token_mlp__prompt_kernel_PW5_L:
    buffer_load_dwordx2 v[8:9], v50, s[20:23], s46 offen sc1
    s_waitcnt vmcnt(0)
    v_cmp_ne_u64 vcc, s[100:101], v[8:9]
    s_sub_u32 s39, s39, 1
    s_cbranch_scc1 parallel_sum__mha_block__mixer_token_mlp__prompt_kernel_PW5_X
    s_nop 2
    s_cbranch_vccz parallel_sum__mha_block__mixer_token_mlp__prompt_kernel_PW5_X
    s_sleep 4
    s_branch parallel_sum__mha_block__mixer_token_mlp__prompt_kernel_PW5_L
parallel_sum__mha_block__mixer_token_mlp__prompt_kernel_PW5_X:
    s_mov_b64 exec, -1
    s_branch parallel_sum__mha_block__mixer_token_mlp__prompt_kernel_PR5
parallel_sum__mha_block__mixer_token_mlp__prompt_kernel_last:
    s_endpgm
.section .rodata,"a"
.p2align 6
.amdhsa_kernel parallel_sum__mha_block__mixer_token_mlp__prompt_kernel
  .amdhsa_next_free_vgpr 256
  .amdhsa_next_free_sgpr 102
  .amdhsa_accum_offset 256
  .amdhsa_group_segment_fixed_size 0
  .amdhsa_kernarg_size 88
  .amdhsa_user_sgpr_count 2
  .amdhsa_user_sgpr_kernarg_segment_ptr 1
  .amdhsa_system_sgpr_workgroup_id_x 1
  .amdhsa_float_denorm_mode_32 3
.end_amdhsa_kernel
```
